```python
import torch

def _softmax(x, axis=-1):
    return torch.softmax(x, dim=axis)
def _gelu(x):
    return torch.nn.functional.gelu(x, approximate="tanh")
def _silu(x):
    return torch.nn.functional.silu(x)
def _sigmoid(x):
    return torch.sigmoid(x)
def _layernorm(x, axis=-1, eps=1e-5):
    m = x.mean(dim=axis, keepdim=True)
    v = x.var(dim=axis, keepdim=True, unbiased=False)
    return (x - m) / torch.sqrt(v + eps)
def _scatter_add(tgt, idx, src, axis=0):
    return tgt.clone().index_add_(axis, idx, src)
def _segment_sum(src, seg, n):
    out = torch.zeros((n,) + src.shape[1:], dtype=src.dtype)
    return out.index_add_(0, seg, src)
def _pad(x, pw):
    flat = tuple(v for pair in reversed(pw) for v in pair)
    return torch.nn.functional.pad(x, flat)

kernel_name = 'standalone__mha_block_cached__near_ridge'

def setup_inputs():

    _w = (lambda a: (lambda t: t.to(torch.bfloat16) if t.is_floating_point() else t)(torch.as_tensor(a)))
    B, Sq, D = 8, 192, 640
    H, Sk, Dh = 32, 2048, 128
    return {
        "x": _w((lambda *s: torch.randn(*s, dtype=torch.bfloat16) * 0.8)(B, Sq, D)),
        "k_cache": _w((lambda *s: torch.randn(*s, dtype=torch.bfloat16) * 0.8)(B, H, Sk, Dh)),
        "v_cache": _w((lambda *s: torch.randn(*s, dtype=torch.bfloat16) * 0.05)(B, H, Sk, Dh)),
        "wq": _w((lambda *s: torch.randn(*s, dtype=torch.bfloat16) * 0.8)(D, H * Dh) * (D ** -0.5)),
        "wo": _w((lambda *s: torch.randn(*s, dtype=torch.bfloat16) * 0.05)(H * Dh, D) * ((H * Dh) ** -0.5)),
    }

def reference(x, k_cache, v_cache, wq, wo):
    B, Sq, D = x.shape
    H, Dh = 32, 128
    q = (lambda x, *d: x.permute(*d))((x @ wq).reshape(B, Sq, H, Dh), 0, 2, 1, 3)
    scores = torch.einsum("bhqd,bhkd->bhqk", q, k_cache) * (Dh ** -0.5)
    p = _softmax(scores, axis=-1)
    o = torch.einsum("bhqk,bhkd->bhqd", p, v_cache)
    return (lambda x, *d: x.permute(*d))(o, 0, 2, 1, 3).reshape(B, Sq, H * Dh) @ wo
```

```asm
; @launch grid=(256,1,1) block=(256,1,1) lds=163840
.amdgcn_target "amdgcn-amd-amdhsa--gfx950"
.text
.globl standalone__mha_block_cached__near_ridge_kernel
.p2align 8
.type standalone__mha_block_cached__near_ridge_kernel,@function
standalone__mha_block_cached__near_ridge_kernel:
  s_cmp_ge_u32 s2, 256
  s_cbranch_scc1 K1_end
  s_mov_b32 s44, 0
K1_start:
  s_load_dwordx8 s[4:11], s[0:1], 0
  s_load_dwordx2 s[12:13], s[0:1], 56
  s_load_dwordx4 s[84:87], s[0:1], 32
  s_load_dwordx2 s[88:89], s[0:1], 48
  v_lshrrev_b32 v208, 6, v0
  v_and_b32 v187, 63, v0
  v_readfirstlane_b32 s36, v208
  v_lshlrev_b32 v186, 4, v187
  s_getpc_b64 s[56:57]
K1_pc:
  v_lshlrev_b32 v249, 7, v0
  global_load_dword v217, v249, s[56:57]
  v_add_u32 v251, 32768, v249
  v_min_u32 v251, K1_safe-K1_pc, v251
  global_load_dword v250, v251, s[56:57]
  s_and_b32 s39, s2, 1
  s_lshl_b32 s39, s39, 2
  s_lshr_b32 s46, s2, 6
  s_add_u32 s39, s39, s46
  s_and_b32 s40, s2, 6
  s_lshl_b32 s40, s40, 2
  s_bfe_u32 s47, s2, 0x30003
  s_add_u32 s40, s40, s47
  s_mul_i32 s46, s46, 5
  s_add_u32 s46, s46, 1
  s_lshr_b32 s46, s46, 1
  s_add_u32 s46, s46, s47
  s_cmp_ge_u32 s46, 10
  s_cselect_b32 s47, 10, 0
  s_sub_u32 s46, s46, s47
  s_add_u32 s46, s40, s39
  s_and_b32 s46, s46, 3
  s_lshl_b32 s60, s46, 7
  s_lshl_b32 s50, s46, 7
  s_and_b32 s50, s50, 128
  s_and_b32 s37, s36, 1
  s_lshr_b32 s38, s36, 1
  s_lshl_b32 s45, s36, 12
  v_lshrrev_b32 v209, 4, v187
  v_and_b32 v210, 15, v187
  v_lshrrev_b32 v211, 3, v187
  v_and_b32 v212, 7, v187
  v_xor_b32 v212, v212, v209
  v_lshlrev_b32 v212, 4, v212
  v_xor_b32 v213, 64, v212
  v_mul_u32_u24 v211, 1280, v211
  s_mul_i32 s46, s36, 61440
  v_add_u32 v211, s46, v211
  v_add_u32 v212, v211, v212
  v_add_u32 v213, v211, v213
  v_add_u32 v218, 0, v212
  v_add_u32 v219, 9216, v213
  v_add_u32 v220, 18432, v212
  v_add_u32 v221, 27648, v213
  v_add_u32 v222, 40960, v212
  v_add_u32 v223, 50176, v213
  v_lshlrev_b32 v211, 2, v209
  v_xor_b32 v211, v211, v210
  v_lshlrev_b32 v211, 4, v211
  s_lshl_b32 s46, s36, 17
  s_lshl_b32 s47, s40, 8
  s_add_u32 s46, s46, s47
  v_lshl_add_u32 v212, v209, 13, v211
  v_add_u32 v212, s46, v212
  v_xor_b32 v213, 32, v212
  v_add_u32 v224, 0, v212
  v_add_u32 v225, 31744, v212
  v_add_u32 v226, 63488, v213
  v_add_u32 v227, 95232, v213
  s_mul_i32 s48, s36, 6144
  s_add_u32 s49, s45, 24576
  s_mul_i32 s46, s39, 245760
  s_lshl_b32 s47, s39, 5
  s_add_u32 s47, s47, s40
  s_lshl_b32 s47, s47, 19
  s_waitcnt lgkmcnt(0)
  s_add_u32 s16, s4, s46
  s_addc_u32 s17, s5, 0
  s_and_b32 s17, s17, 0xffff
  s_mov_b32 s18, 0x3c000
  s_mov_b32 s19, 0x20000
  s_mov_b32 s20, s10
  s_and_b32 s21, s11, 0xffff
  s_mov_b32 s22, 0x500000
  s_mov_b32 s23, 0x20000
  s_add_u32 m0, s48, 122880
  s_lshl_b32 s51, s50, 12
  buffer_load_dwordx4 v218, s[16:19], s50 offen lds
  buffer_load_dwordx4 v219, s[16:19], s50 offen offset:1024 lds
  buffer_load_dwordx4 v220, s[16:19], s50 offen offset:2048 lds
  buffer_load_dwordx4 v221, s[16:19], s50 offen offset:3072 lds
  s_add_u32 m0, s48, 126976
  s_nop 0
  buffer_load_dwordx4 v222, s[16:19], s50 offen lds
  buffer_load_dwordx4 v223, s[16:19], s50 offen offset:1024 lds
  s_add_u32 m0, s49, 122880
  s_add_u32 s50, s60, 128
  s_and_b32 s50, s50, 128
  s_add_u32 s50, s50, 0
  buffer_load_dwordx4 v224, s[20:23], s51 offen lds
  buffer_load_dwordx4 v225, s[20:23], s51 offen offset:1024 lds
  buffer_load_dwordx4 v226, s[20:23], s51 offen offset:2048 lds
  buffer_load_dwordx4 v227, s[20:23], s51 offen offset:3072 lds
  v_lshrrev_b32 v212, 1, v210
  v_xor_b32 v212, v212, v209
  v_lshlrev_b32 v212, 4, v212
  v_lshl_add_u32 v212, v210, 7, v212
  s_mul_i32 s46, s37, 12288
  v_add_u32 v228, s46, v212
  v_xor_b32 v229, 64, v228
  v_bfe_u32 v214, v187, 2, 2
  v_bfe_u32 v212, v187, 1, 1
  v_lshl_add_u32 v212, v214, 2, v212
  v_bfe_u32 v213, v187, 4, 1
  v_lshl_add_u32 v212, v213, 1, v212
  v_and_b32 v213, 1, v187
  v_lshlrev_b32 v213, 3, v213
  v_lshl_add_u32 v215, v212, 4, v213
  v_lshl_add_u32 v215, v214, 8, v215
  v_lshl_add_u32 v212, v209, 11, v215
  v_add_u32 v212, 24576, v212
  s_lshl_b32 s46, s38, 7
  v_xor_b32 v212, s46, v212
  v_xor_b32 v230, 0, v212
  v_xor_b32 v231, 32, v212
  v_xor_b32 v232, 64, v212
  v_xor_b32 v233, 96, v212
  v_add_u32 v234, 81920, v228
  v_add_u32 v235, 81920, v229
  v_add_u32 v236, 81920, v230
  v_add_u32 v237, 81920, v231
  v_add_u32 v238, 81920, v232
  v_add_u32 v239, 81920, v233
  s_add_u32 m0, s48, 0
  s_lshl_b32 s51, s50, 12
  buffer_load_dwordx4 v218, s[16:19], s50 offen lds
  buffer_load_dwordx4 v219, s[16:19], s50 offen offset:1024 lds
  buffer_load_dwordx4 v220, s[16:19], s50 offen offset:2048 lds
  buffer_load_dwordx4 v221, s[16:19], s50 offen offset:3072 lds
  s_add_u32 m0, s48, 4096
  s_nop 0
  buffer_load_dwordx4 v222, s[16:19], s50 offen lds
  buffer_load_dwordx4 v223, s[16:19], s50 offen offset:1024 lds
  s_add_u32 m0, s49, 0
  s_add_u32 s50, s60, 0
  s_and_b32 s50, s50, 384
  s_add_u32 s50, s50, 256
  buffer_load_dwordx4 v224, s[20:23], s51 offen lds
  buffer_load_dwordx4 v225, s[20:23], s51 offen offset:1024 lds
  buffer_load_dwordx4 v226, s[20:23], s51 offen offset:2048 lds
  buffer_load_dwordx4 v227, s[20:23], s51 offen offset:3072 lds
  s_add_u32 s24, s6, s47
  s_addc_u32 s25, s7, 0
  s_and_b32 s25, s25, 0xffff
  s_mov_b32 s26, 0x80000
  s_mov_b32 s27, 0x20000
  s_add_u32 s28, s8, s47
  s_addc_u32 s29, s9, 0
  s_and_b32 s29, s29, 0xffff
  s_mov_b32 s30, 0x80000
  s_mov_b32 s31, 0x20000
  s_mov_b32 s32, s12
  s_and_b32 s33, s13, 0xffff
  s_mov_b32 s34, 0xf08000
  s_mov_b32 s35, 0x20000
  s_mov_b32 s52, s88
  s_and_b32 s53, s89, 0xffff
  s_mov_b32 s54, 0x100
  s_mov_b32 s55, 0x20000
  s_mov_b32 s92, s84
  s_and_b32 s93, s85, 0xffff
  s_mov_b32 s94, 0x500000
  s_mov_b32 s95, 0x20000
  s_mov_b32 s41, s45
  s_mov_b32 s42, s45
  v_lshl_add_u32 v185, v209, 8, v211
  s_lshl_b32 s46, s37, 5
  v_xor_b32 v185, s46, v185
  v_xor_b32 v212, v210, v209
  v_lshlrev_b32 v212, 4, v212
  v_lshl_add_u32 v184, v209, 8, v212
  s_lshl_b32 s46, s36, 6
  v_xor_b32 v184, s46, v184
  v_lshl_add_u32 v212, v209, 12, v215
  v_add_u32 v212, 65536, v212
  v_xor_b32 v176, 0, v212
  v_xor_b32 v177, 32, v212
  v_xor_b32 v178, 64, v212
  v_xor_b32 v179, 96, v212
  v_xor_b32 v180, 128, v212
  v_xor_b32 v181, 160, v212
  v_xor_b32 v182, 192, v212
  v_xor_b32 v183, 224, v212
  v_and_b32 v212, 3, v187
  v_lshl_add_u32 v212, v214, 4, v212
  v_xor_b32 v213, v210, v209
  v_lshlrev_b32 v213, 4, v213
  v_lshl_add_u32 v212, v212, 8, v213
  v_xor_b32 v172, 0, v212
  v_xor_b32 v173, 64, v212
  v_xor_b32 v174, 128, v212
  v_xor_b32 v175, 192, v212
  s_mul_i32 s57, s36, 12288
  s_add_u32 s57, s57, 114688
  v_lshl_add_u32 v212, v210, 8, v213
  v_add_u32 v212, s57, v212
  v_xor_b32 v240, 0, v212
  v_xor_b32 v241, 64, v212
  v_xor_b32 v242, 128, v212
  v_xor_b32 v243, 192, v212
  s_mul_i32 s57, s37, 24576
  s_add_u32 s57, s57, 114688
  v_lshrrev_b32 v212, 5, v187
  v_xor_b32 v212, v212, v210
  s_lshl_b32 s58, s38, 3
  v_xor_b32 v212, s58, v212
  v_lshlrev_b32 v212, 4, v212
  v_bfe_u32 v213, v187, 4, 1
  v_lshl_add_u32 v212, v213, 3, v212
  v_lshl_add_u32 v212, v210, 8, v212
  v_add_u32 v212, s57, v212
  v_xor_b32 v244, 0, v212
  v_xor_b32 v245, 32, v212
  v_xor_b32 v246, 64, v212
  v_xor_b32 v247, 96, v212
  v_and_b32 v212, 3, v187
  v_mov_b32 v213, 0x3f803f80
  v_cmp_eq_u32 vcc, 0, v212
  s_nop 1
  v_cndmask_b32 v160, 0, v213, vcc
  v_mov_b32 v161, v160
  v_mov_b32 v162, v160
  v_mov_b32 v163, v160
  v_cmp_eq_u32 vcc, 1, v212
  s_nop 1
  v_cndmask_b32 v164, 0, v213, vcc
  v_mov_b32 v165, v164
  v_mov_b32 v166, v164
  v_mov_b32 v167, v164
  v_cmp_eq_u32 vcc, 2, v212
  s_nop 1
  v_cndmask_b32 v168, 0, v213, vcc
  v_mov_b32 v169, v168
  v_mov_b32 v170, v168
  v_mov_b32 v171, v168
  v_mov_b64 v[156:157], 0
  v_mov_b64 v[158:159], 0
  s_lshr_b32 s61, s2, 3
  s_mul_i32 s62, s61, 205
  s_lshr_b32 s62, s62, 10
  s_mul_i32 s63, s62, 5
  s_sub_u32 s63, s61, s63
  s_and_b32 s64, s2, 1
  s_mul_i32 s64, s64, 12
  s_waitcnt vmcnt(10)
  s_barrier
  ds_read_b64_tr_b16 a[48:49], v236 offset:40960
  ds_read_b64_tr_b16 a[50:51], v236 offset:41984
  ds_read_b128 a[80:83], v234 offset:40960
  ds_read_b128 a[84:87], v234 offset:43008
  ds_read_b128 a[88:91], v234 offset:45056
  ds_read_b128 a[92:95], v234 offset:47104
  ds_read_b128 a[96:99], v234 offset:49152
  ds_read_b128 a[100:103], v234 offset:51200
  ds_read_b64_tr_b16 a[52:53], v237 offset:40960
  ds_read_b64_tr_b16 a[54:55], v237 offset:41984
  ds_read_b64_tr_b16 a[56:57], v238 offset:40960
  ds_read_b64_tr_b16 a[58:59], v238 offset:41984
  ds_read_b64_tr_b16 a[60:61], v239 offset:40960
  ds_read_b64_tr_b16 a[62:63], v239 offset:41984
  s_waitcnt lgkmcnt(6)
  v_mfma_f32_16x16x32_bf16 v[0:3], a[48:51], a[80:83], 0
  ds_read_b64_tr_b16 a[64:65], v236 offset:49152
  ds_read_b64_tr_b16 a[66:67], v236 offset:50176
  v_mfma_f32_16x16x32_bf16 v[4:7], a[48:51], a[84:87], 0
  s_add_u32 m0, s48, 81920
  s_lshl_b32 s51, s50, 12
  buffer_load_dwordx4 v218, s[16:19], s50 offen lds
  v_mfma_f32_16x16x32_bf16 v[8:11], a[48:51], a[88:91], 0
  ds_read_b128 a[104:107], v235 offset:40960
  ds_read_b128 a[108:111], v235 offset:43008
  v_mfma_f32_16x16x32_bf16 v[12:15], a[48:51], a[92:95], 0
  buffer_load_dwordx4 v219, s[16:19], s50 offen offset:1024 lds
  v_mfma_f32_16x16x32_bf16 v[16:19], a[48:51], a[96:99], 0
  ds_read_b128 a[112:115], v235 offset:45056
  ds_read_b128 a[116:119], v235 offset:47104
  v_mfma_f32_16x16x32_bf16 v[20:23], a[48:51], a[100:103], 0
  buffer_load_dwordx4 v220, s[16:19], s50 offen offset:2048 lds
  s_waitcnt lgkmcnt(6)
  v_mfma_f32_16x16x32_bf16 v[24:27], a[52:55], a[80:83], 0
  ds_read_b128 a[120:123], v235 offset:49152
  ds_read_b128 a[124:127], v235 offset:51200
  v_mfma_f32_16x16x32_bf16 v[28:31], a[52:55], a[84:87], 0
  buffer_load_dwordx4 v221, s[16:19], s50 offen offset:3072 lds
  v_mfma_f32_16x16x32_bf16 v[32:35], a[52:55], a[88:91], 0
  ds_read_b64_tr_b16 a[68:69], v237 offset:49152
  ds_read_b64_tr_b16 a[70:71], v237 offset:50176
  v_mfma_f32_16x16x32_bf16 v[36:39], a[52:55], a[92:95], 0
  s_add_u32 m0, s48, 86016
  s_nop 0
  buffer_load_dwordx4 v222, s[16:19], s50 offen lds
  v_mfma_f32_16x16x32_bf16 v[40:43], a[52:55], a[96:99], 0
  ds_read_b64_tr_b16 a[72:73], v238 offset:49152
  ds_read_b64_tr_b16 a[74:75], v238 offset:50176
  v_mfma_f32_16x16x32_bf16 v[44:47], a[52:55], a[100:103], 0
  buffer_load_dwordx4 v223, s[16:19], s50 offen offset:1024 lds
  v_mfma_f32_16x16x32_bf16 v[48:51], a[56:59], a[80:83], 0
  ds_read_b64_tr_b16 a[76:77], v239 offset:49152
  ds_read_b64_tr_b16 a[78:79], v239 offset:50176
  v_mfma_f32_16x16x32_bf16 v[52:55], a[56:59], a[84:87], 0
  s_add_u32 m0, s49, 81920
  s_add_u32 s50, s60, 128
  s_and_b32 s50, s50, 384
  s_add_u32 s50, s50, 256
  buffer_load_dwordx4 v224, s[20:23], s51 offen lds
  v_mfma_f32_16x16x32_bf16 v[56:59], a[56:59], a[88:91], 0
  v_mfma_f32_16x16x32_bf16 v[60:63], a[56:59], a[92:95], 0
  buffer_load_dwordx4 v225, s[20:23], s51 offen offset:1024 lds
  v_mfma_f32_16x16x32_bf16 v[64:67], a[56:59], a[96:99], 0
  v_mfma_f32_16x16x32_bf16 v[68:71], a[56:59], a[100:103], 0
  buffer_load_dwordx4 v226, s[20:23], s51 offen offset:2048 lds
  v_mfma_f32_16x16x32_bf16 v[72:75], a[60:63], a[80:83], 0
  v_mfma_f32_16x16x32_bf16 v[76:79], a[60:63], a[84:87], 0
  buffer_load_dwordx4 v227, s[20:23], s51 offen offset:3072 lds
  v_mfma_f32_16x16x32_bf16 v[80:83], a[60:63], a[88:91], 0
  v_mfma_f32_16x16x32_bf16 v[84:87], a[60:63], a[92:95], 0
  v_mfma_f32_16x16x32_bf16 v[88:91], a[60:63], a[96:99], 0
  v_mfma_f32_16x16x32_bf16 v[92:95], a[60:63], a[100:103], 0
  s_waitcnt lgkmcnt(0)
  s_waitcnt vmcnt(10)
  s_barrier
  v_mfma_f32_16x16x32_bf16 v[0:3], a[64:67], a[104:107], v[0:3]
  ds_read_b64_tr_b16 a[48:49], v230
  ds_read_b64_tr_b16 a[50:51], v230 offset:1024
  v_mfma_f32_16x16x32_bf16 v[4:7], a[64:67], a[108:111], v[4:7]
  s_add_u32 m0, s48, 122880
  s_lshl_b32 s51, s50, 12
  buffer_load_dwordx4 v218, s[16:19], s50 offen lds
  v_mfma_f32_16x16x32_bf16 v[8:11], a[64:67], a[112:115], v[8:11]
  ds_read_b128 a[80:83], v228
  ds_read_b128 a[84:87], v228 offset:2048
  v_mfma_f32_16x16x32_bf16 v[12:15], a[64:67], a[116:119], v[12:15]
  s_bfe_u32 s65, s2, 0x10002
  s_mul_i32 s65, s65, 6
  s_add_u32 s64, s64, s65
  s_add_u32 s64, s64, s62
  v_mfma_f32_16x16x32_bf16 v[16:19], a[64:67], a[120:123], v[16:19]
  ds_read_b128 a[88:91], v228 offset:4096
  ds_read_b128 a[92:95], v228 offset:6144
  v_mfma_f32_16x16x32_bf16 v[20:23], a[64:67], a[124:127], v[20:23]
  buffer_load_dwordx4 v219, s[16:19], s50 offen offset:1024 lds
  v_mfma_f32_16x16x32_bf16 v[24:27], a[68:71], a[104:107], v[24:27]
  ds_read_b128 a[96:99], v228 offset:8192
  ds_read_b128 a[100:103], v228 offset:10240
  v_mfma_f32_16x16x32_bf16 v[28:31], a[68:71], a[108:111], v[28:31]
  s_bfe_u32 s65, s2, 0x10001
  s_mul_i32 s90, s65, 640
  s_mul_i32 s65, s65, 5
  s_add_u32 s65, s65, s63
  v_mfma_f32_16x16x32_bf16 v[32:35], a[68:71], a[112:115], v[32:35]
  ds_read_b64_tr_b16 a[52:53], v231
  ds_read_b64_tr_b16 a[54:55], v231 offset:1024
  v_mfma_f32_16x16x32_bf16 v[36:39], a[68:71], a[116:119], v[36:39]
  buffer_load_dwordx4 v220, s[16:19], s50 offen offset:2048 lds
  v_mfma_f32_16x16x32_bf16 v[40:43], a[68:71], a[120:123], v[40:43]
  ds_read_b64_tr_b16 a[56:57], v232
  ds_read_b64_tr_b16 a[58:59], v232 offset:1024
  v_mfma_f32_16x16x32_bf16 v[44:47], a[68:71], a[124:127], v[44:47]
  s_lshl_b32 s65, s65, 7
  s_mul_i32 s66, s64, 171
  s_lshr_b32 s66, s66, 9
  s_mul_i32 s67, s62, 1
  v_mfma_f32_16x16x32_bf16 v[48:51], a[72:75], a[104:107], v[48:51]
  ds_read_b64_tr_b16 a[60:61], v233
  ds_read_b64_tr_b16 a[62:63], v233 offset:1024
  v_mfma_f32_16x16x32_bf16 v[52:55], a[72:75], a[108:111], v[52:55]
  buffer_load_dwordx4 v221, s[16:19], s50 offen offset:3072 lds
  v_mfma_f32_16x16x32_bf16 v[56:59], a[72:75], a[112:115], v[56:59]
  s_mul_i32 s68, s63, 3
  s_add_u32 s67, s67, s68
  v_mfma_f32_16x16x32_bf16 v[60:63], a[72:75], a[116:119], v[60:63]
  v_mfma_f32_16x16x32_bf16 v[64:67], a[72:75], a[120:123], v[64:67]
  v_mfma_f32_16x16x32_bf16 v[68:71], a[72:75], a[124:127], v[68:71]
  s_add_u32 m0, s48, 126976
  s_nop 0
  buffer_load_dwordx4 v222, s[16:19], s50 offen lds
  v_mfma_f32_16x16x32_bf16 v[72:75], a[76:79], a[104:107], v[72:75]
  v_mfma_f32_16x16x32_bf16 v[76:79], a[76:79], a[108:111], v[76:79]
  v_mfma_f32_16x16x32_bf16 v[80:83], a[76:79], a[112:115], v[80:83]
  v_mfma_f32_16x16x32_bf16 v[84:87], a[76:79], a[116:119], v[84:87]
  buffer_load_dwordx4 v223, s[16:19], s50 offen offset:1024 lds
  v_mfma_f32_16x16x32_bf16 v[88:91], a[76:79], a[120:123], v[88:91]
  v_mfma_f32_16x16x32_bf16 v[92:95], a[76:79], a[124:127], v[92:95]
  s_waitcnt lgkmcnt(6)
  v_mfma_f32_16x16x32_bf16 v[0:3], a[48:51], a[80:83], v[0:3]
  ds_read_b64_tr_b16 a[64:65], v230 offset:8192
  ds_read_b64_tr_b16 a[66:67], v230 offset:9216
  v_mfma_f32_16x16x32_bf16 v[4:7], a[48:51], a[84:87], v[4:7]
  s_add_u32 m0, s49, 122880
  s_add_u32 s50, s60, 256
  s_and_b32 s50, s50, 384
  s_add_u32 s50, s50, 256
  buffer_load_dwordx4 v224, s[20:23], s51 offen lds
  v_mfma_f32_16x16x32_bf16 v[8:11], a[48:51], a[88:91], v[8:11]
  ds_read_b128 a[104:107], v229
  ds_read_b128 a[108:111], v229 offset:2048
  v_mfma_f32_16x16x32_bf16 v[12:15], a[48:51], a[92:95], v[12:15]
  s_lshl_b32 s69, s64, 2
  s_add_u32 s69, s69, s36
  s_lshl_b32 s75, s69, 17
  s_lshl_b32 s76, s36, 15
  v_mfma_f32_16x16x32_bf16 v[16:19], a[48:51], a[96:99], v[16:19]
  ds_read_b128 a[112:115], v229 offset:4096
  ds_read_b128 a[116:119], v229 offset:6144
  v_mfma_f32_16x16x32_bf16 v[20:23], a[48:51], a[100:103], v[20:23]
  buffer_load_dwordx4 v225, s[20:23], s51 offen offset:1024 lds
  s_waitcnt lgkmcnt(6)
  v_mfma_f32_16x16x32_bf16 v[24:27], a[52:55], a[80:83], v[24:27]
  ds_read_b128 a[120:123], v229 offset:8192
  ds_read_b128 a[124:127], v229 offset:10240
  v_mfma_f32_16x16x32_bf16 v[28:31], a[52:55], a[84:87], v[28:31]
  s_add_u32 s75, s75, s76
  s_mul_i32 s76, s36, 1310720
  s_add_u32 s76, s76, s65
  s_mul_i32 s69, s69, 20480
  v_mfma_f32_16x16x32_bf16 v[32:35], a[52:55], a[88:91], v[32:35]
  ds_read_b64_tr_b16 a[68:69], v231 offset:8192
  ds_read_b64_tr_b16 a[70:71], v231 offset:9216
  v_mfma_f32_16x16x32_bf16 v[36:39], a[52:55], a[92:95], v[36:39]
  buffer_load_dwordx4 v226, s[20:23], s51 offen offset:2048 lds
  v_mfma_f32_16x16x32_bf16 v[40:43], a[52:55], a[96:99], v[40:43]
  ds_read_b64_tr_b16 a[72:73], v232 offset:8192
  ds_read_b64_tr_b16 a[74:75], v232 offset:9216
  v_mfma_f32_16x16x32_bf16 v[44:47], a[52:55], a[100:103], v[44:47]
  s_add_u32 s69, s69, s65
  s_lshl_b32 s77, s61, 2
  s_add_u32 s77, s77, s36
  s_mul_i32 s77, s77, 40960
  v_mfma_f32_16x16x32_bf16 v[48:51], a[56:59], a[80:83], v[48:51]
  ds_read_b64_tr_b16 a[76:77], v233 offset:8192
  ds_read_b64_tr_b16 a[78:79], v233 offset:9216
  v_mfma_f32_16x16x32_bf16 v[52:55], a[56:59], a[84:87], v[52:55]
  buffer_load_dwordx4 v227, s[20:23], s51 offen offset:3072 lds
  v_mfma_f32_16x16x32_bf16 v[56:59], a[56:59], a[88:91], v[56:59]
  s_add_u32 s77, s77, s90
  v_lshrrev_b32 v212, 3, v187
  v_mfma_f32_16x16x32_bf16 v[60:63], a[56:59], a[92:95], v[60:63]
  v_mfma_f32_16x16x32_bf16 v[64:67], a[56:59], a[96:99], v[64:67]
  v_mfma_f32_16x16x32_bf16 v[68:71], a[56:59], a[100:103], v[68:71]
  v_mfma_f32_16x16x32_bf16 v[72:75], a[60:63], a[80:83], v[72:75]
  v_mfma_f32_16x16x32_bf16 v[76:79], a[60:63], a[84:87], v[76:79]
  v_mfma_f32_16x16x32_bf16 v[80:83], a[60:63], a[88:91], v[80:83]
  v_mfma_f32_16x16x32_bf16 v[84:87], a[60:63], a[92:95], v[84:87]
  v_mfma_f32_16x16x32_bf16 v[88:91], a[60:63], a[96:99], v[88:91]
  v_mfma_f32_16x16x32_bf16 v[92:95], a[60:63], a[100:103], v[92:95]
  s_waitcnt lgkmcnt(0)
  s_waitcnt vmcnt(10)
  s_barrier
  v_mfma_f32_16x16x32_bf16 v[0:3], a[64:67], a[104:107], v[0:3]
  ds_read_b64_tr_b16 a[48:49], v236
  ds_read_b64_tr_b16 a[50:51], v236 offset:1024
  v_mfma_f32_16x16x32_bf16 v[4:7], a[64:67], a[108:111], v[4:7]
  s_add_u32 m0, s48, 0
  s_lshl_b32 s51, s50, 12
  buffer_load_dwordx4 v218, s[16:19], s50 offen lds
  v_mfma_f32_16x16x32_bf16 v[8:11], a[64:67], a[112:115], v[8:11]
  ds_read_b128 a[80:83], v234
  ds_read_b128 a[84:87], v234 offset:2048
  v_mfma_f32_16x16x32_bf16 v[12:15], a[64:67], a[116:119], v[12:15]
  v_and_b32 v213, 7, v187
  v_lshrrev_b32 v193, 4, v187
  v_mfma_f32_16x16x32_bf16 v[16:19], a[64:67], a[120:123], v[16:19]
  ds_read_b128 a[88:91], v234 offset:4096
  ds_read_b128 a[92:95], v234 offset:6144
  v_mfma_f32_16x16x32_bf16 v[20:23], a[64:67], a[124:127], v[20:23]
  buffer_load_dwordx4 v219, s[16:19], s50 offen offset:1024 lds
  v_mfma_f32_16x16x32_bf16 v[24:27], a[68:71], a[104:107], v[24:27]
  ds_read_b128 a[96:99], v234 offset:8192
  ds_read_b128 a[100:103], v234 offset:10240
  v_mfma_f32_16x16x32_bf16 v[28:31], a[68:71], a[108:111], v[28:31]
  v_lshlrev_b32 v194, 1, v193
  v_xor_b32 v213, v213, v194
  v_mfma_f32_16x16x32_bf16 v[32:35], a[68:71], a[112:115], v[32:35]
  ds_read_b64_tr_b16 a[52:53], v237
  ds_read_b64_tr_b16 a[54:55], v237 offset:1024
  v_mfma_f32_16x16x32_bf16 v[36:39], a[68:71], a[116:119], v[36:39]
  buffer_load_dwordx4 v220, s[16:19], s50 offen offset:2048 lds
  v_mfma_f32_16x16x32_bf16 v[40:43], a[68:71], a[120:123], v[40:43]
  ds_read_b64_tr_b16 a[56:57], v238
  ds_read_b64_tr_b16 a[58:59], v238 offset:1024
  v_mfma_f32_16x16x32_bf16 v[44:47], a[68:71], a[124:127], v[44:47]
  v_lshlrev_b32 v213, 4, v213
  v_mul_u32_u24 v212, 1280, v212
  v_mfma_f32_16x16x32_bf16 v[48:51], a[72:75], a[104:107], v[48:51]
  ds_read_b64_tr_b16 a[60:61], v239
  ds_read_b64_tr_b16 a[62:63], v239 offset:1024
  v_mfma_f32_16x16x32_bf16 v[52:55], a[72:75], a[108:111], v[52:55]
  buffer_load_dwordx4 v221, s[16:19], s50 offen offset:3072 lds
  v_mfma_f32_16x16x32_bf16 v[56:59], a[72:75], a[112:115], v[56:59]
  v_add3_u32 v188, v212, v213, s76
  v_add_u32 v189, 9216, v188
  v_mfma_f32_16x16x32_bf16 v[60:63], a[72:75], a[116:119], v[60:63]
  v_add_u32 v190, 9216, v189
  v_add_u32 v191, 9216, v190
  v_mfma_f32_16x16x32_bf16 v[64:67], a[72:75], a[120:123], v[64:67]
  v_bfe_u32 v212, v187, 2, 2
  v_lshl_add_u32 v212, v193, 2, v212
  v_mfma_f32_16x16x32_bf16 v[68:71], a[72:75], a[124:127], v[68:71]
  s_add_u32 m0, s48, 4096
  s_nop 0
  buffer_load_dwordx4 v222, s[16:19], s50 offen lds
  v_mfma_f32_16x16x32_bf16 v[72:75], a[76:79], a[104:107], v[72:75]
  v_bfe_u32 v213, v212, 1, 2
  v_lshlrev_b32 v213, 5, v213
  v_mfma_f32_16x16x32_bf16 v[76:79], a[76:79], a[108:111], v[76:79]
  v_mfma_f32_16x16x32_bf16 v[80:83], a[76:79], a[112:115], v[80:83]
  v_mfma_f32_16x16x32_bf16 v[84:87], a[76:79], a[116:119], v[84:87]
  buffer_load_dwordx4 v223, s[16:19], s50 offen offset:1024 lds
  v_mfma_f32_16x16x32_bf16 v[88:91], a[76:79], a[120:123], v[88:91]
  v_mfma_f32_16x16x32_bf16 v[92:95], a[76:79], a[124:127], v[92:95]
  s_waitcnt lgkmcnt(6)
  v_mfma_f32_16x16x32_bf16 v[0:3], a[48:51], a[80:83], v[0:3]
  ds_read_b64_tr_b16 a[64:65], v236 offset:8192
  ds_read_b64_tr_b16 a[66:67], v236 offset:9216
  v_mfma_f32_16x16x32_bf16 v[4:7], a[48:51], a[84:87], v[4:7]
  s_add_u32 m0, s49, 0
  s_add_u32 s50, s60, 384
  s_and_b32 s50, s50, 384
  s_add_u32 s50, s50, 256
  buffer_load_dwordx4 v224, s[20:23], s51 offen lds
  v_mfma_f32_16x16x32_bf16 v[8:11], a[48:51], a[88:91], v[8:11]
  ds_read_b128 a[104:107], v235
  ds_read_b128 a[108:111], v235 offset:2048
  v_mfma_f32_16x16x32_bf16 v[12:15], a[48:51], a[92:95], v[12:15]
  v_lshl_add_u32 v213, v212, 7, v213
  v_and_b32 v212, 3, v187
  v_mfma_f32_16x16x32_bf16 v[16:19], a[48:51], a[96:99], v[16:19]
  ds_read_b128 a[112:115], v235 offset:4096
  ds_read_b128 a[116:119], v235 offset:6144
  v_mfma_f32_16x16x32_bf16 v[20:23], a[48:51], a[100:103], v[20:23]
  buffer_load_dwordx4 v225, s[20:23], s51 offen offset:1024 lds
  s_waitcnt lgkmcnt(6)
  v_mfma_f32_16x16x32_bf16 v[24:27], a[52:55], a[80:83], v[24:27]
  ds_read_b128 a[120:123], v235 offset:8192
  ds_read_b128 a[124:127], v235 offset:10240
  v_mfma_f32_16x16x32_bf16 v[28:31], a[52:55], a[84:87], v[28:31]
  v_lshl_add_u32 v213, v212, 3, v213
  v_add_u32 v192, s45, v213
  v_mfma_f32_16x16x32_bf16 v[32:35], a[52:55], a[88:91], v[32:35]
  ds_read_b64_tr_b16 a[68:69], v237 offset:8192
  ds_read_b64_tr_b16 a[70:71], v237 offset:9216
  v_mfma_f32_16x16x32_bf16 v[36:39], a[52:55], a[92:95], v[36:39]
  buffer_load_dwordx4 v226, s[20:23], s51 offen offset:2048 lds
  v_mfma_f32_16x16x32_bf16 v[40:43], a[52:55], a[96:99], v[40:43]
  ds_read_b64_tr_b16 a[72:73], v238 offset:8192
  ds_read_b64_tr_b16 a[74:75], v238 offset:9216
  v_mfma_f32_16x16x32_bf16 v[44:47], a[52:55], a[100:103], v[44:47]
  v_xor_b32 v193, 32, v192
  v_xor_b32 v194, 64, v192
  v_mfma_f32_16x16x32_bf16 v[48:51], a[56:59], a[80:83], v[48:51]
  ds_read_b64_tr_b16 a[76:77], v239 offset:8192
  ds_read_b64_tr_b16 a[78:79], v239 offset:9216
  v_mfma_f32_16x16x32_bf16 v[52:55], a[56:59], a[84:87], v[52:55]
  buffer_load_dwordx4 v227, s[20:23], s51 offen offset:3072 lds
  v_mfma_f32_16x16x32_bf16 v[56:59], a[56:59], a[88:91], v[56:59]
  v_xor_b32 v195, 96, v192
  v_add_u32 v196, 65536, v192
  v_mfma_f32_16x16x32_bf16 v[60:63], a[56:59], a[92:95], v[60:63]
  v_add_u32 v197, 65536, v193
  v_add_u32 v198, 65536, v194
  v_mfma_f32_16x16x32_bf16 v[64:67], a[56:59], a[96:99], v[64:67]
  v_add_u32 v199, 65536, v195
  v_add_u32 v200, 131072, v192
  v_mfma_f32_16x16x32_bf16 v[68:71], a[56:59], a[100:103], v[68:71]
  v_add_u32 v201, 131072, v193
  v_add_u32 v202, 131072, v194
  v_mfma_f32_16x16x32_bf16 v[72:75], a[60:63], a[80:83], v[72:75]
  v_mfma_f32_16x16x32_bf16 v[76:79], a[60:63], a[84:87], v[76:79]
  v_mfma_f32_16x16x32_bf16 v[80:83], a[60:63], a[88:91], v[80:83]
  v_mfma_f32_16x16x32_bf16 v[84:87], a[60:63], a[92:95], v[84:87]
  v_mfma_f32_16x16x32_bf16 v[88:91], a[60:63], a[96:99], v[88:91]
  v_mfma_f32_16x16x32_bf16 v[92:95], a[60:63], a[100:103], v[92:95]
  s_waitcnt lgkmcnt(0)
  s_waitcnt vmcnt(10)
  s_barrier
  v_mfma_f32_16x16x32_bf16 v[0:3], a[64:67], a[104:107], v[0:3]
  ds_read_b64_tr_b16 a[48:49], v236 offset:40960
  ds_read_b64_tr_b16 a[50:51], v236 offset:41984
  v_mfma_f32_16x16x32_bf16 v[4:7], a[64:67], a[108:111], v[4:7]
  s_add_u32 m0, s48, 81920
  s_lshl_b32 s51, s50, 12
  buffer_load_dwordx4 v218, s[16:19], s50 offen lds
  v_mfma_f32_16x16x32_bf16 v[8:11], a[64:67], a[112:115], v[8:11]
  ds_read_b128 a[80:83], v234 offset:40960
  ds_read_b128 a[84:87], v234 offset:43008
  v_mfma_f32_16x16x32_bf16 v[12:15], a[64:67], a[116:119], v[12:15]
  v_add_u32 v203, 131072, v195
  v_add_u32 v204, s75, v186
  v_mfma_f32_16x16x32_bf16 v[16:19], a[64:67], a[120:123], v[16:19]
  ds_read_b128 a[88:91], v234 offset:45056
  ds_read_b128 a[92:95], v234 offset:47104
  v_mfma_f32_16x16x32_bf16 v[20:23], a[64:67], a[124:127], v[20:23]
  buffer_load_dwordx4 v219, s[16:19], s50 offen offset:1024 lds
  v_mfma_f32_16x16x32_bf16 v[24:27], a[68:71], a[104:107], v[24:27]
  ds_read_b128 a[96:99], v234 offset:49152
  ds_read_b128 a[100:103], v234 offset:51200
  v_mfma_f32_16x16x32_bf16 v[28:31], a[68:71], a[108:111], v[28:31]
  v_xor_b32 v205, 131072, v204
  v_xor_b32 v206, 262144, v204
  v_mfma_f32_16x16x32_bf16 v[32:35], a[68:71], a[112:115], v[32:35]
  ds_read_b64_tr_b16 a[52:53], v237 offset:40960
  ds_read_b64_tr_b16 a[54:55], v237 offset:41984
  v_mfma_f32_16x16x32_bf16 v[36:39], a[68:71], a[116:119], v[36:39]
  buffer_load_dwordx4 v220, s[16:19], s50 offen offset:2048 lds
  v_mfma_f32_16x16x32_bf16 v[40:43], a[68:71], a[120:123], v[40:43]
  ds_read_b64_tr_b16 a[56:57], v238 offset:40960
  ds_read_b64_tr_b16 a[58:59], v238 offset:41984
  v_mfma_f32_16x16x32_bf16 v[44:47], a[68:71], a[124:127], v[44:47]
  v_xor_b32 v207, 393216, v204
  v_and_b32 v212, 31, v187
  v_mfma_f32_16x16x32_bf16 v[48:51], a[72:75], a[104:107], v[48:51]
  ds_read_b64_tr_b16 a[60:61], v239 offset:40960
  ds_read_b64_tr_b16 a[62:63], v239 offset:41984
  v_mfma_f32_16x16x32_bf16 v[52:55], a[72:75], a[108:111], v[52:55]
  buffer_load_dwordx4 v221, s[16:19], s50 offen offset:3072 lds
  v_mfma_f32_16x16x32_bf16 v[56:59], a[72:75], a[112:115], v[56:59]
  v_mul_u32_u24 v212, 1280, v212
  v_lshrrev_b32 v213, 5, v187
  v_mfma_f32_16x16x32_bf16 v[60:63], a[72:75], a[116:119], v[60:63]
  v_lshl_add_u32 v248, v213, 7, v212
  v_accvgpr_write_b32 a144, 0
  v_mfma_f32_16x16x32_bf16 v[64:67], a[72:75], a[120:123], v[64:67]
  v_accvgpr_write_b32 a145, 0
  v_accvgpr_write_b32 a146, 0
  v_mfma_f32_16x16x32_bf16 v[68:71], a[72:75], a[124:127], v[68:71]
  s_add_u32 m0, s48, 86016
  s_nop 0
  buffer_load_dwordx4 v222, s[16:19], s50 offen lds
  v_mfma_f32_16x16x32_bf16 v[72:75], a[76:79], a[104:107], v[72:75]
  v_accvgpr_write_b32 a147, 0
  v_accvgpr_write_b32 a148, 0
  v_mfma_f32_16x16x32_bf16 v[76:79], a[76:79], a[108:111], v[76:79]
  v_mfma_f32_16x16x32_bf16 v[80:83], a[76:79], a[112:115], v[80:83]
  v_mfma_f32_16x16x32_bf16 v[84:87], a[76:79], a[116:119], v[84:87]
  buffer_load_dwordx4 v223, s[16:19], s50 offen offset:1024 lds
  v_mfma_f32_16x16x32_bf16 v[88:91], a[76:79], a[120:123], v[88:91]
  v_mfma_f32_16x16x32_bf16 v[92:95], a[76:79], a[124:127], v[92:95]
  s_waitcnt lgkmcnt(6)
  v_mfma_f32_16x16x32_bf16 v[0:3], a[48:51], a[80:83], v[0:3]
  ds_read_b64_tr_b16 a[64:65], v236 offset:49152
  ds_read_b64_tr_b16 a[66:67], v236 offset:50176
  v_mfma_f32_16x16x32_bf16 v[4:7], a[48:51], a[84:87], v[4:7]
  s_add_u32 m0, s49, 81920
  s_add_u32 s50, s60, 0
  s_and_b32 s50, s50, 384
  s_add_u32 s50, s50, 768
  buffer_load_dwordx4 v224, s[20:23], s51 offen lds
  v_mfma_f32_16x16x32_bf16 v[8:11], a[48:51], a[88:91], v[8:11]
  ds_read_b128 a[104:107], v235 offset:40960
  ds_read_b128 a[108:111], v235 offset:43008
  v_mfma_f32_16x16x32_bf16 v[12:15], a[48:51], a[92:95], v[12:15]
  v_accvgpr_write_b32 a149, 0
  v_accvgpr_write_b32 a150, 0
  v_mfma_f32_16x16x32_bf16 v[16:19], a[48:51], a[96:99], v[16:19]
  ds_read_b128 a[112:115], v235 offset:45056
  ds_read_b128 a[116:119], v235 offset:47104
  v_mfma_f32_16x16x32_bf16 v[20:23], a[48:51], a[100:103], v[20:23]
  buffer_load_dwordx4 v225, s[20:23], s51 offen offset:1024 lds
  s_waitcnt lgkmcnt(6)
  v_mfma_f32_16x16x32_bf16 v[24:27], a[52:55], a[80:83], v[24:27]
  ds_read_b128 a[120:123], v235 offset:49152
  ds_read_b128 a[124:127], v235 offset:51200
  v_mfma_f32_16x16x32_bf16 v[28:31], a[52:55], a[84:87], v[28:31]
  v_accvgpr_write_b32 a151, 0
  v_accvgpr_write_b32 a152, 0
  v_mfma_f32_16x16x32_bf16 v[32:35], a[52:55], a[88:91], v[32:35]
  ds_read_b64_tr_b16 a[68:69], v237 offset:49152
  ds_read_b64_tr_b16 a[70:71], v237 offset:50176
  v_mfma_f32_16x16x32_bf16 v[36:39], a[52:55], a[92:95], v[36:39]
  buffer_load_dwordx4 v226, s[20:23], s51 offen offset:2048 lds
  v_mfma_f32_16x16x32_bf16 v[40:43], a[52:55], a[96:99], v[40:43]
  ds_read_b64_tr_b16 a[72:73], v238 offset:49152
  ds_read_b64_tr_b16 a[74:75], v238 offset:50176
  v_mfma_f32_16x16x32_bf16 v[44:47], a[52:55], a[100:103], v[44:47]
  v_accvgpr_write_b32 a153, 0
  v_accvgpr_write_b32 a154, 0
  v_mfma_f32_16x16x32_bf16 v[48:51], a[56:59], a[80:83], v[48:51]
  ds_read_b64_tr_b16 a[76:77], v239 offset:49152
  ds_read_b64_tr_b16 a[78:79], v239 offset:50176
  v_mfma_f32_16x16x32_bf16 v[52:55], a[56:59], a[84:87], v[52:55]
  buffer_load_dwordx4 v227, s[20:23], s51 offen offset:3072 lds
  v_mfma_f32_16x16x32_bf16 v[56:59], a[56:59], a[88:91], v[56:59]
  v_accvgpr_write_b32 a155, 0
  v_accvgpr_write_b32 a156, 0
  v_mfma_f32_16x16x32_bf16 v[60:63], a[56:59], a[92:95], v[60:63]
  v_accvgpr_write_b32 a157, 0
  v_accvgpr_write_b32 a158, 0
  v_mfma_f32_16x16x32_bf16 v[64:67], a[56:59], a[96:99], v[64:67]
  v_accvgpr_write_b32 a159, 0
  v_accvgpr_write_b32 a160, 0
  v_mfma_f32_16x16x32_bf16 v[68:71], a[56:59], a[100:103], v[68:71]
  v_accvgpr_write_b32 a161, 0
  v_accvgpr_write_b32 a162, 0
  v_mfma_f32_16x16x32_bf16 v[72:75], a[60:63], a[80:83], v[72:75]
  v_mfma_f32_16x16x32_bf16 v[76:79], a[60:63], a[84:87], v[76:79]
  v_mfma_f32_16x16x32_bf16 v[80:83], a[60:63], a[88:91], v[80:83]
  v_mfma_f32_16x16x32_bf16 v[84:87], a[60:63], a[92:95], v[84:87]
  v_mfma_f32_16x16x32_bf16 v[88:91], a[60:63], a[96:99], v[88:91]
  v_mfma_f32_16x16x32_bf16 v[92:95], a[60:63], a[100:103], v[92:95]
  s_waitcnt lgkmcnt(0)
  s_waitcnt vmcnt(10)
  s_barrier
  v_mfma_f32_16x16x32_bf16 v[0:3], a[64:67], a[104:107], v[0:3]
  ds_read_b64_tr_b16 a[48:49], v230
  ds_read_b64_tr_b16 a[50:51], v230 offset:1024
  v_mfma_f32_16x16x32_bf16 v[4:7], a[64:67], a[108:111], v[4:7]
  s_add_u32 m0, s48, 122880
  s_lshl_b32 s51, s50, 12
  buffer_load_dwordx4 v218, s[16:19], s50 offen lds
  v_mfma_f32_16x16x32_bf16 v[8:11], a[64:67], a[112:115], v[8:11]
  ds_read_b128 a[80:83], v228
  ds_read_b128 a[84:87], v228 offset:2048
  v_mfma_f32_16x16x32_bf16 v[12:15], a[64:67], a[116:119], v[12:15]
  v_accvgpr_write_b32 a163, 0
  v_accvgpr_write_b32 a164, 0
  v_mfma_f32_16x16x32_bf16 v[16:19], a[64:67], a[120:123], v[16:19]
  ds_read_b128 a[88:91], v228 offset:4096
  ds_read_b128 a[92:95], v228 offset:6144
  v_mfma_f32_16x16x32_bf16 v[20:23], a[64:67], a[124:127], v[20:23]
  buffer_load_dwordx4 v219, s[16:19], s50 offen offset:1024 lds
  v_mfma_f32_16x16x32_bf16 v[24:27], a[68:71], a[104:107], v[24:27]
  ds_read_b128 a[96:99], v228 offset:8192
  ds_read_b128 a[100:103], v228 offset:10240
  v_mfma_f32_16x16x32_bf16 v[28:31], a[68:71], a[108:111], v[28:31]
  v_accvgpr_write_b32 a165, 0
  v_accvgpr_write_b32 a166, 0
  v_mfma_f32_16x16x32_bf16 v[32:35], a[68:71], a[112:115], v[32:35]
  ds_read_b64_tr_b16 a[52:53], v231
  ds_read_b64_tr_b16 a[54:55], v231 offset:1024
  v_mfma_f32_16x16x32_bf16 v[36:39], a[68:71], a[116:119], v[36:39]
  buffer_load_dwordx4 v220, s[16:19], s50 offen offset:2048 lds
  v_mfma_f32_16x16x32_bf16 v[40:43], a[68:71], a[120:123], v[40:43]
  ds_read_b64_tr_b16 a[56:57], v232
  ds_read_b64_tr_b16 a[58:59], v232 offset:1024
  v_mfma_f32_16x16x32_bf16 v[44:47], a[68:71], a[124:127], v[44:47]
  v_accvgpr_write_b32 a167, 0
  v_accvgpr_write_b32 a168, 0
  v_mfma_f32_16x16x32_bf16 v[48:51], a[72:75], a[104:107], v[48:51]
  ds_read_b64_tr_b16 a[60:61], v233
  ds_read_b64_tr_b16 a[62:63], v233 offset:1024
  v_mfma_f32_16x16x32_bf16 v[52:55], a[72:75], a[108:111], v[52:55]
  buffer_load_dwordx4 v221, s[16:19], s50 offen offset:3072 lds
  v_mfma_f32_16x16x32_bf16 v[56:59], a[72:75], a[112:115], v[56:59]
  v_accvgpr_write_b32 a169, 0
  v_accvgpr_write_b32 a170, 0
  v_mfma_f32_16x16x32_bf16 v[60:63], a[72:75], a[116:119], v[60:63]
  v_accvgpr_write_b32 a171, 0
  v_accvgpr_write_b32 a172, 0
  v_mfma_f32_16x16x32_bf16 v[64:67], a[72:75], a[120:123], v[64:67]
  v_accvgpr_write_b32 a173, 0
  v_accvgpr_write_b32 a174, 0
  v_mfma_f32_16x16x32_bf16 v[68:71], a[72:75], a[124:127], v[68:71]
  s_add_u32 m0, s48, 126976
  s_nop 0
  buffer_load_dwordx4 v222, s[16:19], s50 offen lds
  v_mfma_f32_16x16x32_bf16 v[72:75], a[76:79], a[104:107], v[72:75]
  v_accvgpr_write_b32 a175, 0
  s_mov_b32 s58, 0x3e0293ee
  v_mfma_f32_16x16x32_bf16 v[76:79], a[76:79], a[108:111], v[76:79]
  v_mfma_f32_16x16x32_bf16 v[80:83], a[76:79], a[112:115], v[80:83]
  v_mfma_f32_16x16x32_bf16 v[84:87], a[76:79], a[116:119], v[84:87]
  buffer_load_dwordx4 v223, s[16:19], s50 offen offset:1024 lds
  v_mfma_f32_16x16x32_bf16 v[88:91], a[76:79], a[120:123], v[88:91]
  v_mfma_f32_16x16x32_bf16 v[92:95], a[76:79], a[124:127], v[92:95]
  s_waitcnt lgkmcnt(6)
  v_mfma_f32_16x16x32_bf16 v[0:3], a[48:51], a[80:83], v[0:3]
  ds_read_b64_tr_b16 a[64:65], v230 offset:8192
  ds_read_b64_tr_b16 a[66:67], v230 offset:9216
  v_mfma_f32_16x16x32_bf16 v[4:7], a[48:51], a[84:87], v[4:7]
  s_add_u32 m0, s49, 122880
  s_add_u32 s50, s60, 128
  s_and_b32 s50, s50, 384
  s_add_u32 s50, s50, 768
  buffer_load_dwordx4 v224, s[20:23], s51 offen lds
  v_mfma_f32_16x16x32_bf16 v[8:11], a[48:51], a[88:91], v[8:11]
  ds_read_b128 a[104:107], v229
  ds_read_b128 a[108:111], v229 offset:2048
  v_mfma_f32_16x16x32_bf16 v[12:15], a[48:51], a[92:95], v[12:15]
  v_mfma_f32_16x16x32_bf16 v[16:19], a[48:51], a[96:99], v[16:19]
  ds_read_b128 a[112:115], v229 offset:4096
  ds_read_b128 a[116:119], v229 offset:6144
  v_mfma_f32_16x16x32_bf16 v[20:23], a[48:51], a[100:103], v[20:23]
  buffer_load_dwordx4 v225, s[20:23], s51 offen offset:1024 lds
  s_waitcnt lgkmcnt(6)
  v_mfma_f32_16x16x32_bf16 v[24:27], a[52:55], a[80:83], v[24:27]
  ds_read_b128 a[120:123], v229 offset:8192
  ds_read_b128 a[124:127], v229 offset:10240
  v_mfma_f32_16x16x32_bf16 v[28:31], a[52:55], a[84:87], v[28:31]
  v_mfma_f32_16x16x32_bf16 v[32:35], a[52:55], a[88:91], v[32:35]
  ds_read_b64_tr_b16 a[68:69], v231 offset:8192
  ds_read_b64_tr_b16 a[70:71], v231 offset:9216
  v_mfma_f32_16x16x32_bf16 v[36:39], a[52:55], a[92:95], v[36:39]
  buffer_load_dwordx4 v226, s[20:23], s51 offen offset:2048 lds
  v_mfma_f32_16x16x32_bf16 v[40:43], a[52:55], a[96:99], v[40:43]
  ds_read_b64_tr_b16 a[72:73], v232 offset:8192
  ds_read_b64_tr_b16 a[74:75], v232 offset:9216
  v_mfma_f32_16x16x32_bf16 v[44:47], a[52:55], a[100:103], v[44:47]
  v_mfma_f32_16x16x32_bf16 v[48:51], a[56:59], a[80:83], v[48:51]
  ds_read_b64_tr_b16 a[76:77], v233 offset:8192
  ds_read_b64_tr_b16 a[78:79], v233 offset:9216
  v_mfma_f32_16x16x32_bf16 v[52:55], a[56:59], a[84:87], v[52:55]
  buffer_load_dwordx4 v227, s[20:23], s51 offen offset:3072 lds
  v_mfma_f32_16x16x32_bf16 v[56:59], a[56:59], a[88:91], v[56:59]
  v_mfma_f32_16x16x32_bf16 v[60:63], a[56:59], a[92:95], v[60:63]
  v_mfma_f32_16x16x32_bf16 v[64:67], a[56:59], a[96:99], v[64:67]
  v_mfma_f32_16x16x32_bf16 v[68:71], a[56:59], a[100:103], v[68:71]
  v_mfma_f32_16x16x32_bf16 v[72:75], a[60:63], a[80:83], v[72:75]
  v_mfma_f32_16x16x32_bf16 v[76:79], a[60:63], a[84:87], v[76:79]
  v_mfma_f32_16x16x32_bf16 v[80:83], a[60:63], a[88:91], v[80:83]
  v_mfma_f32_16x16x32_bf16 v[84:87], a[60:63], a[92:95], v[84:87]
  v_mfma_f32_16x16x32_bf16 v[88:91], a[60:63], a[96:99], v[88:91]
  v_mfma_f32_16x16x32_bf16 v[92:95], a[60:63], a[100:103], v[92:95]
  s_waitcnt lgkmcnt(0)
  s_waitcnt vmcnt(10)
  s_barrier
  v_mfma_f32_16x16x32_bf16 v[0:3], a[64:67], a[104:107], v[0:3]
  ds_read_b64_tr_b16 a[48:49], v236
  ds_read_b64_tr_b16 a[50:51], v236 offset:1024
  v_mfma_f32_16x16x32_bf16 v[4:7], a[64:67], a[108:111], v[4:7]
  s_add_u32 m0, s48, 0
  s_lshl_b32 s51, s50, 12
  buffer_load_dwordx4 v218, s[16:19], s50 offen lds
  v_mfma_f32_16x16x32_bf16 v[8:11], a[64:67], a[112:115], v[8:11]
  ds_read_b128 a[80:83], v234
  ds_read_b128 a[84:87], v234 offset:2048
  v_mfma_f32_16x16x32_bf16 v[12:15], a[64:67], a[116:119], v[12:15]
  v_mfma_f32_16x16x32_bf16 v[16:19], a[64:67], a[120:123], v[16:19]
  ds_read_b128 a[88:91], v234 offset:4096
  ds_read_b128 a[92:95], v234 offset:6144
  v_mfma_f32_16x16x32_bf16 v[20:23], a[64:67], a[124:127], v[20:23]
  buffer_load_dwordx4 v219, s[16:19], s50 offen offset:1024 lds
  v_mfma_f32_16x16x32_bf16 v[24:27], a[68:71], a[104:107], v[24:27]
  ds_read_b128 a[96:99], v234 offset:8192
  ds_read_b128 a[100:103], v234 offset:10240
  v_mfma_f32_16x16x32_bf16 v[28:31], a[68:71], a[108:111], v[28:31]
  v_mfma_f32_16x16x32_bf16 v[32:35], a[68:71], a[112:115], v[32:35]
  ds_read_b64_tr_b16 a[52:53], v237
  ds_read_b64_tr_b16 a[54:55], v237 offset:1024
  v_mfma_f32_16x16x32_bf16 v[36:39], a[68:71], a[116:119], v[36:39]
  buffer_load_dwordx4 v220, s[16:19], s50 offen offset:2048 lds
  v_mfma_f32_16x16x32_bf16 v[40:43], a[68:71], a[120:123], v[40:43]
  ds_read_b64_tr_b16 a[56:57], v238
  ds_read_b64_tr_b16 a[58:59], v238 offset:1024
  v_mfma_f32_16x16x32_bf16 v[44:47], a[68:71], a[124:127], v[44:47]
  v_mfma_f32_16x16x32_bf16 v[48:51], a[72:75], a[104:107], v[48:51]
  ds_read_b64_tr_b16 a[60:61], v239
  ds_read_b64_tr_b16 a[62:63], v239 offset:1024
  v_mfma_f32_16x16x32_bf16 v[52:55], a[72:75], a[108:111], v[52:55]
  buffer_load_dwordx4 v221, s[16:19], s50 offen offset:3072 lds
  v_mfma_f32_16x16x32_bf16 v[56:59], a[72:75], a[112:115], v[56:59]
  v_mfma_f32_16x16x32_bf16 v[60:63], a[72:75], a[116:119], v[60:63]
  v_mfma_f32_16x16x32_bf16 v[64:67], a[72:75], a[120:123], v[64:67]
  v_mfma_f32_16x16x32_bf16 v[68:71], a[72:75], a[124:127], v[68:71]
  s_add_u32 m0, s48, 4096
  s_nop 0
  buffer_load_dwordx4 v222, s[16:19], s50 offen lds
  v_mfma_f32_16x16x32_bf16 v[72:75], a[76:79], a[104:107], v[72:75]
  v_mfma_f32_16x16x32_bf16 v[76:79], a[76:79], a[108:111], v[76:79]
  v_mfma_f32_16x16x32_bf16 v[80:83], a[76:79], a[112:115], v[80:83]
  v_mfma_f32_16x16x32_bf16 v[84:87], a[76:79], a[116:119], v[84:87]
  buffer_load_dwordx4 v223, s[16:19], s50 offen offset:1024 lds
  v_mfma_f32_16x16x32_bf16 v[88:91], a[76:79], a[120:123], v[88:91]
  v_mfma_f32_16x16x32_bf16 v[92:95], a[76:79], a[124:127], v[92:95]
  s_waitcnt lgkmcnt(6)
  v_mfma_f32_16x16x32_bf16 v[0:3], a[48:51], a[80:83], v[0:3]
  ds_read_b64_tr_b16 a[64:65], v236 offset:8192
  ds_read_b64_tr_b16 a[66:67], v236 offset:9216
  v_mfma_f32_16x16x32_bf16 v[4:7], a[48:51], a[84:87], v[4:7]
  s_add_u32 m0, s49, 0
  s_add_u32 s50, s60, 256
  s_and_b32 s50, s50, 384
  s_add_u32 s50, s50, 768
  buffer_load_dwordx4 v224, s[20:23], s51 offen lds
  v_mfma_f32_16x16x32_bf16 v[8:11], a[48:51], a[88:91], v[8:11]
  ds_read_b128 a[104:107], v235
  ds_read_b128 a[108:111], v235 offset:2048
  v_mfma_f32_16x16x32_bf16 v[12:15], a[48:51], a[92:95], v[12:15]
  v_mfma_f32_16x16x32_bf16 v[16:19], a[48:51], a[96:99], v[16:19]
  ds_read_b128 a[112:115], v235 offset:4096
  ds_read_b128 a[116:119], v235 offset:6144
  v_mfma_f32_16x16x32_bf16 v[20:23], a[48:51], a[100:103], v[20:23]
  buffer_load_dwordx4 v225, s[20:23], s51 offen offset:1024 lds
  s_waitcnt lgkmcnt(6)
  v_mfma_f32_16x16x32_bf16 v[24:27], a[52:55], a[80:83], v[24:27]
  ds_read_b128 a[120:123], v235 offset:8192
  ds_read_b128 a[124:127], v235 offset:10240
  v_mfma_f32_16x16x32_bf16 v[28:31], a[52:55], a[84:87], v[28:31]
  v_mfma_f32_16x16x32_bf16 v[32:35], a[52:55], a[88:91], v[32:35]
  ds_read_b64_tr_b16 a[68:69], v237 offset:8192
  ds_read_b64_tr_b16 a[70:71], v237 offset:9216
  v_mfma_f32_16x16x32_bf16 v[36:39], a[52:55], a[92:95], v[36:39]
  buffer_load_dwordx4 v226, s[20:23], s51 offen offset:2048 lds
  v_mfma_f32_16x16x32_bf16 v[40:43], a[52:55], a[96:99], v[40:43]
  ds_read_b64_tr_b16 a[72:73], v238 offset:8192
  ds_read_b64_tr_b16 a[74:75], v238 offset:9216
  v_mfma_f32_16x16x32_bf16 v[44:47], a[52:55], a[100:103], v[44:47]
  v_mfma_f32_16x16x32_bf16 v[48:51], a[56:59], a[80:83], v[48:51]
  ds_read_b64_tr_b16 a[76:77], v239 offset:8192
  ds_read_b64_tr_b16 a[78:79], v239 offset:9216
  v_mfma_f32_16x16x32_bf16 v[52:55], a[56:59], a[84:87], v[52:55]
  buffer_load_dwordx4 v227, s[20:23], s51 offen offset:3072 lds
  v_mfma_f32_16x16x32_bf16 v[56:59], a[56:59], a[88:91], v[56:59]
  v_mfma_f32_16x16x32_bf16 v[60:63], a[56:59], a[92:95], v[60:63]
  v_mfma_f32_16x16x32_bf16 v[64:67], a[56:59], a[96:99], v[64:67]
  v_mfma_f32_16x16x32_bf16 v[68:71], a[56:59], a[100:103], v[68:71]
  v_mfma_f32_16x16x32_bf16 v[72:75], a[60:63], a[80:83], v[72:75]
  v_mfma_f32_16x16x32_bf16 v[76:79], a[60:63], a[84:87], v[76:79]
  v_mfma_f32_16x16x32_bf16 v[80:83], a[60:63], a[88:91], v[80:83]
  v_mfma_f32_16x16x32_bf16 v[84:87], a[60:63], a[92:95], v[84:87]
  v_mfma_f32_16x16x32_bf16 v[88:91], a[60:63], a[96:99], v[88:91]
  v_mfma_f32_16x16x32_bf16 v[92:95], a[60:63], a[100:103], v[92:95]
  s_waitcnt lgkmcnt(0)
  s_waitcnt vmcnt(10)
  s_barrier
  v_mfma_f32_16x16x32_bf16 v[0:3], a[64:67], a[104:107], v[0:3]
  ds_read_b64_tr_b16 a[48:49], v236 offset:40960
  ds_read_b64_tr_b16 a[50:51], v236 offset:41984
  v_mfma_f32_16x16x32_bf16 v[4:7], a[64:67], a[108:111], v[4:7]
  s_add_u32 m0, s48, 81920
  s_lshl_b32 s51, s50, 12
  buffer_load_dwordx4 v218, s[16:19], s50 offen lds
  v_mfma_f32_16x16x32_bf16 v[8:11], a[64:67], a[112:115], v[8:11]
  ds_read_b128 a[80:83], v234 offset:40960
  ds_read_b128 a[84:87], v234 offset:43008
  v_mfma_f32_16x16x32_bf16 v[12:15], a[64:67], a[116:119], v[12:15]
  v_mfma_f32_16x16x32_bf16 v[16:19], a[64:67], a[120:123], v[16:19]
  ds_read_b128 a[88:91], v234 offset:45056
  ds_read_b128 a[92:95], v234 offset:47104
  v_mfma_f32_16x16x32_bf16 v[20:23], a[64:67], a[124:127], v[20:23]
  buffer_load_dwordx4 v219, s[16:19], s50 offen offset:1024 lds
  v_mfma_f32_16x16x32_bf16 v[24:27], a[68:71], a[104:107], v[24:27]
  ds_read_b128 a[96:99], v234 offset:49152
  ds_read_b128 a[100:103], v234 offset:51200
  v_mfma_f32_16x16x32_bf16 v[28:31], a[68:71], a[108:111], v[28:31]
  v_mfma_f32_16x16x32_bf16 v[32:35], a[68:71], a[112:115], v[32:35]
  ds_read_b64_tr_b16 a[52:53], v237 offset:40960
  ds_read_b64_tr_b16 a[54:55], v237 offset:41984
  v_mfma_f32_16x16x32_bf16 v[36:39], a[68:71], a[116:119], v[36:39]
  buffer_load_dwordx4 v220, s[16:19], s50 offen offset:2048 lds
  v_mfma_f32_16x16x32_bf16 v[40:43], a[68:71], a[120:123], v[40:43]
  ds_read_b64_tr_b16 a[56:57], v238 offset:40960
  ds_read_b64_tr_b16 a[58:59], v238 offset:41984
  v_mfma_f32_16x16x32_bf16 v[44:47], a[68:71], a[124:127], v[44:47]
  v_mfma_f32_16x16x32_bf16 v[48:51], a[72:75], a[104:107], v[48:51]
  ds_read_b64_tr_b16 a[60:61], v239 offset:40960
  ds_read_b64_tr_b16 a[62:63], v239 offset:41984
  v_mfma_f32_16x16x32_bf16 v[52:55], a[72:75], a[108:111], v[52:55]
  buffer_load_dwordx4 v221, s[16:19], s50 offen offset:3072 lds
  v_mfma_f32_16x16x32_bf16 v[56:59], a[72:75], a[112:115], v[56:59]
  v_mfma_f32_16x16x32_bf16 v[60:63], a[72:75], a[116:119], v[60:63]
  v_mfma_f32_16x16x32_bf16 v[64:67], a[72:75], a[120:123], v[64:67]
  v_mfma_f32_16x16x32_bf16 v[68:71], a[72:75], a[124:127], v[68:71]
  s_add_u32 m0, s48, 86016
  s_nop 0
  buffer_load_dwordx4 v222, s[16:19], s50 offen lds
  v_mfma_f32_16x16x32_bf16 v[72:75], a[76:79], a[104:107], v[72:75]
  v_mfma_f32_16x16x32_bf16 v[76:79], a[76:79], a[108:111], v[76:79]
  v_mfma_f32_16x16x32_bf16 v[80:83], a[76:79], a[112:115], v[80:83]
  v_mfma_f32_16x16x32_bf16 v[84:87], a[76:79], a[116:119], v[84:87]
  buffer_load_dwordx4 v223, s[16:19], s50 offen offset:1024 lds
  v_mfma_f32_16x16x32_bf16 v[88:91], a[76:79], a[120:123], v[88:91]
  v_mfma_f32_16x16x32_bf16 v[92:95], a[76:79], a[124:127], v[92:95]
  s_waitcnt lgkmcnt(6)
  v_mfma_f32_16x16x32_bf16 v[0:3], a[48:51], a[80:83], v[0:3]
  ds_read_b64_tr_b16 a[64:65], v236 offset:49152
  ds_read_b64_tr_b16 a[66:67], v236 offset:50176
  v_mfma_f32_16x16x32_bf16 v[4:7], a[48:51], a[84:87], v[4:7]
  s_add_u32 m0, s49, 81920
  s_add_u32 s50, s60, 384
  s_and_b32 s50, s50, 384
  s_add_u32 s50, s50, 768
  buffer_load_dwordx4 v224, s[20:23], s51 offen lds
  v_mfma_f32_16x16x32_bf16 v[8:11], a[48:51], a[88:91], v[8:11]
  ds_read_b128 a[104:107], v235 offset:40960
  ds_read_b128 a[108:111], v235 offset:43008
  v_mfma_f32_16x16x32_bf16 v[12:15], a[48:51], a[92:95], v[12:15]
  v_mfma_f32_16x16x32_bf16 v[16:19], a[48:51], a[96:99], v[16:19]
  ds_read_b128 a[112:115], v235 offset:45056
  ds_read_b128 a[116:119], v235 offset:47104
  v_mfma_f32_16x16x32_bf16 v[20:23], a[48:51], a[100:103], v[20:23]
  buffer_load_dwordx4 v225, s[20:23], s51 offen offset:1024 lds
  s_waitcnt lgkmcnt(6)
  v_mfma_f32_16x16x32_bf16 v[24:27], a[52:55], a[80:83], v[24:27]
  ds_read_b128 a[120:123], v235 offset:49152
  ds_read_b128 a[124:127], v235 offset:51200
  v_mfma_f32_16x16x32_bf16 v[28:31], a[52:55], a[84:87], v[28:31]
  v_mfma_f32_16x16x32_bf16 v[32:35], a[52:55], a[88:91], v[32:35]
  ds_read_b64_tr_b16 a[68:69], v237 offset:49152
  ds_read_b64_tr_b16 a[70:71], v237 offset:50176
  v_mfma_f32_16x16x32_bf16 v[36:39], a[52:55], a[92:95], v[36:39]
  buffer_load_dwordx4 v226, s[20:23], s51 offen offset:2048 lds
  v_mfma_f32_16x16x32_bf16 v[40:43], a[52:55], a[96:99], v[40:43]
  ds_read_b64_tr_b16 a[72:73], v238 offset:49152
  ds_read_b64_tr_b16 a[74:75], v238 offset:50176
  v_mfma_f32_16x16x32_bf16 v[44:47], a[52:55], a[100:103], v[44:47]
  v_mfma_f32_16x16x32_bf16 v[48:51], a[56:59], a[80:83], v[48:51]
  ds_read_b64_tr_b16 a[76:77], v239 offset:49152
  ds_read_b64_tr_b16 a[78:79], v239 offset:50176
  v_mfma_f32_16x16x32_bf16 v[52:55], a[56:59], a[84:87], v[52:55]
  buffer_load_dwordx4 v227, s[20:23], s51 offen offset:3072 lds
  v_mfma_f32_16x16x32_bf16 v[56:59], a[56:59], a[88:91], v[56:59]
  v_mfma_f32_16x16x32_bf16 v[60:63], a[56:59], a[92:95], v[60:63]
  v_mfma_f32_16x16x32_bf16 v[64:67], a[56:59], a[96:99], v[64:67]
  v_mfma_f32_16x16x32_bf16 v[68:71], a[56:59], a[100:103], v[68:71]
  v_mfma_f32_16x16x32_bf16 v[72:75], a[60:63], a[80:83], v[72:75]
  v_mfma_f32_16x16x32_bf16 v[76:79], a[60:63], a[84:87], v[76:79]
  v_mfma_f32_16x16x32_bf16 v[80:83], a[60:63], a[88:91], v[80:83]
  v_mfma_f32_16x16x32_bf16 v[84:87], a[60:63], a[92:95], v[84:87]
  v_mfma_f32_16x16x32_bf16 v[88:91], a[60:63], a[96:99], v[88:91]
  v_mfma_f32_16x16x32_bf16 v[92:95], a[60:63], a[100:103], v[92:95]
  s_waitcnt lgkmcnt(0)
  s_waitcnt vmcnt(10)
  s_barrier
  v_mfma_f32_16x16x32_bf16 v[0:3], a[64:67], a[104:107], v[0:3]
  ds_read_b64_tr_b16 a[48:49], v230
  ds_read_b64_tr_b16 a[50:51], v230 offset:1024
  v_mfma_f32_16x16x32_bf16 v[4:7], a[64:67], a[108:111], v[4:7]
  s_add_u32 m0, s48, 122880
  s_lshl_b32 s51, s50, 12
  buffer_load_dwordx4 v218, s[16:19], s50 offen lds
  v_mfma_f32_16x16x32_bf16 v[8:11], a[64:67], a[112:115], v[8:11]
  ds_read_b128 a[80:83], v228
  ds_read_b128 a[84:87], v228 offset:2048
  v_mfma_f32_16x16x32_bf16 v[12:15], a[64:67], a[116:119], v[12:15]
  v_mfma_f32_16x16x32_bf16 v[16:19], a[64:67], a[120:123], v[16:19]
  ds_read_b128 a[88:91], v228 offset:4096
  ds_read_b128 a[92:95], v228 offset:6144
  v_mfma_f32_16x16x32_bf16 v[20:23], a[64:67], a[124:127], v[20:23]
  buffer_load_dwordx4 v219, s[16:19], s50 offen offset:1024 lds
  v_mfma_f32_16x16x32_bf16 v[24:27], a[68:71], a[104:107], v[24:27]
  ds_read_b128 a[96:99], v228 offset:8192
  ds_read_b128 a[100:103], v228 offset:10240
  v_mfma_f32_16x16x32_bf16 v[28:31], a[68:71], a[108:111], v[28:31]
  v_mfma_f32_16x16x32_bf16 v[32:35], a[68:71], a[112:115], v[32:35]
  ds_read_b64_tr_b16 a[52:53], v231
  ds_read_b64_tr_b16 a[54:55], v231 offset:1024
  v_mfma_f32_16x16x32_bf16 v[36:39], a[68:71], a[116:119], v[36:39]
  buffer_load_dwordx4 v220, s[16:19], s50 offen offset:2048 lds
  v_mfma_f32_16x16x32_bf16 v[40:43], a[68:71], a[120:123], v[40:43]
  ds_read_b64_tr_b16 a[56:57], v232
  ds_read_b64_tr_b16 a[58:59], v232 offset:1024
  v_mfma_f32_16x16x32_bf16 v[44:47], a[68:71], a[124:127], v[44:47]
  v_mfma_f32_16x16x32_bf16 v[48:51], a[72:75], a[104:107], v[48:51]
  ds_read_b64_tr_b16 a[60:61], v233
  ds_read_b64_tr_b16 a[62:63], v233 offset:1024
  v_mfma_f32_16x16x32_bf16 v[52:55], a[72:75], a[108:111], v[52:55]
  buffer_load_dwordx4 v221, s[16:19], s50 offen offset:3072 lds
  v_mfma_f32_16x16x32_bf16 v[56:59], a[72:75], a[112:115], v[56:59]
  v_mfma_f32_16x16x32_bf16 v[60:63], a[72:75], a[116:119], v[60:63]
  v_mfma_f32_16x16x32_bf16 v[64:67], a[72:75], a[120:123], v[64:67]
  v_mfma_f32_16x16x32_bf16 v[68:71], a[72:75], a[124:127], v[68:71]
  s_add_u32 m0, s48, 126976
  s_nop 0
  buffer_load_dwordx4 v222, s[16:19], s50 offen lds
  v_mfma_f32_16x16x32_bf16 v[72:75], a[76:79], a[104:107], v[72:75]
  v_mfma_f32_16x16x32_bf16 v[76:79], a[76:79], a[108:111], v[76:79]
  v_mfma_f32_16x16x32_bf16 v[80:83], a[76:79], a[112:115], v[80:83]
  v_mfma_f32_16x16x32_bf16 v[84:87], a[76:79], a[116:119], v[84:87]
  buffer_load_dwordx4 v223, s[16:19], s50 offen offset:1024 lds
  v_mfma_f32_16x16x32_bf16 v[88:91], a[76:79], a[120:123], v[88:91]
  v_mfma_f32_16x16x32_bf16 v[92:95], a[76:79], a[124:127], v[92:95]
  s_waitcnt lgkmcnt(6)
  v_mfma_f32_16x16x32_bf16 v[0:3], a[48:51], a[80:83], v[0:3]
  ds_read_b64_tr_b16 a[64:65], v230 offset:8192
  ds_read_b64_tr_b16 a[66:67], v230 offset:9216
  v_mfma_f32_16x16x32_bf16 v[4:7], a[48:51], a[84:87], v[4:7]
  s_add_u32 m0, s49, 122880
  s_add_u32 s50, s60, 0
  s_and_b32 s50, s50, 384
  s_add_u32 s50, s50, 1280
  buffer_load_dwordx4 v224, s[20:23], s51 offen lds
  v_mfma_f32_16x16x32_bf16 v[8:11], a[48:51], a[88:91], v[8:11]
  ds_read_b128 a[104:107], v229
  ds_read_b128 a[108:111], v229 offset:2048
  v_mfma_f32_16x16x32_bf16 v[12:15], a[48:51], a[92:95], v[12:15]
  buffer_load_dwordx4 v225, s[20:23], s51 offen offset:1024 lds
  v_mfma_f32_16x16x32_bf16 v[16:19], a[48:51], a[96:99], v[16:19]
  ds_read_b128 a[112:115], v229 offset:4096
  ds_read_b128 a[116:119], v229 offset:6144
  v_mfma_f32_16x16x32_bf16 v[20:23], a[48:51], a[100:103], v[20:23]
  buffer_load_dwordx4 v226, s[20:23], s51 offen offset:2048 lds
  s_waitcnt lgkmcnt(6)
  v_mfma_f32_16x16x32_bf16 v[24:27], a[52:55], a[80:83], v[24:27]
  ds_read_b128 a[120:123], v229 offset:8192
  ds_read_b128 a[124:127], v229 offset:10240
  v_mfma_f32_16x16x32_bf16 v[28:31], a[52:55], a[84:87], v[28:31]
  buffer_load_dwordx4 v227, s[20:23], s51 offen offset:3072 lds
  v_mfma_f32_16x16x32_bf16 v[32:35], a[52:55], a[88:91], v[32:35]
  ds_read_b64_tr_b16 a[68:69], v231 offset:8192
  ds_read_b64_tr_b16 a[70:71], v231 offset:9216
  v_mfma_f32_16x16x32_bf16 v[36:39], a[52:55], a[92:95], v[36:39]
  s_add_u32 m0, s45, 49152
  s_nop 0
  buffer_load_dwordx4 v184, s[24:27], s41 offen nt lds
  v_mfma_f32_16x16x32_bf16 v[40:43], a[52:55], a[96:99], v[40:43]
  ds_read_b64_tr_b16 a[72:73], v232 offset:8192
  ds_read_b64_tr_b16 a[74:75], v232 offset:9216
  v_mfma_f32_16x16x32_bf16 v[44:47], a[52:55], a[100:103], v[44:47]
  buffer_load_dwordx4 v184, s[24:27], s41 offen offset:1024 nt lds
  v_mfma_f32_16x16x32_bf16 v[48:51], a[56:59], a[80:83], v[48:51]
  ds_read_b64_tr_b16 a[76:77], v233 offset:8192
  ds_read_b64_tr_b16 a[78:79], v233 offset:9216
  v_mfma_f32_16x16x32_bf16 v[52:55], a[56:59], a[84:87], v[52:55]
  buffer_load_dwordx4 v184, s[24:27], s41 offen offset:2048 nt lds
  v_mfma_f32_16x16x32_bf16 v[56:59], a[56:59], a[88:91], v[56:59]
  v_mfma_f32_16x16x32_bf16 v[60:63], a[56:59], a[92:95], v[60:63]
  buffer_load_dwordx4 v184, s[24:27], s41 offen offset:3072 nt lds
  v_mfma_f32_16x16x32_bf16 v[64:67], a[56:59], a[96:99], v[64:67]
  v_mfma_f32_16x16x32_bf16 v[68:71], a[56:59], a[100:103], v[68:71]
  v_mfma_f32_16x16x32_bf16 v[72:75], a[60:63], a[80:83], v[72:75]
  v_mfma_f32_16x16x32_bf16 v[76:79], a[60:63], a[84:87], v[76:79]
  v_mfma_f32_16x16x32_bf16 v[80:83], a[60:63], a[88:91], v[80:83]
  v_mfma_f32_16x16x32_bf16 v[84:87], a[60:63], a[92:95], v[84:87]
  v_mfma_f32_16x16x32_bf16 v[88:91], a[60:63], a[96:99], v[88:91]
  v_mfma_f32_16x16x32_bf16 v[92:95], a[60:63], a[100:103], v[92:95]
  s_add_u32 s41, s41, 16384
  s_waitcnt lgkmcnt(0)
  s_waitcnt vmcnt(14)
  s_barrier
  v_mfma_f32_16x16x32_bf16 v[0:3], a[64:67], a[104:107], v[0:3]
  ds_read_b64_tr_b16 a[48:49], v236
  ds_read_b64_tr_b16 a[50:51], v236 offset:1024
  v_mfma_f32_16x16x32_bf16 v[4:7], a[64:67], a[108:111], v[4:7]
  s_add_u32 m0, s45, 65536
  s_nop 0
  buffer_load_dwordx4 v185, s[28:31], s42 offen nt lds
  v_mfma_f32_16x16x32_bf16 v[8:11], a[64:67], a[112:115], v[8:11]
  ds_read_b128 a[80:83], v234
  ds_read_b128 a[84:87], v234 offset:2048
  v_mfma_f32_16x16x32_bf16 v[12:15], a[64:67], a[116:119], v[12:15]
  v_mfma_f32_16x16x32_bf16 v[16:19], a[64:67], a[120:123], v[16:19]
  ds_read_b128 a[88:91], v234 offset:4096
  ds_read_b128 a[92:95], v234 offset:6144
  v_mfma_f32_16x16x32_bf16 v[20:23], a[64:67], a[124:127], v[20:23]
  buffer_load_dwordx4 v185, s[28:31], s42 offen offset:1024 nt lds
  v_mfma_f32_16x16x32_bf16 v[24:27], a[68:71], a[104:107], v[24:27]
  ds_read_b128 a[96:99], v234 offset:8192
  ds_read_b128 a[100:103], v234 offset:10240
  v_mfma_f32_16x16x32_bf16 v[28:31], a[68:71], a[108:111], v[28:31]
  v_mfma_f32_16x16x32_bf16 v[32:35], a[68:71], a[112:115], v[32:35]
  ds_read_b64_tr_b16 a[52:53], v237
  ds_read_b64_tr_b16 a[54:55], v237 offset:1024
  v_mfma_f32_16x16x32_bf16 v[36:39], a[68:71], a[116:119], v[36:39]
  buffer_load_dwordx4 v185, s[28:31], s42 offen offset:2048 nt lds
  v_mfma_f32_16x16x32_bf16 v[40:43], a[68:71], a[120:123], v[40:43]
  ds_read_b64_tr_b16 a[56:57], v238
  ds_read_b64_tr_b16 a[58:59], v238 offset:1024
  v_mfma_f32_16x16x32_bf16 v[44:47], a[68:71], a[124:127], v[44:47]
  v_mfma_f32_16x16x32_bf16 v[48:51], a[72:75], a[104:107], v[48:51]
  ds_read_b64_tr_b16 a[60:61], v239
  ds_read_b64_tr_b16 a[62:63], v239 offset:1024
  v_mfma_f32_16x16x32_bf16 v[52:55], a[72:75], a[108:111], v[52:55]
  buffer_load_dwordx4 v185, s[28:31], s42 offen offset:3072 nt lds
  v_mfma_f32_16x16x32_bf16 v[56:59], a[72:75], a[112:115], v[56:59]
  v_mfma_f32_16x16x32_bf16 v[60:63], a[72:75], a[116:119], v[60:63]
  v_mfma_f32_16x16x32_bf16 v[64:67], a[72:75], a[120:123], v[64:67]
  v_mfma_f32_16x16x32_bf16 v[68:71], a[72:75], a[124:127], v[68:71]
  v_mfma_f32_16x16x32_bf16 v[72:75], a[76:79], a[104:107], v[72:75]
  v_mfma_f32_16x16x32_bf16 v[76:79], a[76:79], a[108:111], v[76:79]
  v_mfma_f32_16x16x32_bf16 v[80:83], a[76:79], a[112:115], v[80:83]
  v_mfma_f32_16x16x32_bf16 v[84:87], a[76:79], a[116:119], v[84:87]
  v_mfma_f32_16x16x32_bf16 v[88:91], a[76:79], a[120:123], v[88:91]
  v_mfma_f32_16x16x32_bf16 v[92:95], a[76:79], a[124:127], v[92:95]
  s_add_u32 s42, s42, 16384
  s_waitcnt lgkmcnt(6)
  v_mfma_f32_16x16x32_bf16 v[0:3], a[48:51], a[80:83], v[0:3]
  ds_read_b64_tr_b16 a[64:65], v236 offset:8192
  ds_read_b64_tr_b16 a[66:67], v236 offset:9216
  v_mfma_f32_16x16x32_bf16 v[4:7], a[48:51], a[84:87], v[4:7]
  s_add_u32 m0, s45, 32768
  s_nop 0
  buffer_load_dwordx4 v184, s[24:27], s41 offen nt lds
  v_mfma_f32_16x16x32_bf16 v[8:11], a[48:51], a[88:91], v[8:11]
  ds_read_b128 a[104:107], v235
  ds_read_b128 a[108:111], v235 offset:2048
  v_mfma_f32_16x16x32_bf16 v[12:15], a[48:51], a[92:95], v[12:15]
  v_mfma_f32_16x16x32_bf16 v[16:19], a[48:51], a[96:99], v[16:19]
  ds_read_b128 a[112:115], v235 offset:4096
  ds_read_b128 a[116:119], v235 offset:6144
  v_mfma_f32_16x16x32_bf16 v[20:23], a[48:51], a[100:103], v[20:23]
  buffer_load_dwordx4 v184, s[24:27], s41 offen offset:1024 nt lds
  s_waitcnt lgkmcnt(6)
  v_mfma_f32_16x16x32_bf16 v[24:27], a[52:55], a[80:83], v[24:27]
  ds_read_b128 a[120:123], v235 offset:8192
  ds_read_b128 a[124:127], v235 offset:10240
  v_mfma_f32_16x16x32_bf16 v[28:31], a[52:55], a[84:87], v[28:31]
  v_mfma_f32_16x16x32_bf16 v[32:35], a[52:55], a[88:91], v[32:35]
  ds_read_b64_tr_b16 a[68:69], v237 offset:8192
  ds_read_b64_tr_b16 a[70:71], v237 offset:9216
  v_mfma_f32_16x16x32_bf16 v[36:39], a[52:55], a[92:95], v[36:39]
  buffer_load_dwordx4 v184, s[24:27], s41 offen offset:2048 nt lds
  v_mfma_f32_16x16x32_bf16 v[40:43], a[52:55], a[96:99], v[40:43]
  ds_read_b64_tr_b16 a[72:73], v238 offset:8192
  ds_read_b64_tr_b16 a[74:75], v238 offset:9216
  v_mfma_f32_16x16x32_bf16 v[44:47], a[52:55], a[100:103], v[44:47]
  v_mfma_f32_16x16x32_bf16 v[48:51], a[56:59], a[80:83], v[48:51]
  ds_read_b64_tr_b16 a[76:77], v239 offset:8192
  ds_read_b64_tr_b16 a[78:79], v239 offset:9216
  v_mfma_f32_16x16x32_bf16 v[52:55], a[56:59], a[84:87], v[52:55]
  buffer_load_dwordx4 v184, s[24:27], s41 offen offset:3072 nt lds
  v_mfma_f32_16x16x32_bf16 v[56:59], a[56:59], a[88:91], v[56:59]
  v_mfma_f32_16x16x32_bf16 v[60:63], a[56:59], a[92:95], v[60:63]
  v_mfma_f32_16x16x32_bf16 v[64:67], a[56:59], a[96:99], v[64:67]
  v_mfma_f32_16x16x32_bf16 v[68:71], a[56:59], a[100:103], v[68:71]
  v_mfma_f32_16x16x32_bf16 v[72:75], a[60:63], a[80:83], v[72:75]
  v_mfma_f32_16x16x32_bf16 v[76:79], a[60:63], a[84:87], v[76:79]
  v_mfma_f32_16x16x32_bf16 v[80:83], a[60:63], a[88:91], v[80:83]
  v_mfma_f32_16x16x32_bf16 v[84:87], a[60:63], a[92:95], v[84:87]
  v_mfma_f32_16x16x32_bf16 v[88:91], a[60:63], a[96:99], v[88:91]
  v_mfma_f32_16x16x32_bf16 v[92:95], a[60:63], a[100:103], v[92:95]
  s_add_u32 s41, s41, 16384
  s_waitcnt lgkmcnt(0)
  s_waitcnt vmcnt(12)
  s_barrier
  v_mfma_f32_16x16x32_bf16 v[0:3], a[64:67], a[104:107], v[0:3]
  ds_read_b64_tr_b16 a[48:49], v236 offset:40960
  ds_read_b64_tr_b16 a[50:51], v236 offset:41984
  v_mfma_f32_16x16x32_bf16 v[4:7], a[64:67], a[108:111], v[4:7]
  s_add_u32 m0, s45, 81920
  s_nop 0
  buffer_load_dwordx4 v185, s[28:31], s42 offen nt lds
  v_mfma_f32_16x16x32_bf16 v[8:11], a[64:67], a[112:115], v[8:11]
  ds_read_b128 a[80:83], v234 offset:40960
  ds_read_b128 a[84:87], v234 offset:43008
  v_mfma_f32_16x16x32_bf16 v[12:15], a[64:67], a[116:119], v[12:15]
  v_mfma_f32_16x16x32_bf16 v[16:19], a[64:67], a[120:123], v[16:19]
  ds_read_b128 a[88:91], v234 offset:45056
  ds_read_b128 a[92:95], v234 offset:47104
  v_mfma_f32_16x16x32_bf16 v[20:23], a[64:67], a[124:127], v[20:23]
  buffer_load_dwordx4 v185, s[28:31], s42 offen offset:1024 nt lds
  v_mfma_f32_16x16x32_bf16 v[24:27], a[68:71], a[104:107], v[24:27]
  ds_read_b128 a[96:99], v234 offset:49152
  ds_read_b128 a[100:103], v234 offset:51200
  v_mfma_f32_16x16x32_bf16 v[28:31], a[68:71], a[108:111], v[28:31]
  v_mfma_f32_16x16x32_bf16 v[32:35], a[68:71], a[112:115], v[32:35]
  ds_read_b64_tr_b16 a[52:53], v237 offset:40960
  ds_read_b64_tr_b16 a[54:55], v237 offset:41984
  v_mfma_f32_16x16x32_bf16 v[36:39], a[68:71], a[116:119], v[36:39]
  buffer_load_dwordx4 v185, s[28:31], s42 offen offset:2048 nt lds
  v_mfma_f32_16x16x32_bf16 v[40:43], a[68:71], a[120:123], v[40:43]
  ds_read_b64_tr_b16 a[56:57], v238 offset:40960
  ds_read_b64_tr_b16 a[58:59], v238 offset:41984
  v_mfma_f32_16x16x32_bf16 v[44:47], a[68:71], a[124:127], v[44:47]
  v_mfma_f32_16x16x32_bf16 v[48:51], a[72:75], a[104:107], v[48:51]
  ds_read_b64_tr_b16 a[60:61], v239 offset:40960
  ds_read_b64_tr_b16 a[62:63], v239 offset:41984
  v_mfma_f32_16x16x32_bf16 v[52:55], a[72:75], a[108:111], v[52:55]
  buffer_load_dwordx4 v185, s[28:31], s42 offen offset:3072 nt lds
  v_mfma_f32_16x16x32_bf16 v[56:59], a[72:75], a[112:115], v[56:59]
  v_mfma_f32_16x16x32_bf16 v[60:63], a[72:75], a[116:119], v[60:63]
  v_mfma_f32_16x16x32_bf16 v[64:67], a[72:75], a[120:123], v[64:67]
  v_mfma_f32_16x16x32_bf16 v[68:71], a[72:75], a[124:127], v[68:71]
  v_mfma_f32_16x16x32_bf16 v[72:75], a[76:79], a[104:107], v[72:75]
  v_mfma_f32_16x16x32_bf16 v[76:79], a[76:79], a[108:111], v[76:79]
  v_mfma_f32_16x16x32_bf16 v[80:83], a[76:79], a[112:115], v[80:83]
  v_mfma_f32_16x16x32_bf16 v[84:87], a[76:79], a[116:119], v[84:87]
  v_mfma_f32_16x16x32_bf16 v[88:91], a[76:79], a[120:123], v[88:91]
  v_mfma_f32_16x16x32_bf16 v[92:95], a[76:79], a[124:127], v[92:95]
  s_add_u32 s42, s42, 16384
  s_waitcnt lgkmcnt(6)
  v_mfma_f32_16x16x32_bf16 v[0:3], a[48:51], a[80:83], v[0:3]
  ds_read_b64_tr_b16 a[64:65], v236 offset:49152
  ds_read_b64_tr_b16 a[66:67], v236 offset:50176
  v_mfma_f32_16x16x32_bf16 v[4:7], a[48:51], a[84:87], v[4:7]
  v_mfma_f32_16x16x32_bf16 v[8:11], a[48:51], a[88:91], v[8:11]
  ds_read_b128 a[104:107], v235 offset:40960
  ds_read_b128 a[108:111], v235 offset:43008
  v_mfma_f32_16x16x32_bf16 v[12:15], a[48:51], a[92:95], v[12:15]
  v_mfma_f32_16x16x32_bf16 v[16:19], a[48:51], a[96:99], v[16:19]
  ds_read_b128 a[112:115], v235 offset:45056
  ds_read_b128 a[116:119], v235 offset:47104
  v_mfma_f32_16x16x32_bf16 v[20:23], a[48:51], a[100:103], v[20:23]
  s_waitcnt lgkmcnt(6)
  v_mfma_f32_16x16x32_bf16 v[24:27], a[52:55], a[80:83], v[24:27]
  ds_read_b128 a[120:123], v235 offset:49152
  ds_read_b128 a[124:127], v235 offset:51200
  v_mfma_f32_16x16x32_bf16 v[28:31], a[52:55], a[84:87], v[28:31]
  v_mfma_f32_16x16x32_bf16 v[32:35], a[52:55], a[88:91], v[32:35]
  ds_read_b64_tr_b16 a[68:69], v237 offset:49152
  ds_read_b64_tr_b16 a[70:71], v237 offset:50176
  v_mfma_f32_16x16x32_bf16 v[36:39], a[52:55], a[92:95], v[36:39]
  v_mfma_f32_16x16x32_bf16 v[40:43], a[52:55], a[96:99], v[40:43]
  ds_read_b64_tr_b16 a[72:73], v238 offset:49152
  ds_read_b64_tr_b16 a[74:75], v238 offset:50176
  v_mfma_f32_16x16x32_bf16 v[44:47], a[52:55], a[100:103], v[44:47]
  v_mfma_f32_16x16x32_bf16 v[48:51], a[56:59], a[80:83], v[48:51]
  ds_read_b64_tr_b16 a[76:77], v239 offset:49152
  ds_read_b64_tr_b16 a[78:79], v239 offset:50176
  v_mfma_f32_16x16x32_bf16 v[52:55], a[56:59], a[84:87], v[52:55]
  v_mfma_f32_16x16x32_bf16 v[56:59], a[56:59], a[88:91], v[56:59]
  v_mfma_f32_16x16x32_bf16 v[60:63], a[56:59], a[92:95], v[60:63]
  v_mfma_f32_16x16x32_bf16 v[64:67], a[56:59], a[96:99], v[64:67]
  v_mfma_f32_16x16x32_bf16 v[68:71], a[56:59], a[100:103], v[68:71]
  v_mfma_f32_16x16x32_bf16 v[72:75], a[60:63], a[80:83], v[72:75]
  v_mfma_f32_16x16x32_bf16 v[76:79], a[60:63], a[84:87], v[76:79]
  v_mfma_f32_16x16x32_bf16 v[80:83], a[60:63], a[88:91], v[80:83]
  v_mfma_f32_16x16x32_bf16 v[84:87], a[60:63], a[92:95], v[84:87]
  v_mfma_f32_16x16x32_bf16 v[88:91], a[60:63], a[96:99], v[88:91]
  v_mfma_f32_16x16x32_bf16 v[92:95], a[60:63], a[100:103], v[92:95]
  s_waitcnt lgkmcnt(0)
  s_barrier
  v_mfma_f32_16x16x32_bf16 v[0:3], a[64:67], a[104:107], v[0:3]
  v_mfma_f32_16x16x32_bf16 v[4:7], a[64:67], a[108:111], v[4:7]
  v_mfma_f32_16x16x32_bf16 v[8:11], a[64:67], a[112:115], v[8:11]
  v_mfma_f32_16x16x32_bf16 v[12:15], a[64:67], a[116:119], v[12:15]
  v_mfma_f32_16x16x32_bf16 v[16:19], a[64:67], a[120:123], v[16:19]
  v_mfma_f32_16x16x32_bf16 v[20:23], a[64:67], a[124:127], v[20:23]
  v_mfma_f32_16x16x32_bf16 v[24:27], a[68:71], a[104:107], v[24:27]
  v_mfma_f32_16x16x32_bf16 v[28:31], a[68:71], a[108:111], v[28:31]
  v_mfma_f32_16x16x32_bf16 v[32:35], a[68:71], a[112:115], v[32:35]
  v_pk_mul_f32 v[0:1], v[0:1], s[58:59] op_sel_hi:[1,0]
  v_pk_mul_f32 v[2:3], v[2:3], s[58:59] op_sel_hi:[1,0]
  v_cvt_pk_bf16_f32 v0, v0, v1
  v_mfma_f32_16x16x32_bf16 v[36:39], a[68:71], a[116:119], v[36:39]
  v_cvt_pk_bf16_f32 v1, v2, v3
  ds_write_b64 v244, v[0:1]
  v_mfma_f32_16x16x32_bf16 v[40:43], a[68:71], a[120:123], v[40:43]
  v_pk_mul_f32 v[4:5], v[4:5], s[58:59] op_sel_hi:[1,0]
  v_pk_mul_f32 v[6:7], v[6:7], s[58:59] op_sel_hi:[1,0]
  v_cvt_pk_bf16_f32 v4, v4, v5
  v_mfma_f32_16x16x32_bf16 v[44:47], a[68:71], a[124:127], v[44:47]
  v_cvt_pk_bf16_f32 v5, v6, v7
  ds_write_b64 v244, v[4:5] offset:4096
  v_mfma_f32_16x16x32_bf16 v[48:51], a[72:75], a[104:107], v[48:51]
  v_pk_mul_f32 v[8:9], v[8:9], s[58:59] op_sel_hi:[1,0]
  v_pk_mul_f32 v[10:11], v[10:11], s[58:59] op_sel_hi:[1,0]
  v_cvt_pk_bf16_f32 v8, v8, v9
  v_mfma_f32_16x16x32_bf16 v[52:55], a[72:75], a[108:111], v[52:55]
  v_cvt_pk_bf16_f32 v9, v10, v11
  ds_write_b64 v244, v[8:9] offset:8192
  v_mfma_f32_16x16x32_bf16 v[56:59], a[72:75], a[112:115], v[56:59]
  v_pk_mul_f32 v[12:13], v[12:13], s[58:59] op_sel_hi:[1,0]
  v_pk_mul_f32 v[14:15], v[14:15], s[58:59] op_sel_hi:[1,0]
  v_cvt_pk_bf16_f32 v12, v12, v13
  v_mfma_f32_16x16x32_bf16 v[60:63], a[72:75], a[116:119], v[60:63]
  v_cvt_pk_bf16_f32 v13, v14, v15
  ds_write_b64 v244, v[12:13] offset:12288
  v_mfma_f32_16x16x32_bf16 v[64:67], a[72:75], a[120:123], v[64:67]
  v_pk_mul_f32 v[16:17], v[16:17], s[58:59] op_sel_hi:[1,0]
  v_pk_mul_f32 v[18:19], v[18:19], s[58:59] op_sel_hi:[1,0]
  v_cvt_pk_bf16_f32 v16, v16, v17
  v_mfma_f32_16x16x32_bf16 v[68:71], a[72:75], a[124:127], v[68:71]
  v_cvt_pk_bf16_f32 v17, v18, v19
  ds_write_b64 v244, v[16:17] offset:16384
  v_mfma_f32_16x16x32_bf16 v[72:75], a[76:79], a[104:107], v[72:75]
  v_pk_mul_f32 v[20:21], v[20:21], s[58:59] op_sel_hi:[1,0]
  v_pk_mul_f32 v[22:23], v[22:23], s[58:59] op_sel_hi:[1,0]
  v_cvt_pk_bf16_f32 v20, v20, v21
  v_mfma_f32_16x16x32_bf16 v[76:79], a[76:79], a[108:111], v[76:79]
  v_cvt_pk_bf16_f32 v21, v22, v23
  ds_write_b64 v244, v[20:21] offset:20480
  v_mfma_f32_16x16x32_bf16 v[80:83], a[76:79], a[112:115], v[80:83]
  v_pk_mul_f32 v[24:25], v[24:25], s[58:59] op_sel_hi:[1,0]
  v_pk_mul_f32 v[26:27], v[26:27], s[58:59] op_sel_hi:[1,0]
  v_cvt_pk_bf16_f32 v24, v24, v25
  v_mfma_f32_16x16x32_bf16 v[84:87], a[76:79], a[116:119], v[84:87]
  v_cvt_pk_bf16_f32 v25, v26, v27
  ds_write_b64 v245, v[24:25]
  v_mfma_f32_16x16x32_bf16 v[88:91], a[76:79], a[120:123], v[88:91]
  v_pk_mul_f32 v[28:29], v[28:29], s[58:59] op_sel_hi:[1,0]
  v_pk_mul_f32 v[30:31], v[30:31], s[58:59] op_sel_hi:[1,0]
  v_cvt_pk_bf16_f32 v28, v28, v29
  v_mfma_f32_16x16x32_bf16 v[92:95], a[76:79], a[124:127], v[92:95]
  v_cvt_pk_bf16_f32 v29, v30, v31
  ds_write_b64 v245, v[28:29] offset:4096
  v_pk_mul_f32 v[32:33], v[32:33], s[58:59] op_sel_hi:[1,0]
  v_pk_mul_f32 v[34:35], v[34:35], s[58:59] op_sel_hi:[1,0]
  v_cvt_pk_bf16_f32 v32, v32, v33
  v_cvt_pk_bf16_f32 v33, v34, v35
  ds_write_b64 v245, v[32:33] offset:8192
  v_pk_mul_f32 v[36:37], v[36:37], s[58:59] op_sel_hi:[1,0]
  v_pk_mul_f32 v[38:39], v[38:39], s[58:59] op_sel_hi:[1,0]
  v_cvt_pk_bf16_f32 v36, v36, v37
  v_cvt_pk_bf16_f32 v37, v38, v39
  ds_write_b64 v245, v[36:37] offset:12288
  v_pk_mul_f32 v[40:41], v[40:41], s[58:59] op_sel_hi:[1,0]
  v_pk_mul_f32 v[42:43], v[42:43], s[58:59] op_sel_hi:[1,0]
  v_cvt_pk_bf16_f32 v40, v40, v41
  v_cvt_pk_bf16_f32 v41, v42, v43
  ds_write_b64 v245, v[40:41] offset:16384
  v_pk_mul_f32 v[44:45], v[44:45], s[58:59] op_sel_hi:[1,0]
  v_pk_mul_f32 v[46:47], v[46:47], s[58:59] op_sel_hi:[1,0]
  v_cvt_pk_bf16_f32 v44, v44, v45
  v_cvt_pk_bf16_f32 v45, v46, v47
  ds_write_b64 v245, v[44:45] offset:20480
  v_pk_mul_f32 v[48:49], v[48:49], s[58:59] op_sel_hi:[1,0]
  v_pk_mul_f32 v[50:51], v[50:51], s[58:59] op_sel_hi:[1,0]
  v_cvt_pk_bf16_f32 v48, v48, v49
  v_cvt_pk_bf16_f32 v49, v50, v51
  ds_write_b64 v246, v[48:49]
  v_pk_mul_f32 v[52:53], v[52:53], s[58:59] op_sel_hi:[1,0]
  v_pk_mul_f32 v[54:55], v[54:55], s[58:59] op_sel_hi:[1,0]
  v_cvt_pk_bf16_f32 v52, v52, v53
  v_cvt_pk_bf16_f32 v53, v54, v55
  ds_write_b64 v246, v[52:53] offset:4096
  v_pk_mul_f32 v[56:57], v[56:57], s[58:59] op_sel_hi:[1,0]
  v_pk_mul_f32 v[58:59], v[58:59], s[58:59] op_sel_hi:[1,0]
  v_cvt_pk_bf16_f32 v56, v56, v57
  v_cvt_pk_bf16_f32 v57, v58, v59
  ds_write_b64 v246, v[56:57] offset:8192
  v_pk_mul_f32 v[60:61], v[60:61], s[58:59] op_sel_hi:[1,0]
  v_pk_mul_f32 v[62:63], v[62:63], s[58:59] op_sel_hi:[1,0]
  v_cvt_pk_bf16_f32 v60, v60, v61
  v_cvt_pk_bf16_f32 v61, v62, v63
  ds_write_b64 v246, v[60:61] offset:12288
  v_pk_mul_f32 v[64:65], v[64:65], s[58:59] op_sel_hi:[1,0]
  v_pk_mul_f32 v[66:67], v[66:67], s[58:59] op_sel_hi:[1,0]
  v_cvt_pk_bf16_f32 v64, v64, v65
  v_cvt_pk_bf16_f32 v65, v66, v67
  ds_write_b64 v246, v[64:65] offset:16384
  v_pk_mul_f32 v[68:69], v[68:69], s[58:59] op_sel_hi:[1,0]
  v_pk_mul_f32 v[70:71], v[70:71], s[58:59] op_sel_hi:[1,0]
  v_cvt_pk_bf16_f32 v68, v68, v69
  v_cvt_pk_bf16_f32 v69, v70, v71
  ds_write_b64 v246, v[68:69] offset:20480
  v_pk_mul_f32 v[72:73], v[72:73], s[58:59] op_sel_hi:[1,0]
  v_pk_mul_f32 v[74:75], v[74:75], s[58:59] op_sel_hi:[1,0]
  v_cvt_pk_bf16_f32 v72, v72, v73
  v_cvt_pk_bf16_f32 v73, v74, v75
  ds_write_b64 v247, v[72:73]
  v_pk_mul_f32 v[76:77], v[76:77], s[58:59] op_sel_hi:[1,0]
  v_pk_mul_f32 v[78:79], v[78:79], s[58:59] op_sel_hi:[1,0]
  v_cvt_pk_bf16_f32 v76, v76, v77
  v_cvt_pk_bf16_f32 v77, v78, v79
  ds_write_b64 v247, v[76:77] offset:4096
  v_pk_mul_f32 v[80:81], v[80:81], s[58:59] op_sel_hi:[1,0]
  v_pk_mul_f32 v[82:83], v[82:83], s[58:59] op_sel_hi:[1,0]
  v_cvt_pk_bf16_f32 v80, v80, v81
  v_cvt_pk_bf16_f32 v81, v82, v83
  ds_write_b64 v247, v[80:81] offset:8192
  v_pk_mul_f32 v[84:85], v[84:85], s[58:59] op_sel_hi:[1,0]
  v_pk_mul_f32 v[86:87], v[86:87], s[58:59] op_sel_hi:[1,0]
  v_cvt_pk_bf16_f32 v84, v84, v85
  v_cvt_pk_bf16_f32 v85, v86, v87
  ds_write_b64 v247, v[84:85] offset:12288
  v_pk_mul_f32 v[88:89], v[88:89], s[58:59] op_sel_hi:[1,0]
  v_pk_mul_f32 v[90:91], v[90:91], s[58:59] op_sel_hi:[1,0]
  v_cvt_pk_bf16_f32 v88, v88, v89
  v_cvt_pk_bf16_f32 v89, v90, v91
  ds_write_b64 v247, v[88:89] offset:16384
  v_pk_mul_f32 v[92:93], v[92:93], s[58:59] op_sel_hi:[1,0]
  v_pk_mul_f32 v[94:95], v[94:95], s[58:59] op_sel_hi:[1,0]
  v_cvt_pk_bf16_f32 v92, v92, v93
  v_cvt_pk_bf16_f32 v93, v94, v95
  ds_write_b64 v247, v[92:93] offset:20480
  s_waitcnt lgkmcnt(0)
  s_waitcnt vmcnt(12)
  s_barrier
  ds_read_b128 a[48:51], v172 offset:49152
  ds_read_b128 a[52:55], v173 offset:49152
  ds_read_b128 a[56:59], v174 offset:49152
  ds_read_b128 a[60:63], v175 offset:49152
  ds_read_b128 a[0:3], v240
  ds_read_b128 a[4:7], v241
  ds_read_b128 a[8:11], v242
  ds_read_b128 a[12:15], v243
  ds_read_b128 a[16:19], v240 offset:4096
  ds_read_b128 a[20:23], v241 offset:4096
  ds_read_b128 a[24:27], v242 offset:4096
  ds_read_b128 a[28:31], v243 offset:4096
  ds_read_b128 a[32:35], v240 offset:8192
  ds_read_b128 a[36:39], v241 offset:8192
  ds_read_b128 a[40:43], v242 offset:8192
  ds_read_b128 a[44:47], v243 offset:8192
  ds_read_b128 a[64:67], v172 offset:50176
  ds_read_b128 a[68:71], v173 offset:50176
  ds_read_b128 a[72:75], v174 offset:50176
  ds_read_b128 a[76:79], v175 offset:50176
  s_mov_b32 s20, s86
  s_and_b32 s21, s87, 0xffff
  s_mov_b32 s22, 0x1e0000
  s_mov_b32 s23, 0x20000
  v_mov_b64 v[0:1], 0
  v_mov_b64 v[2:3], 0
  v_mov_b64 v[4:5], 0
  v_mov_b64 v[6:7], 0
  v_mov_b64 v[8:9], 0
  v_mov_b64 v[10:11], 0
  v_mov_b64 v[12:13], 0
  v_mov_b64 v[14:15], 0
  v_mov_b64 v[16:17], 0
  v_mov_b64 v[18:19], 0
  v_mov_b64 v[20:21], 0
  v_mov_b64 v[22:23], 0
  v_mov_b64 v[24:25], 0
  v_mov_b64 v[26:27], 0
  v_mov_b64 v[28:29], 0
  v_mov_b64 v[30:31], 0
  v_mov_b64 v[32:33], 0
  v_mov_b64 v[34:35], 0
  v_mov_b64 v[36:37], 0
  v_mov_b64 v[38:39], 0
  v_mov_b64 v[40:41], 0
  v_mov_b64 v[42:43], 0
  v_mov_b64 v[44:45], 0
  v_mov_b64 v[46:47], 0
  s_cmp_lg_u32 s44, 0
  s_cbranch_scc1 K1_safego
  s_waitcnt lgkmcnt(15)
  v_mfma_f32_16x16x32_bf16 v[96:99], a[48:51], a[0:3], 0
  v_mov_b64 v[48:49], 0
  v_mov_b64 v[50:51], 0
  s_waitcnt lgkmcnt(14)
  v_mfma_f32_16x16x32_bf16 v[96:99], a[52:55], a[4:7], v[96:99]
  v_mov_b64 v[52:53], 0
  v_mov_b64 v[54:55], 0
  s_waitcnt lgkmcnt(13)
  v_mfma_f32_16x16x32_bf16 v[96:99], a[56:59], a[8:11], v[96:99]
  v_mov_b64 v[56:57], 0
  v_mov_b64 v[58:59], 0
  s_waitcnt lgkmcnt(12)
  v_mfma_f32_16x16x32_bf16 v[96:99], a[60:63], a[12:15], v[96:99]
  v_mov_b64 v[60:61], 0
  v_mov_b64 v[62:63], 0
  s_waitcnt lgkmcnt(11)
  v_mfma_f32_16x16x32_bf16 v[104:107], a[48:51], a[16:19], 0
  v_mov_b64 v[64:65], 0
  v_mov_b64 v[66:67], 0
  s_waitcnt lgkmcnt(10)
  v_mfma_f32_16x16x32_bf16 v[104:107], a[52:55], a[20:23], v[104:107]
  v_mov_b64 v[68:69], 0
  v_mov_b64 v[70:71], 0
  s_waitcnt lgkmcnt(9)
  v_mfma_f32_16x16x32_bf16 v[104:107], a[56:59], a[24:27], v[104:107]
  v_mov_b64 v[72:73], 0
  v_mov_b64 v[74:75], 0
  s_waitcnt lgkmcnt(8)
  v_mfma_f32_16x16x32_bf16 v[104:107], a[60:63], a[28:31], v[104:107]
  v_mov_b64 v[76:77], 0
  v_mov_b64 v[78:79], 0
  s_waitcnt lgkmcnt(7)
  v_mfma_f32_16x16x32_bf16 v[112:115], a[48:51], a[32:35], 0
  v_mov_b64 v[80:81], 0
  v_mov_b64 v[82:83], 0
  s_waitcnt lgkmcnt(6)
  v_mfma_f32_16x16x32_bf16 v[112:115], a[52:55], a[36:39], v[112:115]
  v_mov_b64 v[84:85], 0
  v_mov_b64 v[86:87], 0
  s_waitcnt lgkmcnt(5)
  v_mfma_f32_16x16x32_bf16 v[112:115], a[56:59], a[40:43], v[112:115]
  v_mov_b64 v[88:89], 0
  v_mov_b64 v[90:91], 0
  s_waitcnt lgkmcnt(4)
  v_mfma_f32_16x16x32_bf16 v[112:115], a[60:63], a[44:47], v[112:115]
  v_mov_b64 v[92:93], 0
  v_mov_b64 v[94:95], 0
  v_max3_f32 v208, v96, v97, v98
  v_max3_f32 v209, v104, v105, v106
  s_nop 3
  v_max3_f32 v210, v112, v113, v114
  v_max_f32 v208, v208, v99
  v_max_f32 v209, v209, v107
  v_max_f32 v210, v210, v115
  v_mov_b32 v214, v208
  v_mov_b32 v215, v209
  v_mov_b32 v216, v210
  v_permlane16_swap_b32 v214, v208
  v_permlane16_swap_b32 v215, v209
  v_permlane16_swap_b32 v216, v210
  v_max_f32 v208, v208, v214
  v_max_f32 v209, v209, v215
  v_max_f32 v210, v210, v216
  v_mov_b32 v214, v208
  v_mov_b32 v215, v209
  v_mov_b32 v216, v210
  v_permlane32_swap_b32 v214, v208
  v_permlane32_swap_b32 v215, v209
  v_permlane32_swap_b32 v216, v210
  v_max_f32 v208, v208, v214
  v_max_f32 v209, v209, v215
  v_max_f32 v210, v210, v216
  v_sub_f32 v144, 0, v208
  v_sub_f32 v148, 0, v209
  v_sub_f32 v152, 0, v210
  v_sub_f32 v145, 0, v208
  v_sub_f32 v149, 0, v209
  v_sub_f32 v153, 0, v210
  v_sub_f32 v146, 0, v208
  v_sub_f32 v150, 0, v209
  v_sub_f32 v154, 0, v210
  v_sub_f32 v147, 0, v208
  v_sub_f32 v151, 0, v209
  v_sub_f32 v155, 0, v210
  s_mov_b32 s43, 7
  v_mov_b32 v128, 0
  v_mov_b32 v129, 0
  v_mov_b32 v130, 0
  v_mov_b32 v131, 0
  v_mov_b32 v132, 0
  v_mov_b32 v133, 0
  v_mov_b32 v134, 0
  v_mov_b32 v135, 0
  v_mov_b32 v136, 0
  v_mov_b32 v137, 0
  v_mov_b32 v138, 0
  v_mov_b32 v139, 0
  v_mov_b32 v140, 0
  v_mov_b32 v141, 0xff800000
  v_mov_b32 v142, 0xff800000
  v_mov_b32 v143, 0xff800000
  s_waitcnt lgkmcnt(0)
  s_nop 1
.p2align 6

.p2align 6
K1_loop:
  s_waitcnt lgkmcnt(0)
  v_mfma_f32_16x16x32_bf16 v[96:99], a[48:51], a[0:3], v[144:147]
  v_cvt_pk_bf16_f32 v136, v136, v137
  v_cvt_pk_bf16_f32 v137, v138, v139
  v_mfma_f32_16x16x32_bf16 v[96:99], a[52:55], a[4:7], v[96:99]
  v_exp_f32 v141, v141
  v_mfma_f32_16x16x32_bf16 v[96:99], a[56:59], a[8:11], v[96:99]
  v_exp_f32 v142, v142
  v_mfma_f32_16x16x32_bf16 v[96:99], a[60:63], a[12:15], v[96:99]
  v_exp_f32 v143, v143
  v_mfma_f32_16x16x32_bf16 v[100:103], a[64:67], a[0:3], v[144:147]
  s_waitcnt vmcnt(4) lgkmcnt(0)
  s_barrier
  v_mfma_f32_16x16x32_bf16 v[100:103], a[68:71], a[4:7], v[100:103]
  v_cvt_pk_bf16_f32 v138, v140, v141
  v_cvt_pk_bf16_f32 v139, v142, v143
  v_mfma_f32_16x16x32_bf16 v[100:103], a[72:75], a[8:11], v[100:103]
  ds_read_b64_tr_b16 a[112:113], v176
  ds_read_b64_tr_b16 a[114:115], v176 offset:1024
  v_mfma_f32_16x16x32_bf16 v[100:103], a[76:79], a[12:15], v[100:103]
  v_mfma_f32_16x16x32_bf16 v[32:35], a[144:147], v[128:131], v[32:35]
  v_mfma_f32_16x16x32_bf16 v[36:39], a[148:151], v[128:131], v[36:39]
  ds_read_b64_tr_b16 a[116:117], v177
  ds_read_b64_tr_b16 a[118:119], v177 offset:1024
  v_mfma_f32_16x16x32_bf16 v[40:43], a[152:155], v[128:131], v[40:43]
  v_mfma_f32_16x16x32_bf16 v[44:47], a[156:159], v[128:131], v[44:47]
  v_mfma_f32_16x16x32_bf16 v[48:51], a[160:163], v[128:131], v[48:51]
  ds_read_b64_tr_b16 a[120:121], v178
  ds_read_b64_tr_b16 a[122:123], v178 offset:1024
  v_mfma_f32_16x16x32_bf16 v[52:55], a[164:167], v[128:131], v[52:55]
  v_exp_f32 v96, v96
  v_mfma_f32_16x16x32_bf16 v[56:59], a[168:171], v[128:131], v[56:59]
  v_exp_f32 v97, v97
  v_mfma_f32_16x16x32_bf16 v[60:63], a[172:175], v[128:131], v[60:63]
  ds_read_b64_tr_b16 a[124:125], v179
  ds_read_b64_tr_b16 a[126:127], v179 offset:1024
  v_mfma_f32_16x16x32_bf16 v[156:159], v[164:167], v[128:131], v[156:159]
  v_exp_f32 v98, v98
  v_mfma_f32_16x16x32_bf16 v[104:107], a[48:51], a[16:19], v[148:151]
  v_exp_f32 v99, v99
  v_mfma_f32_16x16x32_bf16 v[104:107], a[52:55], a[20:23], v[104:107]
  ds_read_b64_tr_b16 a[128:129], v180
  ds_read_b128 a[80:83], v172 offset:51200
  v_mfma_f32_16x16x32_bf16 v[104:107], a[56:59], a[24:27], v[104:107]
  v_exp_f32 v100, v100
  v_mfma_f32_16x16x32_bf16 v[104:107], a[60:63], a[28:31], v[104:107]
  v_cvt_pk_bf16_f32 v96, v96, v97
  v_cvt_pk_bf16_f32 v97, v98, v99
  v_mfma_f32_16x16x32_bf16 v[108:111], a[64:67], a[16:19], v[148:151]
  ds_read_b64_tr_b16 a[130:131], v180 offset:1024
  ds_read_b128 a[84:87], v173 offset:51200
  v_mfma_f32_16x16x32_bf16 v[108:111], a[68:71], a[20:23], v[108:111]
  v_exp_f32 v101, v101
  v_mfma_f32_16x16x32_bf16 v[108:111], a[72:75], a[24:27], v[108:111]
  v_exp_f32 v102, v102
  v_mfma_f32_16x16x32_bf16 v[108:111], a[76:79], a[28:31], v[108:111]
  ds_read_b64_tr_b16 a[132:133], v181
  ds_read_b128 a[88:91], v174 offset:51200
  v_mfma_f32_16x16x32_bf16 v[64:67], a[144:147], v[136:139], v[64:67]
  v_exp_f32 v103, v103
  v_mfma_f32_16x16x32_bf16 v[68:71], a[148:151], v[136:139], v[68:71]
  v_cvt_pk_bf16_f32 v98, v100, v101
  v_cvt_pk_bf16_f32 v99, v102, v103
  v_mfma_f32_16x16x32_bf16 v[72:75], a[152:155], v[136:139], v[72:75]
  ds_read_b64_tr_b16 a[134:135], v181 offset:1024
  ds_read_b128 a[92:95], v175 offset:51200
  v_mfma_f32_16x16x32_bf16 v[76:79], a[156:159], v[136:139], v[76:79]
  v_mfma_f32_16x16x32_bf16 v[80:83], a[160:163], v[136:139], v[80:83]
  v_exp_f32 v104, v104
  v_mfma_f32_16x16x32_bf16 v[84:87], a[164:167], v[136:139], v[84:87]
  ds_read_b64_tr_b16 a[136:137], v182
  ds_read_b128 a[96:99], v172 offset:52224
  v_mfma_f32_16x16x32_bf16 v[88:91], a[168:171], v[136:139], v[88:91]
  v_exp_f32 v105, v105
  v_mfma_f32_16x16x32_bf16 v[92:95], a[172:175], v[136:139], v[92:95]
  v_exp_f32 v106, v106
  v_mfma_f32_16x16x32_bf16 v[156:159], v[168:171], v[136:139], v[156:159]
  ds_read_b64_tr_b16 a[138:139], v182 offset:1024
  ds_read_b128 a[100:103], v173 offset:52224
  v_mfma_f32_16x16x32_bf16 v[112:115], a[48:51], a[32:35], v[152:155]
  v_exp_f32 v107, v107
  v_mfma_f32_16x16x32_bf16 v[112:115], a[52:55], a[36:39], v[112:115]
  v_exp_f32 v108, v108
  v_mfma_f32_16x16x32_bf16 v[112:115], a[56:59], a[40:43], v[112:115]
  ds_read_b64_tr_b16 a[140:141], v183
  ds_read_b128 a[104:107], v174 offset:52224
  v_mfma_f32_16x16x32_bf16 v[112:115], a[60:63], a[44:47], v[112:115]
  v_cvt_pk_bf16_f32 v104, v104, v105
  v_cvt_pk_bf16_f32 v105, v106, v107
  v_mfma_f32_16x16x32_bf16 v[116:119], a[64:67], a[32:35], v[152:155]
  v_exp_f32 v109, v109
  v_mfma_f32_16x16x32_bf16 v[116:119], a[68:71], a[36:39], v[116:119]
  ds_read_b64_tr_b16 a[142:143], v183 offset:1024
  ds_read_b128 a[108:111], v175 offset:52224
  v_mfma_f32_16x16x32_bf16 v[116:119], a[72:75], a[40:43], v[116:119]
  v_exp_f32 v110, v110
  v_mfma_f32_16x16x32_bf16 v[116:119], a[76:79], a[44:47], v[116:119]
  v_exp_f32 v111, v111
  s_waitcnt lgkmcnt(15)
  v_mfma_f32_16x16x32_bf16 v[0:3], a[112:115], v[96:99], v[0:3]
  v_cvt_pk_bf16_f32 v106, v108, v109
  v_cvt_pk_bf16_f32 v107, v110, v111
  v_mfma_f32_16x16x32_bf16 v[4:7], a[116:119], v[96:99], v[4:7]
  v_mfma_f32_16x16x32_bf16 v[8:11], a[120:123], v[96:99], v[8:11]
  v_mfma_f32_16x16x32_bf16 v[12:15], a[124:127], v[96:99], v[12:15]
  s_waitcnt lgkmcnt(0)
  v_mfma_f32_16x16x32_bf16 v[16:19], a[128:131], v[96:99], v[16:19]
  s_add_u32 m0, s45, 16384
  v_exp_f32 v112, v112
  v_mfma_f32_16x16x32_bf16 v[20:23], a[132:135], v[96:99], v[20:23]
  buffer_load_dwordx4 v184, s[24:27], s41 offen nt lds
  v_mfma_f32_16x16x32_bf16 v[24:27], a[136:139], v[96:99], v[24:27]
  v_exp_f32 v113, v113
  v_mfma_f32_16x16x32_bf16 v[28:31], a[140:143], v[96:99], v[28:31]
  v_exp_f32 v114, v114
  v_mfma_f32_16x16x32_bf16 v[156:159], v[160:163], v[96:99], v[156:159]
  buffer_load_dwordx4 v184, s[24:27], s41 offen offset:1024 nt lds
  ds_read_b64_tr_b16 a[144:145], v176 offset:2048
  ds_read_b64_tr_b16 a[146:147], v176 offset:3072
  v_mfma_f32_16x16x32_bf16 v[120:123], a[80:83], a[0:3], v[144:147]
  v_exp_f32 v115, v115
  v_mfma_f32_16x16x32_bf16 v[120:123], a[84:87], a[4:7], v[120:123]
  v_exp_f32 v116, v116
  v_mfma_f32_16x16x32_bf16 v[120:123], a[88:91], a[8:11], v[120:123]
  buffer_load_dwordx4 v184, s[24:27], s41 offen offset:2048 nt lds
  ds_read_b64_tr_b16 a[148:149], v177 offset:2048
  ds_read_b64_tr_b16 a[150:151], v177 offset:3072
  v_mfma_f32_16x16x32_bf16 v[120:123], a[92:95], a[12:15], v[120:123]
  v_cvt_pk_bf16_f32 v112, v112, v113
  v_cvt_pk_bf16_f32 v113, v114, v115
  v_mfma_f32_16x16x32_bf16 v[124:127], a[96:99], a[0:3], v[144:147]
  v_exp_f32 v117, v117
  v_mfma_f32_16x16x32_bf16 v[124:127], a[100:103], a[4:7], v[124:127]
  buffer_load_dwordx4 v184, s[24:27], s41 offen offset:3072 nt lds
  v_mfma_f32_16x16x32_bf16 v[124:127], a[104:107], a[8:11], v[124:127]
  s_add_u32 s41, s41, 16384
  ds_read_b64_tr_b16 a[152:153], v178 offset:2048
  ds_read_b64_tr_b16 a[154:155], v178 offset:3072
  v_mfma_f32_16x16x32_bf16 v[124:127], a[108:111], a[12:15], v[124:127]
  s_add_u32 m0, s45, 98304
  v_exp_f32 v118, v118
  v_mfma_f32_16x16x32_bf16 v[32:35], a[112:115], v[104:107], v[32:35]
  buffer_load_dwordx4 v185, s[28:31], s42 offen nt lds
  v_mfma_f32_16x16x32_bf16 v[36:39], a[116:119], v[104:107], v[36:39]
  ds_read_b64_tr_b16 a[156:157], v179 offset:2048
  ds_read_b64_tr_b16 a[158:159], v179 offset:3072
  v_mfma_f32_16x16x32_bf16 v[40:43], a[120:123], v[104:107], v[40:43]
  v_exp_f32 v119, v119
  v_mfma_f32_16x16x32_bf16 v[44:47], a[124:127], v[104:107], v[44:47]
  buffer_load_dwordx4 v185, s[28:31], s42 offen offset:1024 nt lds
  v_mfma_f32_16x16x32_bf16 v[48:51], a[128:131], v[104:107], v[48:51]
  v_cvt_pk_bf16_f32 v114, v116, v117
  v_cvt_pk_bf16_f32 v115, v118, v119
  v_mfma_f32_16x16x32_bf16 v[52:55], a[132:135], v[104:107], v[52:55]
  ds_read_b64_tr_b16 a[160:161], v180 offset:2048
  ds_read_b128 a[48:51], v172 offset:32768
  v_mfma_f32_16x16x32_bf16 v[56:59], a[136:139], v[104:107], v[56:59]
  buffer_load_dwordx4 v185, s[28:31], s42 offen offset:2048 nt lds
  v_mfma_f32_16x16x32_bf16 v[60:63], a[140:143], v[104:107], v[60:63]
  v_exp_f32 v120, v120
  v_mfma_f32_16x16x32_bf16 v[156:159], v[164:167], v[104:107], v[156:159]
  ds_read_b64_tr_b16 a[162:163], v180 offset:3072
  ds_read_b128 a[52:55], v173 offset:32768
  v_mfma_f32_16x16x32_bf16 v[128:131], a[80:83], a[16:19], v[148:151]
  buffer_load_dwordx4 v185, s[28:31], s42 offen offset:3072 nt lds
  v_mfma_f32_16x16x32_bf16 v[128:131], a[84:87], a[20:23], v[128:131]
  s_add_u32 s42, s42, 16384
  v_exp_f32 v121, v121
  v_mfma_f32_16x16x32_bf16 v[128:131], a[88:91], a[24:27], v[128:131]
  v_exp_f32 v122, v122
  v_mfma_f32_16x16x32_bf16 v[128:131], a[92:95], a[28:31], v[128:131]
  ds_read_b64_tr_b16 a[164:165], v181 offset:2048
  ds_read_b128 a[56:59], v174 offset:32768
  v_mfma_f32_16x16x32_bf16 v[132:135], a[96:99], a[16:19], v[148:151]
  v_exp_f32 v123, v123
  v_mfma_f32_16x16x32_bf16 v[132:135], a[100:103], a[20:23], v[132:135]
  v_exp_f32 v124, v124
  v_mfma_f32_16x16x32_bf16 v[132:135], a[104:107], a[24:27], v[132:135]
  ds_read_b64_tr_b16 a[166:167], v181 offset:3072
  ds_read_b128 a[60:63], v175 offset:32768
  v_mfma_f32_16x16x32_bf16 v[132:135], a[108:111], a[28:31], v[132:135]
  v_cvt_pk_bf16_f32 v120, v120, v121
  v_cvt_pk_bf16_f32 v121, v122, v123
  v_mfma_f32_16x16x32_bf16 v[64:67], a[112:115], v[112:115], v[64:67]
  v_exp_f32 v125, v125
  v_mfma_f32_16x16x32_bf16 v[68:71], a[116:119], v[112:115], v[68:71]
  v_exp_f32 v126, v126
  v_mfma_f32_16x16x32_bf16 v[72:75], a[120:123], v[112:115], v[72:75]
  ds_read_b64_tr_b16 a[168:169], v182 offset:2048
  ds_read_b128 a[64:67], v172 offset:33792
  v_mfma_f32_16x16x32_bf16 v[76:79], a[124:127], v[112:115], v[76:79]
  v_exp_f32 v127, v127
  v_mfma_f32_16x16x32_bf16 v[80:83], a[128:131], v[112:115], v[80:83]
  v_cvt_pk_bf16_f32 v122, v124, v125
  v_cvt_pk_bf16_f32 v123, v126, v127
  v_mfma_f32_16x16x32_bf16 v[84:87], a[132:135], v[112:115], v[84:87]
  ds_read_b64_tr_b16 a[170:171], v182 offset:3072
  ds_read_b128 a[68:71], v173 offset:33792
  v_mfma_f32_16x16x32_bf16 v[88:91], a[136:139], v[112:115], v[88:91]
  v_exp_f32 v128, v128
  v_mfma_f32_16x16x32_bf16 v[92:95], a[140:143], v[112:115], v[92:95]
  v_exp_f32 v129, v129
  v_mfma_f32_16x16x32_bf16 v[156:159], v[168:171], v[112:115], v[156:159]
  v_exp_f32 v130, v130
  v_mfma_f32_16x16x32_bf16 v[136:139], a[80:83], a[32:35], v[152:155]
  ds_read_b64_tr_b16 a[172:173], v183 offset:2048
  ds_read_b128 a[72:75], v174 offset:33792
  v_mfma_f32_16x16x32_bf16 v[136:139], a[84:87], a[36:39], v[136:139]
  v_exp_f32 v131, v131
  v_mfma_f32_16x16x32_bf16 v[136:139], a[88:91], a[40:43], v[136:139]
  v_exp_f32 v132, v132
  v_mfma_f32_16x16x32_bf16 v[136:139], a[92:95], a[44:47], v[136:139]
  ds_read_b64_tr_b16 a[174:175], v183 offset:3072
  ds_read_b128 a[76:79], v175 offset:33792
  v_mfma_f32_16x16x32_bf16 v[140:143], a[96:99], a[32:35], v[152:155]
  v_cvt_pk_bf16_f32 v128, v128, v129
  v_cvt_pk_bf16_f32 v129, v130, v131
  v_mfma_f32_16x16x32_bf16 v[140:143], a[100:103], a[36:39], v[140:143]
  v_exp_f32 v133, v133
  v_mfma_f32_16x16x32_bf16 v[140:143], a[104:107], a[40:43], v[140:143]
  v_exp_f32 v134, v134
  v_mfma_f32_16x16x32_bf16 v[140:143], a[108:111], a[44:47], v[140:143]
  v_exp_f32 v135, v135
  s_waitcnt lgkmcnt(1)
  v_mfma_f32_16x16x32_bf16 v[0:3], a[144:147], v[120:123], v[0:3]
  v_cvt_pk_bf16_f32 v130, v132, v133
  v_cvt_pk_bf16_f32 v131, v134, v135
  v_mfma_f32_16x16x32_bf16 v[4:7], a[148:151], v[120:123], v[4:7]
  v_mfma_f32_16x16x32_bf16 v[8:11], a[152:155], v[120:123], v[8:11]
  v_mfma_f32_16x16x32_bf16 v[12:15], a[156:159], v[120:123], v[12:15]
  v_mfma_f32_16x16x32_bf16 v[16:19], a[160:163], v[120:123], v[16:19]
  v_exp_f32 v136, v136
  v_mfma_f32_16x16x32_bf16 v[20:23], a[164:167], v[120:123], v[20:23]
  v_exp_f32 v137, v137
  v_mfma_f32_16x16x32_bf16 v[24:27], a[168:171], v[120:123], v[24:27]
  v_exp_f32 v138, v138
  v_mfma_f32_16x16x32_bf16 v[28:31], a[172:175], v[120:123], v[28:31]
  v_exp_f32 v139, v139
  v_mfma_f32_16x16x32_bf16 v[156:159], v[160:163], v[120:123], v[156:159]
  v_exp_f32 v140, v140
  s_waitcnt lgkmcnt(0)
  v_mfma_f32_16x16x32_bf16 v[96:99], a[48:51], a[0:3], v[144:147]
  v_cvt_pk_bf16_f32 v136, v136, v137
  v_cvt_pk_bf16_f32 v137, v138, v139
  v_mfma_f32_16x16x32_bf16 v[96:99], a[52:55], a[4:7], v[96:99]
  v_exp_f32 v141, v141
  v_mfma_f32_16x16x32_bf16 v[96:99], a[56:59], a[8:11], v[96:99]
  v_exp_f32 v142, v142
  v_mfma_f32_16x16x32_bf16 v[96:99], a[60:63], a[12:15], v[96:99]
  v_exp_f32 v143, v143
  v_mfma_f32_16x16x32_bf16 v[100:103], a[64:67], a[0:3], v[144:147]
  s_waitcnt vmcnt(4) lgkmcnt(0)
  s_barrier
  v_mfma_f32_16x16x32_bf16 v[100:103], a[68:71], a[4:7], v[100:103]
  v_cvt_pk_bf16_f32 v138, v140, v141
  v_cvt_pk_bf16_f32 v139, v142, v143
  v_mfma_f32_16x16x32_bf16 v[100:103], a[72:75], a[8:11], v[100:103]
  ds_read_b64_tr_b16 a[112:113], v176 offset:16384
  ds_read_b64_tr_b16 a[114:115], v176 offset:17408
  v_mfma_f32_16x16x32_bf16 v[100:103], a[76:79], a[12:15], v[100:103]
  v_mfma_f32_16x16x32_bf16 v[32:35], a[144:147], v[128:131], v[32:35]
  v_mfma_f32_16x16x32_bf16 v[36:39], a[148:151], v[128:131], v[36:39]
  ds_read_b64_tr_b16 a[116:117], v177 offset:16384
  ds_read_b64_tr_b16 a[118:119], v177 offset:17408
  v_mfma_f32_16x16x32_bf16 v[40:43], a[152:155], v[128:131], v[40:43]
  v_mfma_f32_16x16x32_bf16 v[44:47], a[156:159], v[128:131], v[44:47]
  v_mfma_f32_16x16x32_bf16 v[48:51], a[160:163], v[128:131], v[48:51]
  ds_read_b64_tr_b16 a[120:121], v178 offset:16384
  ds_read_b64_tr_b16 a[122:123], v178 offset:17408
  v_mfma_f32_16x16x32_bf16 v[52:55], a[164:167], v[128:131], v[52:55]
  v_exp_f32 v96, v96
  v_mfma_f32_16x16x32_bf16 v[56:59], a[168:171], v[128:131], v[56:59]
  v_exp_f32 v97, v97
  v_mfma_f32_16x16x32_bf16 v[60:63], a[172:175], v[128:131], v[60:63]
  ds_read_b64_tr_b16 a[124:125], v179 offset:16384
  ds_read_b64_tr_b16 a[126:127], v179 offset:17408
  v_mfma_f32_16x16x32_bf16 v[156:159], v[164:167], v[128:131], v[156:159]
  v_exp_f32 v98, v98
  v_mfma_f32_16x16x32_bf16 v[104:107], a[48:51], a[16:19], v[148:151]
  v_exp_f32 v99, v99
  v_mfma_f32_16x16x32_bf16 v[104:107], a[52:55], a[20:23], v[104:107]
  ds_read_b64_tr_b16 a[128:129], v180 offset:16384
  ds_read_b128 a[80:83], v172 offset:34816
  v_mfma_f32_16x16x32_bf16 v[104:107], a[56:59], a[24:27], v[104:107]
  v_exp_f32 v100, v100
  v_mfma_f32_16x16x32_bf16 v[104:107], a[60:63], a[28:31], v[104:107]
  v_cvt_pk_bf16_f32 v96, v96, v97
  v_cvt_pk_bf16_f32 v97, v98, v99
  v_mfma_f32_16x16x32_bf16 v[108:111], a[64:67], a[16:19], v[148:151]
  ds_read_b64_tr_b16 a[130:131], v180 offset:17408
  ds_read_b128 a[84:87], v173 offset:34816
  v_mfma_f32_16x16x32_bf16 v[108:111], a[68:71], a[20:23], v[108:111]
  v_exp_f32 v101, v101
  v_mfma_f32_16x16x32_bf16 v[108:111], a[72:75], a[24:27], v[108:111]
  v_exp_f32 v102, v102
  v_mfma_f32_16x16x32_bf16 v[108:111], a[76:79], a[28:31], v[108:111]
  ds_read_b64_tr_b16 a[132:133], v181 offset:16384
  ds_read_b128 a[88:91], v174 offset:34816
  v_mfma_f32_16x16x32_bf16 v[64:67], a[144:147], v[136:139], v[64:67]
  v_exp_f32 v103, v103
  v_mfma_f32_16x16x32_bf16 v[68:71], a[148:151], v[136:139], v[68:71]
  v_cvt_pk_bf16_f32 v98, v100, v101
  v_cvt_pk_bf16_f32 v99, v102, v103
  v_mfma_f32_16x16x32_bf16 v[72:75], a[152:155], v[136:139], v[72:75]
  ds_read_b64_tr_b16 a[134:135], v181 offset:17408
  ds_read_b128 a[92:95], v175 offset:34816
  v_mfma_f32_16x16x32_bf16 v[76:79], a[156:159], v[136:139], v[76:79]
  v_mfma_f32_16x16x32_bf16 v[80:83], a[160:163], v[136:139], v[80:83]
  v_exp_f32 v104, v104
  v_mfma_f32_16x16x32_bf16 v[84:87], a[164:167], v[136:139], v[84:87]
  ds_read_b64_tr_b16 a[136:137], v182 offset:16384
  ds_read_b128 a[96:99], v172 offset:35840
  v_mfma_f32_16x16x32_bf16 v[88:91], a[168:171], v[136:139], v[88:91]
  v_exp_f32 v105, v105
  v_mfma_f32_16x16x32_bf16 v[92:95], a[172:175], v[136:139], v[92:95]
  v_exp_f32 v106, v106
  v_mfma_f32_16x16x32_bf16 v[156:159], v[168:171], v[136:139], v[156:159]
  ds_read_b64_tr_b16 a[138:139], v182 offset:17408
  ds_read_b128 a[100:103], v173 offset:35840
  v_mfma_f32_16x16x32_bf16 v[112:115], a[48:51], a[32:35], v[152:155]
  v_exp_f32 v107, v107
  v_mfma_f32_16x16x32_bf16 v[112:115], a[52:55], a[36:39], v[112:115]
  v_exp_f32 v108, v108
  v_mfma_f32_16x16x32_bf16 v[112:115], a[56:59], a[40:43], v[112:115]
  ds_read_b64_tr_b16 a[140:141], v183 offset:16384
  ds_read_b128 a[104:107], v174 offset:35840
  v_mfma_f32_16x16x32_bf16 v[112:115], a[60:63], a[44:47], v[112:115]
  v_cvt_pk_bf16_f32 v104, v104, v105
  v_cvt_pk_bf16_f32 v105, v106, v107
  v_mfma_f32_16x16x32_bf16 v[116:119], a[64:67], a[32:35], v[152:155]
  v_exp_f32 v109, v109
  v_mfma_f32_16x16x32_bf16 v[116:119], a[68:71], a[36:39], v[116:119]
  ds_read_b64_tr_b16 a[142:143], v183 offset:17408
  ds_read_b128 a[108:111], v175 offset:35840
  v_mfma_f32_16x16x32_bf16 v[116:119], a[72:75], a[40:43], v[116:119]
  v_exp_f32 v110, v110
  v_mfma_f32_16x16x32_bf16 v[116:119], a[76:79], a[44:47], v[116:119]
  v_exp_f32 v111, v111
  s_waitcnt lgkmcnt(15)
  v_mfma_f32_16x16x32_bf16 v[0:3], a[112:115], v[96:99], v[0:3]
  v_cvt_pk_bf16_f32 v106, v108, v109
  v_cvt_pk_bf16_f32 v107, v110, v111
  v_mfma_f32_16x16x32_bf16 v[4:7], a[116:119], v[96:99], v[4:7]
  v_mfma_f32_16x16x32_bf16 v[8:11], a[120:123], v[96:99], v[8:11]
  v_mfma_f32_16x16x32_bf16 v[12:15], a[124:127], v[96:99], v[12:15]
  s_waitcnt lgkmcnt(0)
  v_mfma_f32_16x16x32_bf16 v[16:19], a[128:131], v[96:99], v[16:19]
  s_add_u32 m0, s45, 0
  v_exp_f32 v112, v112
  v_mfma_f32_16x16x32_bf16 v[20:23], a[132:135], v[96:99], v[20:23]
  buffer_load_dwordx4 v184, s[24:27], s41 offen nt lds
  v_mfma_f32_16x16x32_bf16 v[24:27], a[136:139], v[96:99], v[24:27]
  v_exp_f32 v113, v113
  v_mfma_f32_16x16x32_bf16 v[28:31], a[140:143], v[96:99], v[28:31]
  v_exp_f32 v114, v114
  v_mfma_f32_16x16x32_bf16 v[156:159], v[160:163], v[96:99], v[156:159]
  buffer_load_dwordx4 v184, s[24:27], s41 offen offset:1024 nt lds
  ds_read_b64_tr_b16 a[144:145], v176 offset:18432
  ds_read_b64_tr_b16 a[146:147], v176 offset:19456
  v_mfma_f32_16x16x32_bf16 v[120:123], a[80:83], a[0:3], v[144:147]
  v_exp_f32 v115, v115
  v_mfma_f32_16x16x32_bf16 v[120:123], a[84:87], a[4:7], v[120:123]
  v_exp_f32 v116, v116
  v_mfma_f32_16x16x32_bf16 v[120:123], a[88:91], a[8:11], v[120:123]
  buffer_load_dwordx4 v184, s[24:27], s41 offen offset:2048 nt lds
  ds_read_b64_tr_b16 a[148:149], v177 offset:18432
  ds_read_b64_tr_b16 a[150:151], v177 offset:19456
  v_mfma_f32_16x16x32_bf16 v[120:123], a[92:95], a[12:15], v[120:123]
  v_cvt_pk_bf16_f32 v112, v112, v113
  v_cvt_pk_bf16_f32 v113, v114, v115
  v_mfma_f32_16x16x32_bf16 v[124:127], a[96:99], a[0:3], v[144:147]
  v_exp_f32 v117, v117
  v_mfma_f32_16x16x32_bf16 v[124:127], a[100:103], a[4:7], v[124:127]
  buffer_load_dwordx4 v184, s[24:27], s41 offen offset:3072 nt lds
  v_mfma_f32_16x16x32_bf16 v[124:127], a[104:107], a[8:11], v[124:127]
  s_add_u32 s41, s41, 16384
  ds_read_b64_tr_b16 a[152:153], v178 offset:18432
  ds_read_b64_tr_b16 a[154:155], v178 offset:19456
  v_mfma_f32_16x16x32_bf16 v[124:127], a[108:111], a[12:15], v[124:127]
  s_add_u32 m0, s45, 114688
  v_exp_f32 v118, v118
  v_mfma_f32_16x16x32_bf16 v[32:35], a[112:115], v[104:107], v[32:35]
  buffer_load_dwordx4 v185, s[28:31], s42 offen nt lds
  v_mfma_f32_16x16x32_bf16 v[36:39], a[116:119], v[104:107], v[36:39]
  ds_read_b64_tr_b16 a[156:157], v179 offset:18432
  ds_read_b64_tr_b16 a[158:159], v179 offset:19456
  v_mfma_f32_16x16x32_bf16 v[40:43], a[120:123], v[104:107], v[40:43]
  v_exp_f32 v119, v119
  v_mfma_f32_16x16x32_bf16 v[44:47], a[124:127], v[104:107], v[44:47]
  buffer_load_dwordx4 v185, s[28:31], s42 offen offset:1024 nt lds
  v_mfma_f32_16x16x32_bf16 v[48:51], a[128:131], v[104:107], v[48:51]
  v_cvt_pk_bf16_f32 v114, v116, v117
  v_cvt_pk_bf16_f32 v115, v118, v119
  v_mfma_f32_16x16x32_bf16 v[52:55], a[132:135], v[104:107], v[52:55]
  ds_read_b64_tr_b16 a[160:161], v180 offset:18432
  ds_read_b128 a[48:51], v172 offset:16384
  v_mfma_f32_16x16x32_bf16 v[56:59], a[136:139], v[104:107], v[56:59]
  buffer_load_dwordx4 v185, s[28:31], s42 offen offset:2048 nt lds
  v_mfma_f32_16x16x32_bf16 v[60:63], a[140:143], v[104:107], v[60:63]
  v_exp_f32 v120, v120
  v_mfma_f32_16x16x32_bf16 v[156:159], v[164:167], v[104:107], v[156:159]
  ds_read_b64_tr_b16 a[162:163], v180 offset:19456
  ds_read_b128 a[52:55], v173 offset:16384
  v_mfma_f32_16x16x32_bf16 v[128:131], a[80:83], a[16:19], v[148:151]
  buffer_load_dwordx4 v185, s[28:31], s42 offen offset:3072 nt lds
  v_mfma_f32_16x16x32_bf16 v[128:131], a[84:87], a[20:23], v[128:131]
  s_add_u32 s42, s42, 16384
  v_exp_f32 v121, v121
  v_mfma_f32_16x16x32_bf16 v[128:131], a[88:91], a[24:27], v[128:131]
  v_exp_f32 v122, v122
  v_mfma_f32_16x16x32_bf16 v[128:131], a[92:95], a[28:31], v[128:131]
  ds_read_b64_tr_b16 a[164:165], v181 offset:18432
  ds_read_b128 a[56:59], v174 offset:16384
  v_mfma_f32_16x16x32_bf16 v[132:135], a[96:99], a[16:19], v[148:151]
  v_exp_f32 v123, v123
  v_mfma_f32_16x16x32_bf16 v[132:135], a[100:103], a[20:23], v[132:135]
  v_exp_f32 v124, v124
  v_mfma_f32_16x16x32_bf16 v[132:135], a[104:107], a[24:27], v[132:135]
  ds_read_b64_tr_b16 a[166:167], v181 offset:19456
  ds_read_b128 a[60:63], v175 offset:16384
  v_mfma_f32_16x16x32_bf16 v[132:135], a[108:111], a[28:31], v[132:135]
  v_cvt_pk_bf16_f32 v120, v120, v121
  v_cvt_pk_bf16_f32 v121, v122, v123
  v_mfma_f32_16x16x32_bf16 v[64:67], a[112:115], v[112:115], v[64:67]
  v_exp_f32 v125, v125
  v_mfma_f32_16x16x32_bf16 v[68:71], a[116:119], v[112:115], v[68:71]
  v_exp_f32 v126, v126
  v_mfma_f32_16x16x32_bf16 v[72:75], a[120:123], v[112:115], v[72:75]
  ds_read_b64_tr_b16 a[168:169], v182 offset:18432
  ds_read_b128 a[64:67], v172 offset:17408
  v_mfma_f32_16x16x32_bf16 v[76:79], a[124:127], v[112:115], v[76:79]
  v_exp_f32 v127, v127
  v_mfma_f32_16x16x32_bf16 v[80:83], a[128:131], v[112:115], v[80:83]
  v_cvt_pk_bf16_f32 v122, v124, v125
  v_cvt_pk_bf16_f32 v123, v126, v127
  v_mfma_f32_16x16x32_bf16 v[84:87], a[132:135], v[112:115], v[84:87]
  ds_read_b64_tr_b16 a[170:171], v182 offset:19456
  ds_read_b128 a[68:71], v173 offset:17408
  v_mfma_f32_16x16x32_bf16 v[88:91], a[136:139], v[112:115], v[88:91]
  v_exp_f32 v128, v128
  v_mfma_f32_16x16x32_bf16 v[92:95], a[140:143], v[112:115], v[92:95]
  v_exp_f32 v129, v129
  v_mfma_f32_16x16x32_bf16 v[156:159], v[168:171], v[112:115], v[156:159]
  v_exp_f32 v130, v130
  v_mfma_f32_16x16x32_bf16 v[136:139], a[80:83], a[32:35], v[152:155]
  ds_read_b64_tr_b16 a[172:173], v183 offset:18432
  ds_read_b128 a[72:75], v174 offset:17408
  v_mfma_f32_16x16x32_bf16 v[136:139], a[84:87], a[36:39], v[136:139]
  v_exp_f32 v131, v131
  v_mfma_f32_16x16x32_bf16 v[136:139], a[88:91], a[40:43], v[136:139]
  v_exp_f32 v132, v132
  v_mfma_f32_16x16x32_bf16 v[136:139], a[92:95], a[44:47], v[136:139]
  ds_read_b64_tr_b16 a[174:175], v183 offset:19456
  ds_read_b128 a[76:79], v175 offset:17408
  v_mfma_f32_16x16x32_bf16 v[140:143], a[96:99], a[32:35], v[152:155]
  v_cvt_pk_bf16_f32 v128, v128, v129
  v_cvt_pk_bf16_f32 v129, v130, v131
  v_mfma_f32_16x16x32_bf16 v[140:143], a[100:103], a[36:39], v[140:143]
  v_exp_f32 v133, v133
  v_mfma_f32_16x16x32_bf16 v[140:143], a[104:107], a[40:43], v[140:143]
  v_exp_f32 v134, v134
  v_mfma_f32_16x16x32_bf16 v[140:143], a[108:111], a[44:47], v[140:143]
  v_exp_f32 v135, v135
  s_waitcnt lgkmcnt(1)
  v_mfma_f32_16x16x32_bf16 v[0:3], a[144:147], v[120:123], v[0:3]
  v_cvt_pk_bf16_f32 v130, v132, v133
  v_cvt_pk_bf16_f32 v131, v134, v135
  v_mfma_f32_16x16x32_bf16 v[4:7], a[148:151], v[120:123], v[4:7]
  v_mfma_f32_16x16x32_bf16 v[8:11], a[152:155], v[120:123], v[8:11]
  v_mfma_f32_16x16x32_bf16 v[12:15], a[156:159], v[120:123], v[12:15]
  v_mfma_f32_16x16x32_bf16 v[16:19], a[160:163], v[120:123], v[16:19]
  v_exp_f32 v136, v136
  v_mfma_f32_16x16x32_bf16 v[20:23], a[164:167], v[120:123], v[20:23]
  v_exp_f32 v137, v137
  v_mfma_f32_16x16x32_bf16 v[24:27], a[168:171], v[120:123], v[24:27]
  v_exp_f32 v138, v138
  v_mfma_f32_16x16x32_bf16 v[28:31], a[172:175], v[120:123], v[28:31]
  v_exp_f32 v139, v139
  v_mfma_f32_16x16x32_bf16 v[156:159], v[160:163], v[120:123], v[156:159]
  v_exp_f32 v140, v140
  s_waitcnt lgkmcnt(0)
  v_mfma_f32_16x16x32_bf16 v[96:99], a[48:51], a[0:3], v[144:147]
  v_cvt_pk_bf16_f32 v136, v136, v137
  v_cvt_pk_bf16_f32 v137, v138, v139
  v_mfma_f32_16x16x32_bf16 v[96:99], a[52:55], a[4:7], v[96:99]
  v_exp_f32 v141, v141
  v_mfma_f32_16x16x32_bf16 v[96:99], a[56:59], a[8:11], v[96:99]
  v_exp_f32 v142, v142
  v_mfma_f32_16x16x32_bf16 v[96:99], a[60:63], a[12:15], v[96:99]
  v_exp_f32 v143, v143
  v_mfma_f32_16x16x32_bf16 v[100:103], a[64:67], a[0:3], v[144:147]
  s_waitcnt vmcnt(4) lgkmcnt(0)
  s_barrier
  v_mfma_f32_16x16x32_bf16 v[100:103], a[68:71], a[4:7], v[100:103]
  v_cvt_pk_bf16_f32 v138, v140, v141
  v_cvt_pk_bf16_f32 v139, v142, v143
  v_mfma_f32_16x16x32_bf16 v[100:103], a[72:75], a[8:11], v[100:103]
  ds_read_b64_tr_b16 a[112:113], v176 offset:32768
  ds_read_b64_tr_b16 a[114:115], v176 offset:33792
  v_mfma_f32_16x16x32_bf16 v[100:103], a[76:79], a[12:15], v[100:103]
  v_mfma_f32_16x16x32_bf16 v[32:35], a[144:147], v[128:131], v[32:35]
  v_mfma_f32_16x16x32_bf16 v[36:39], a[148:151], v[128:131], v[36:39]
  ds_read_b64_tr_b16 a[116:117], v177 offset:32768
  ds_read_b64_tr_b16 a[118:119], v177 offset:33792
  v_mfma_f32_16x16x32_bf16 v[40:43], a[152:155], v[128:131], v[40:43]
  v_mfma_f32_16x16x32_bf16 v[44:47], a[156:159], v[128:131], v[44:47]
  v_mfma_f32_16x16x32_bf16 v[48:51], a[160:163], v[128:131], v[48:51]
  ds_read_b64_tr_b16 a[120:121], v178 offset:32768
  ds_read_b64_tr_b16 a[122:123], v178 offset:33792
  v_mfma_f32_16x16x32_bf16 v[52:55], a[164:167], v[128:131], v[52:55]
  v_exp_f32 v96, v96
  v_mfma_f32_16x16x32_bf16 v[56:59], a[168:171], v[128:131], v[56:59]
  v_exp_f32 v97, v97
  v_mfma_f32_16x16x32_bf16 v[60:63], a[172:175], v[128:131], v[60:63]
  ds_read_b64_tr_b16 a[124:125], v179 offset:32768
  ds_read_b64_tr_b16 a[126:127], v179 offset:33792
  v_mfma_f32_16x16x32_bf16 v[156:159], v[164:167], v[128:131], v[156:159]
  v_exp_f32 v98, v98
  v_mfma_f32_16x16x32_bf16 v[104:107], a[48:51], a[16:19], v[148:151]
  v_exp_f32 v99, v99
  v_mfma_f32_16x16x32_bf16 v[104:107], a[52:55], a[20:23], v[104:107]
  ds_read_b64_tr_b16 a[128:129], v180 offset:32768
  ds_read_b128 a[80:83], v172 offset:18432
  v_mfma_f32_16x16x32_bf16 v[104:107], a[56:59], a[24:27], v[104:107]
  v_exp_f32 v100, v100
  v_mfma_f32_16x16x32_bf16 v[104:107], a[60:63], a[28:31], v[104:107]
  v_cvt_pk_bf16_f32 v96, v96, v97
  v_cvt_pk_bf16_f32 v97, v98, v99
  v_mfma_f32_16x16x32_bf16 v[108:111], a[64:67], a[16:19], v[148:151]
  ds_read_b64_tr_b16 a[130:131], v180 offset:33792
  ds_read_b128 a[84:87], v173 offset:18432
  v_mfma_f32_16x16x32_bf16 v[108:111], a[68:71], a[20:23], v[108:111]
  v_exp_f32 v101, v101
  v_mfma_f32_16x16x32_bf16 v[108:111], a[72:75], a[24:27], v[108:111]
  v_exp_f32 v102, v102
  v_mfma_f32_16x16x32_bf16 v[108:111], a[76:79], a[28:31], v[108:111]
  ds_read_b64_tr_b16 a[132:133], v181 offset:32768
  ds_read_b128 a[88:91], v174 offset:18432
  v_mfma_f32_16x16x32_bf16 v[64:67], a[144:147], v[136:139], v[64:67]
  v_exp_f32 v103, v103
  v_mfma_f32_16x16x32_bf16 v[68:71], a[148:151], v[136:139], v[68:71]
  v_cvt_pk_bf16_f32 v98, v100, v101
  v_cvt_pk_bf16_f32 v99, v102, v103
  v_mfma_f32_16x16x32_bf16 v[72:75], a[152:155], v[136:139], v[72:75]
  ds_read_b64_tr_b16 a[134:135], v181 offset:33792
  ds_read_b128 a[92:95], v175 offset:18432
  v_mfma_f32_16x16x32_bf16 v[76:79], a[156:159], v[136:139], v[76:79]
  v_mfma_f32_16x16x32_bf16 v[80:83], a[160:163], v[136:139], v[80:83]
  v_exp_f32 v104, v104
  v_mfma_f32_16x16x32_bf16 v[84:87], a[164:167], v[136:139], v[84:87]
  ds_read_b64_tr_b16 a[136:137], v182 offset:32768
  ds_read_b128 a[96:99], v172 offset:19456
  v_mfma_f32_16x16x32_bf16 v[88:91], a[168:171], v[136:139], v[88:91]
  v_exp_f32 v105, v105
  v_mfma_f32_16x16x32_bf16 v[92:95], a[172:175], v[136:139], v[92:95]
  v_exp_f32 v106, v106
  v_mfma_f32_16x16x32_bf16 v[156:159], v[168:171], v[136:139], v[156:159]
  ds_read_b64_tr_b16 a[138:139], v182 offset:33792
  ds_read_b128 a[100:103], v173 offset:19456
  v_mfma_f32_16x16x32_bf16 v[112:115], a[48:51], a[32:35], v[152:155]
  v_exp_f32 v107, v107
  v_mfma_f32_16x16x32_bf16 v[112:115], a[52:55], a[36:39], v[112:115]
  v_exp_f32 v108, v108
  v_mfma_f32_16x16x32_bf16 v[112:115], a[56:59], a[40:43], v[112:115]
  ds_read_b64_tr_b16 a[140:141], v183 offset:32768
  ds_read_b128 a[104:107], v174 offset:19456
  v_mfma_f32_16x16x32_bf16 v[112:115], a[60:63], a[44:47], v[112:115]
  v_cvt_pk_bf16_f32 v104, v104, v105
  v_cvt_pk_bf16_f32 v105, v106, v107
  v_mfma_f32_16x16x32_bf16 v[116:119], a[64:67], a[32:35], v[152:155]
  v_exp_f32 v109, v109
  v_mfma_f32_16x16x32_bf16 v[116:119], a[68:71], a[36:39], v[116:119]
  ds_read_b64_tr_b16 a[142:143], v183 offset:33792
  ds_read_b128 a[108:111], v175 offset:19456
  v_mfma_f32_16x16x32_bf16 v[116:119], a[72:75], a[40:43], v[116:119]
  v_exp_f32 v110, v110
  v_mfma_f32_16x16x32_bf16 v[116:119], a[76:79], a[44:47], v[116:119]
  v_exp_f32 v111, v111
  s_waitcnt lgkmcnt(15)
  v_mfma_f32_16x16x32_bf16 v[0:3], a[112:115], v[96:99], v[0:3]
  v_cvt_pk_bf16_f32 v106, v108, v109
  v_cvt_pk_bf16_f32 v107, v110, v111
  v_mfma_f32_16x16x32_bf16 v[4:7], a[116:119], v[96:99], v[4:7]
  v_mfma_f32_16x16x32_bf16 v[8:11], a[120:123], v[96:99], v[8:11]
  v_mfma_f32_16x16x32_bf16 v[12:15], a[124:127], v[96:99], v[12:15]
  s_waitcnt lgkmcnt(0)
  v_mfma_f32_16x16x32_bf16 v[16:19], a[128:131], v[96:99], v[16:19]
  s_add_u32 m0, s45, 49152
  v_exp_f32 v112, v112
  v_mfma_f32_16x16x32_bf16 v[20:23], a[132:135], v[96:99], v[20:23]
  buffer_load_dwordx4 v184, s[24:27], s41 offen nt lds
  v_mfma_f32_16x16x32_bf16 v[24:27], a[136:139], v[96:99], v[24:27]
  v_exp_f32 v113, v113
  v_mfma_f32_16x16x32_bf16 v[28:31], a[140:143], v[96:99], v[28:31]
  v_exp_f32 v114, v114
  v_mfma_f32_16x16x32_bf16 v[156:159], v[160:163], v[96:99], v[156:159]
  buffer_load_dwordx4 v184, s[24:27], s41 offen offset:1024 nt lds
  ds_read_b64_tr_b16 a[144:145], v176 offset:34816
  ds_read_b64_tr_b16 a[146:147], v176 offset:35840
  v_mfma_f32_16x16x32_bf16 v[120:123], a[80:83], a[0:3], v[144:147]
  v_exp_f32 v115, v115
  v_mfma_f32_16x16x32_bf16 v[120:123], a[84:87], a[4:7], v[120:123]
  v_exp_f32 v116, v116
  v_mfma_f32_16x16x32_bf16 v[120:123], a[88:91], a[8:11], v[120:123]
  buffer_load_dwordx4 v184, s[24:27], s41 offen offset:2048 nt lds
  ds_read_b64_tr_b16 a[148:149], v177 offset:34816
  ds_read_b64_tr_b16 a[150:151], v177 offset:35840
  v_mfma_f32_16x16x32_bf16 v[120:123], a[92:95], a[12:15], v[120:123]
  v_cvt_pk_bf16_f32 v112, v112, v113
  v_cvt_pk_bf16_f32 v113, v114, v115
  v_mfma_f32_16x16x32_bf16 v[124:127], a[96:99], a[0:3], v[144:147]
  v_exp_f32 v117, v117
  v_mfma_f32_16x16x32_bf16 v[124:127], a[100:103], a[4:7], v[124:127]
  buffer_load_dwordx4 v184, s[24:27], s41 offen offset:3072 nt lds
  v_mfma_f32_16x16x32_bf16 v[124:127], a[104:107], a[8:11], v[124:127]
  s_add_u32 s41, s41, 16384
  ds_read_b64_tr_b16 a[152:153], v178 offset:34816
  ds_read_b64_tr_b16 a[154:155], v178 offset:35840
  v_mfma_f32_16x16x32_bf16 v[124:127], a[108:111], a[12:15], v[124:127]
  s_add_u32 m0, s45, 65536
  v_exp_f32 v118, v118
  v_mfma_f32_16x16x32_bf16 v[32:35], a[112:115], v[104:107], v[32:35]
  buffer_load_dwordx4 v185, s[28:31], s42 offen nt lds
  v_mfma_f32_16x16x32_bf16 v[36:39], a[116:119], v[104:107], v[36:39]
  ds_read_b64_tr_b16 a[156:157], v179 offset:34816
  ds_read_b64_tr_b16 a[158:159], v179 offset:35840
  v_mfma_f32_16x16x32_bf16 v[40:43], a[120:123], v[104:107], v[40:43]
  v_exp_f32 v119, v119
  v_mfma_f32_16x16x32_bf16 v[44:47], a[124:127], v[104:107], v[44:47]
  buffer_load_dwordx4 v185, s[28:31], s42 offen offset:1024 nt lds
  v_mfma_f32_16x16x32_bf16 v[48:51], a[128:131], v[104:107], v[48:51]
  v_cvt_pk_bf16_f32 v114, v116, v117
  v_cvt_pk_bf16_f32 v115, v118, v119
  v_mfma_f32_16x16x32_bf16 v[52:55], a[132:135], v[104:107], v[52:55]
  ds_read_b64_tr_b16 a[160:161], v180 offset:34816
  ds_read_b128 a[48:51], v172
  v_mfma_f32_16x16x32_bf16 v[56:59], a[136:139], v[104:107], v[56:59]
  buffer_load_dwordx4 v185, s[28:31], s42 offen offset:2048 nt lds
  v_mfma_f32_16x16x32_bf16 v[60:63], a[140:143], v[104:107], v[60:63]
  v_exp_f32 v120, v120
  v_mfma_f32_16x16x32_bf16 v[156:159], v[164:167], v[104:107], v[156:159]
  ds_read_b64_tr_b16 a[162:163], v180 offset:35840
  ds_read_b128 a[52:55], v173
  v_mfma_f32_16x16x32_bf16 v[128:131], a[80:83], a[16:19], v[148:151]
  buffer_load_dwordx4 v185, s[28:31], s42 offen offset:3072 nt lds
  v_mfma_f32_16x16x32_bf16 v[128:131], a[84:87], a[20:23], v[128:131]
  s_add_u32 s42, s42, 16384
  v_exp_f32 v121, v121
  v_mfma_f32_16x16x32_bf16 v[128:131], a[88:91], a[24:27], v[128:131]
  v_exp_f32 v122, v122
  v_mfma_f32_16x16x32_bf16 v[128:131], a[92:95], a[28:31], v[128:131]
  ds_read_b64_tr_b16 a[164:165], v181 offset:34816
  ds_read_b128 a[56:59], v174
  v_mfma_f32_16x16x32_bf16 v[132:135], a[96:99], a[16:19], v[148:151]
  v_exp_f32 v123, v123
  v_mfma_f32_16x16x32_bf16 v[132:135], a[100:103], a[20:23], v[132:135]
  v_exp_f32 v124, v124
  v_mfma_f32_16x16x32_bf16 v[132:135], a[104:107], a[24:27], v[132:135]
  ds_read_b64_tr_b16 a[166:167], v181 offset:35840
  ds_read_b128 a[60:63], v175
  v_mfma_f32_16x16x32_bf16 v[132:135], a[108:111], a[28:31], v[132:135]
  v_cvt_pk_bf16_f32 v120, v120, v121
  v_cvt_pk_bf16_f32 v121, v122, v123
  v_mfma_f32_16x16x32_bf16 v[64:67], a[112:115], v[112:115], v[64:67]
  v_exp_f32 v125, v125
  v_mfma_f32_16x16x32_bf16 v[68:71], a[116:119], v[112:115], v[68:71]
  v_exp_f32 v126, v126
  v_mfma_f32_16x16x32_bf16 v[72:75], a[120:123], v[112:115], v[72:75]
  ds_read_b64_tr_b16 a[168:169], v182 offset:34816
  ds_read_b128 a[64:67], v172 offset:1024
  v_mfma_f32_16x16x32_bf16 v[76:79], a[124:127], v[112:115], v[76:79]
  v_exp_f32 v127, v127
  v_mfma_f32_16x16x32_bf16 v[80:83], a[128:131], v[112:115], v[80:83]
  v_cvt_pk_bf16_f32 v122, v124, v125
  v_cvt_pk_bf16_f32 v123, v126, v127
  v_mfma_f32_16x16x32_bf16 v[84:87], a[132:135], v[112:115], v[84:87]
  ds_read_b64_tr_b16 a[170:171], v182 offset:35840
  ds_read_b128 a[68:71], v173 offset:1024
  v_mfma_f32_16x16x32_bf16 v[88:91], a[136:139], v[112:115], v[88:91]
  v_exp_f32 v128, v128
  v_mfma_f32_16x16x32_bf16 v[92:95], a[140:143], v[112:115], v[92:95]
  v_exp_f32 v129, v129
  v_mfma_f32_16x16x32_bf16 v[156:159], v[168:171], v[112:115], v[156:159]
  v_exp_f32 v130, v130
  v_mfma_f32_16x16x32_bf16 v[136:139], a[80:83], a[32:35], v[152:155]
  ds_read_b64_tr_b16 a[172:173], v183 offset:34816
  ds_read_b128 a[72:75], v174 offset:1024
  v_mfma_f32_16x16x32_bf16 v[136:139], a[84:87], a[36:39], v[136:139]
  v_exp_f32 v131, v131
  v_mfma_f32_16x16x32_bf16 v[136:139], a[88:91], a[40:43], v[136:139]
  v_exp_f32 v132, v132
  v_mfma_f32_16x16x32_bf16 v[136:139], a[92:95], a[44:47], v[136:139]
  ds_read_b64_tr_b16 a[174:175], v183 offset:35840
  ds_read_b128 a[76:79], v175 offset:1024
  v_mfma_f32_16x16x32_bf16 v[140:143], a[96:99], a[32:35], v[152:155]
  v_cvt_pk_bf16_f32 v128, v128, v129
  v_cvt_pk_bf16_f32 v129, v130, v131
  v_mfma_f32_16x16x32_bf16 v[140:143], a[100:103], a[36:39], v[140:143]
  v_exp_f32 v133, v133
  v_mfma_f32_16x16x32_bf16 v[140:143], a[104:107], a[40:43], v[140:143]
  v_exp_f32 v134, v134
  v_mfma_f32_16x16x32_bf16 v[140:143], a[108:111], a[44:47], v[140:143]
  v_exp_f32 v135, v135
  s_waitcnt lgkmcnt(1)
  v_mfma_f32_16x16x32_bf16 v[0:3], a[144:147], v[120:123], v[0:3]
  v_cvt_pk_bf16_f32 v130, v132, v133
  v_cvt_pk_bf16_f32 v131, v134, v135
  v_mfma_f32_16x16x32_bf16 v[4:7], a[148:151], v[120:123], v[4:7]
  v_mfma_f32_16x16x32_bf16 v[8:11], a[152:155], v[120:123], v[8:11]
  v_mfma_f32_16x16x32_bf16 v[12:15], a[156:159], v[120:123], v[12:15]
  v_mfma_f32_16x16x32_bf16 v[16:19], a[160:163], v[120:123], v[16:19]
  v_exp_f32 v136, v136
  v_mfma_f32_16x16x32_bf16 v[20:23], a[164:167], v[120:123], v[20:23]
  v_exp_f32 v137, v137
  v_mfma_f32_16x16x32_bf16 v[24:27], a[168:171], v[120:123], v[24:27]
  v_exp_f32 v138, v138
  v_mfma_f32_16x16x32_bf16 v[28:31], a[172:175], v[120:123], v[28:31]
  v_exp_f32 v139, v139
  v_mfma_f32_16x16x32_bf16 v[156:159], v[160:163], v[120:123], v[156:159]
  v_exp_f32 v140, v140
  s_waitcnt lgkmcnt(0)
  v_mfma_f32_16x16x32_bf16 v[96:99], a[48:51], a[0:3], v[144:147]
  v_cvt_pk_bf16_f32 v136, v136, v137
  v_cvt_pk_bf16_f32 v137, v138, v139
  v_mfma_f32_16x16x32_bf16 v[96:99], a[52:55], a[4:7], v[96:99]
  v_exp_f32 v141, v141
  v_mfma_f32_16x16x32_bf16 v[96:99], a[56:59], a[8:11], v[96:99]
  v_exp_f32 v142, v142
  v_mfma_f32_16x16x32_bf16 v[96:99], a[60:63], a[12:15], v[96:99]
  v_exp_f32 v143, v143
  v_mfma_f32_16x16x32_bf16 v[100:103], a[64:67], a[0:3], v[144:147]
  s_waitcnt vmcnt(4) lgkmcnt(0)
  s_barrier
  v_mfma_f32_16x16x32_bf16 v[100:103], a[68:71], a[4:7], v[100:103]
  v_cvt_pk_bf16_f32 v138, v140, v141
  v_cvt_pk_bf16_f32 v139, v142, v143
  v_mfma_f32_16x16x32_bf16 v[100:103], a[72:75], a[8:11], v[100:103]
  ds_read_b64_tr_b16 a[112:113], v176 offset:49152
  ds_read_b64_tr_b16 a[114:115], v176 offset:50176
  v_mfma_f32_16x16x32_bf16 v[100:103], a[76:79], a[12:15], v[100:103]
  v_mfma_f32_16x16x32_bf16 v[32:35], a[144:147], v[128:131], v[32:35]
  v_mfma_f32_16x16x32_bf16 v[36:39], a[148:151], v[128:131], v[36:39]
  ds_read_b64_tr_b16 a[116:117], v177 offset:49152
  ds_read_b64_tr_b16 a[118:119], v177 offset:50176
  v_mfma_f32_16x16x32_bf16 v[40:43], a[152:155], v[128:131], v[40:43]
  v_mfma_f32_16x16x32_bf16 v[44:47], a[156:159], v[128:131], v[44:47]
  v_mfma_f32_16x16x32_bf16 v[48:51], a[160:163], v[128:131], v[48:51]
  ds_read_b64_tr_b16 a[120:121], v178 offset:49152
  ds_read_b64_tr_b16 a[122:123], v178 offset:50176
  v_mfma_f32_16x16x32_bf16 v[52:55], a[164:167], v[128:131], v[52:55]
  v_exp_f32 v96, v96
  v_mfma_f32_16x16x32_bf16 v[56:59], a[168:171], v[128:131], v[56:59]
  v_exp_f32 v97, v97
  v_mfma_f32_16x16x32_bf16 v[60:63], a[172:175], v[128:131], v[60:63]
  ds_read_b64_tr_b16 a[124:125], v179 offset:49152
  ds_read_b64_tr_b16 a[126:127], v179 offset:50176
  v_mfma_f32_16x16x32_bf16 v[156:159], v[164:167], v[128:131], v[156:159]
  v_exp_f32 v98, v98
  v_mfma_f32_16x16x32_bf16 v[104:107], a[48:51], a[16:19], v[148:151]
  v_exp_f32 v99, v99
  v_mfma_f32_16x16x32_bf16 v[104:107], a[52:55], a[20:23], v[104:107]
  ds_read_b64_tr_b16 a[128:129], v180 offset:49152
  ds_read_b128 a[80:83], v172 offset:2048
  v_mfma_f32_16x16x32_bf16 v[104:107], a[56:59], a[24:27], v[104:107]
  v_exp_f32 v100, v100
  v_mfma_f32_16x16x32_bf16 v[104:107], a[60:63], a[28:31], v[104:107]
  v_cvt_pk_bf16_f32 v96, v96, v97
  v_cvt_pk_bf16_f32 v97, v98, v99
  v_mfma_f32_16x16x32_bf16 v[108:111], a[64:67], a[16:19], v[148:151]
  ds_read_b64_tr_b16 a[130:131], v180 offset:50176
  ds_read_b128 a[84:87], v173 offset:2048
  v_mfma_f32_16x16x32_bf16 v[108:111], a[68:71], a[20:23], v[108:111]
  v_exp_f32 v101, v101
  v_mfma_f32_16x16x32_bf16 v[108:111], a[72:75], a[24:27], v[108:111]
  v_exp_f32 v102, v102
  v_mfma_f32_16x16x32_bf16 v[108:111], a[76:79], a[28:31], v[108:111]
  ds_read_b64_tr_b16 a[132:133], v181 offset:49152
  ds_read_b128 a[88:91], v174 offset:2048
  v_mfma_f32_16x16x32_bf16 v[64:67], a[144:147], v[136:139], v[64:67]
  v_exp_f32 v103, v103
  v_mfma_f32_16x16x32_bf16 v[68:71], a[148:151], v[136:139], v[68:71]
  v_cvt_pk_bf16_f32 v98, v100, v101
  v_cvt_pk_bf16_f32 v99, v102, v103
  v_mfma_f32_16x16x32_bf16 v[72:75], a[152:155], v[136:139], v[72:75]
  ds_read_b64_tr_b16 a[134:135], v181 offset:50176
  ds_read_b128 a[92:95], v175 offset:2048
  v_mfma_f32_16x16x32_bf16 v[76:79], a[156:159], v[136:139], v[76:79]
  v_mfma_f32_16x16x32_bf16 v[80:83], a[160:163], v[136:139], v[80:83]
  v_exp_f32 v104, v104
  v_mfma_f32_16x16x32_bf16 v[84:87], a[164:167], v[136:139], v[84:87]
  ds_read_b64_tr_b16 a[136:137], v182 offset:49152
  ds_read_b128 a[96:99], v172 offset:3072
  v_mfma_f32_16x16x32_bf16 v[88:91], a[168:171], v[136:139], v[88:91]
  v_exp_f32 v105, v105
  v_mfma_f32_16x16x32_bf16 v[92:95], a[172:175], v[136:139], v[92:95]
  v_exp_f32 v106, v106
  v_mfma_f32_16x16x32_bf16 v[156:159], v[168:171], v[136:139], v[156:159]
  ds_read_b64_tr_b16 a[138:139], v182 offset:50176
  ds_read_b128 a[100:103], v173 offset:3072
  v_mfma_f32_16x16x32_bf16 v[112:115], a[48:51], a[32:35], v[152:155]
  v_exp_f32 v107, v107
  v_mfma_f32_16x16x32_bf16 v[112:115], a[52:55], a[36:39], v[112:115]
  v_exp_f32 v108, v108
  v_mfma_f32_16x16x32_bf16 v[112:115], a[56:59], a[40:43], v[112:115]
  ds_read_b64_tr_b16 a[140:141], v183 offset:49152
  ds_read_b128 a[104:107], v174 offset:3072
  v_mfma_f32_16x16x32_bf16 v[112:115], a[60:63], a[44:47], v[112:115]
  v_cvt_pk_bf16_f32 v104, v104, v105
  v_cvt_pk_bf16_f32 v105, v106, v107
  v_mfma_f32_16x16x32_bf16 v[116:119], a[64:67], a[32:35], v[152:155]
  v_exp_f32 v109, v109
  v_mfma_f32_16x16x32_bf16 v[116:119], a[68:71], a[36:39], v[116:119]
  ds_read_b64_tr_b16 a[142:143], v183 offset:50176
  ds_read_b128 a[108:111], v175 offset:3072
  v_mfma_f32_16x16x32_bf16 v[116:119], a[72:75], a[40:43], v[116:119]
  v_exp_f32 v110, v110
  v_mfma_f32_16x16x32_bf16 v[116:119], a[76:79], a[44:47], v[116:119]
  v_exp_f32 v111, v111
  s_waitcnt lgkmcnt(15)
  v_mfma_f32_16x16x32_bf16 v[0:3], a[112:115], v[96:99], v[0:3]
  v_cvt_pk_bf16_f32 v106, v108, v109
  v_cvt_pk_bf16_f32 v107, v110, v111
  v_mfma_f32_16x16x32_bf16 v[4:7], a[116:119], v[96:99], v[4:7]
  v_mfma_f32_16x16x32_bf16 v[8:11], a[120:123], v[96:99], v[8:11]
  v_mfma_f32_16x16x32_bf16 v[12:15], a[124:127], v[96:99], v[12:15]
  s_waitcnt lgkmcnt(0)
  v_mfma_f32_16x16x32_bf16 v[16:19], a[128:131], v[96:99], v[16:19]
  s_add_u32 m0, s45, 32768
  v_exp_f32 v112, v112
  v_mfma_f32_16x16x32_bf16 v[20:23], a[132:135], v[96:99], v[20:23]
  buffer_load_dwordx4 v184, s[24:27], s41 offen nt lds
  v_mfma_f32_16x16x32_bf16 v[24:27], a[136:139], v[96:99], v[24:27]
  v_exp_f32 v113, v113
  v_mfma_f32_16x16x32_bf16 v[28:31], a[140:143], v[96:99], v[28:31]
  v_exp_f32 v114, v114
  v_mfma_f32_16x16x32_bf16 v[156:159], v[160:163], v[96:99], v[156:159]
  buffer_load_dwordx4 v184, s[24:27], s41 offen offset:1024 nt lds
  ds_read_b64_tr_b16 a[144:145], v176 offset:51200
  ds_read_b64_tr_b16 a[146:147], v176 offset:52224
  v_mfma_f32_16x16x32_bf16 v[120:123], a[80:83], a[0:3], v[144:147]
  v_exp_f32 v115, v115
  v_mfma_f32_16x16x32_bf16 v[120:123], a[84:87], a[4:7], v[120:123]
  v_exp_f32 v116, v116
  v_mfma_f32_16x16x32_bf16 v[120:123], a[88:91], a[8:11], v[120:123]
  buffer_load_dwordx4 v184, s[24:27], s41 offen offset:2048 nt lds
  ds_read_b64_tr_b16 a[148:149], v177 offset:51200
  ds_read_b64_tr_b16 a[150:151], v177 offset:52224
  v_mfma_f32_16x16x32_bf16 v[120:123], a[92:95], a[12:15], v[120:123]
  v_cvt_pk_bf16_f32 v112, v112, v113
  v_cvt_pk_bf16_f32 v113, v114, v115
  v_mfma_f32_16x16x32_bf16 v[124:127], a[96:99], a[0:3], v[144:147]
  v_exp_f32 v117, v117
  v_mfma_f32_16x16x32_bf16 v[124:127], a[100:103], a[4:7], v[124:127]
  buffer_load_dwordx4 v184, s[24:27], s41 offen offset:3072 nt lds
  v_mfma_f32_16x16x32_bf16 v[124:127], a[104:107], a[8:11], v[124:127]
  s_add_u32 s41, s41, 16384
  ds_read_b64_tr_b16 a[152:153], v178 offset:51200
  ds_read_b64_tr_b16 a[154:155], v178 offset:52224
  v_mfma_f32_16x16x32_bf16 v[124:127], a[108:111], a[12:15], v[124:127]
  s_add_u32 m0, s45, 81920
  v_exp_f32 v118, v118
  v_mfma_f32_16x16x32_bf16 v[32:35], a[112:115], v[104:107], v[32:35]
  buffer_load_dwordx4 v185, s[28:31], s42 offen nt lds
  v_mfma_f32_16x16x32_bf16 v[36:39], a[116:119], v[104:107], v[36:39]
  ds_read_b64_tr_b16 a[156:157], v179 offset:51200
  ds_read_b64_tr_b16 a[158:159], v179 offset:52224
  v_mfma_f32_16x16x32_bf16 v[40:43], a[120:123], v[104:107], v[40:43]
  v_exp_f32 v119, v119
  v_mfma_f32_16x16x32_bf16 v[44:47], a[124:127], v[104:107], v[44:47]
  buffer_load_dwordx4 v185, s[28:31], s42 offen offset:1024 nt lds
  v_mfma_f32_16x16x32_bf16 v[48:51], a[128:131], v[104:107], v[48:51]
  v_cvt_pk_bf16_f32 v114, v116, v117
  v_cvt_pk_bf16_f32 v115, v118, v119
  v_mfma_f32_16x16x32_bf16 v[52:55], a[132:135], v[104:107], v[52:55]
  ds_read_b64_tr_b16 a[160:161], v180 offset:51200
  ds_read_b128 a[48:51], v172 offset:49152
  v_mfma_f32_16x16x32_bf16 v[56:59], a[136:139], v[104:107], v[56:59]
  buffer_load_dwordx4 v185, s[28:31], s42 offen offset:2048 nt lds
  v_mfma_f32_16x16x32_bf16 v[60:63], a[140:143], v[104:107], v[60:63]
  v_exp_f32 v120, v120
  v_mfma_f32_16x16x32_bf16 v[156:159], v[164:167], v[104:107], v[156:159]
  ds_read_b64_tr_b16 a[162:163], v180 offset:52224
  ds_read_b128 a[52:55], v173 offset:49152
  v_mfma_f32_16x16x32_bf16 v[128:131], a[80:83], a[16:19], v[148:151]
  buffer_load_dwordx4 v185, s[28:31], s42 offen offset:3072 nt lds
  v_mfma_f32_16x16x32_bf16 v[128:131], a[84:87], a[20:23], v[128:131]
  s_add_u32 s42, s42, 16384
  v_exp_f32 v121, v121
  v_mfma_f32_16x16x32_bf16 v[128:131], a[88:91], a[24:27], v[128:131]
  v_exp_f32 v122, v122
  v_mfma_f32_16x16x32_bf16 v[128:131], a[92:95], a[28:31], v[128:131]
  ds_read_b64_tr_b16 a[164:165], v181 offset:51200
  ds_read_b128 a[56:59], v174 offset:49152
  v_mfma_f32_16x16x32_bf16 v[132:135], a[96:99], a[16:19], v[148:151]
  v_exp_f32 v123, v123
  v_mfma_f32_16x16x32_bf16 v[132:135], a[100:103], a[20:23], v[132:135]
  v_exp_f32 v124, v124
  v_mfma_f32_16x16x32_bf16 v[132:135], a[104:107], a[24:27], v[132:135]
  ds_read_b64_tr_b16 a[166:167], v181 offset:52224
  ds_read_b128 a[60:63], v175 offset:49152
  v_mfma_f32_16x16x32_bf16 v[132:135], a[108:111], a[28:31], v[132:135]
  v_cvt_pk_bf16_f32 v120, v120, v121
  v_cvt_pk_bf16_f32 v121, v122, v123
  v_mfma_f32_16x16x32_bf16 v[64:67], a[112:115], v[112:115], v[64:67]
  v_exp_f32 v125, v125
  v_mfma_f32_16x16x32_bf16 v[68:71], a[116:119], v[112:115], v[68:71]
  v_exp_f32 v126, v126
  v_mfma_f32_16x16x32_bf16 v[72:75], a[120:123], v[112:115], v[72:75]
  ds_read_b64_tr_b16 a[168:169], v182 offset:51200
  ds_read_b128 a[64:67], v172 offset:50176
  v_mfma_f32_16x16x32_bf16 v[76:79], a[124:127], v[112:115], v[76:79]
  v_exp_f32 v127, v127
  v_mfma_f32_16x16x32_bf16 v[80:83], a[128:131], v[112:115], v[80:83]
  v_cvt_pk_bf16_f32 v122, v124, v125
  v_cvt_pk_bf16_f32 v123, v126, v127
  v_mfma_f32_16x16x32_bf16 v[84:87], a[132:135], v[112:115], v[84:87]
  ds_read_b64_tr_b16 a[170:171], v182 offset:52224
  ds_read_b128 a[68:71], v173 offset:50176
  v_mfma_f32_16x16x32_bf16 v[88:91], a[136:139], v[112:115], v[88:91]
  v_exp_f32 v128, v128
  v_mfma_f32_16x16x32_bf16 v[92:95], a[140:143], v[112:115], v[92:95]
  v_exp_f32 v129, v129
  v_mfma_f32_16x16x32_bf16 v[156:159], v[168:171], v[112:115], v[156:159]
  v_exp_f32 v130, v130
  v_mfma_f32_16x16x32_bf16 v[136:139], a[80:83], a[32:35], v[152:155]
  ds_read_b64_tr_b16 a[172:173], v183 offset:51200
  ds_read_b128 a[72:75], v174 offset:50176
  v_mfma_f32_16x16x32_bf16 v[136:139], a[84:87], a[36:39], v[136:139]
  v_exp_f32 v131, v131
  v_mfma_f32_16x16x32_bf16 v[136:139], a[88:91], a[40:43], v[136:139]
  v_exp_f32 v132, v132
  v_mfma_f32_16x16x32_bf16 v[136:139], a[92:95], a[44:47], v[136:139]
  ds_read_b64_tr_b16 a[174:175], v183 offset:52224
  ds_read_b128 a[76:79], v175 offset:50176
  v_mfma_f32_16x16x32_bf16 v[140:143], a[96:99], a[32:35], v[152:155]
  v_cvt_pk_bf16_f32 v128, v128, v129
  v_cvt_pk_bf16_f32 v129, v130, v131
  v_mfma_f32_16x16x32_bf16 v[140:143], a[100:103], a[36:39], v[140:143]
  v_exp_f32 v133, v133
  v_mfma_f32_16x16x32_bf16 v[140:143], a[104:107], a[40:43], v[140:143]
  v_exp_f32 v134, v134
  v_mfma_f32_16x16x32_bf16 v[140:143], a[108:111], a[44:47], v[140:143]
  v_exp_f32 v135, v135
  s_waitcnt lgkmcnt(1)
  v_mfma_f32_16x16x32_bf16 v[0:3], a[144:147], v[120:123], v[0:3]
  v_cvt_pk_bf16_f32 v130, v132, v133
  v_cvt_pk_bf16_f32 v131, v134, v135
  v_mfma_f32_16x16x32_bf16 v[4:7], a[148:151], v[120:123], v[4:7]
  v_mfma_f32_16x16x32_bf16 v[8:11], a[152:155], v[120:123], v[8:11]
  v_mfma_f32_16x16x32_bf16 v[12:15], a[156:159], v[120:123], v[12:15]
  v_mfma_f32_16x16x32_bf16 v[16:19], a[160:163], v[120:123], v[16:19]
  v_exp_f32 v136, v136
  v_mfma_f32_16x16x32_bf16 v[20:23], a[164:167], v[120:123], v[20:23]
  v_exp_f32 v137, v137
  v_mfma_f32_16x16x32_bf16 v[24:27], a[168:171], v[120:123], v[24:27]
  s_sub_u32 s43, s43, 1
  v_exp_f32 v138, v138
  v_mfma_f32_16x16x32_bf16 v[28:31], a[172:175], v[120:123], v[28:31]
  s_cmp_lg_u32 s43, 0
  v_exp_f32 v139, v139
  v_mfma_f32_16x16x32_bf16 v[156:159], v[160:163], v[120:123], v[156:159]
  v_exp_f32 v140, v140
  s_cbranch_scc1 K1_loop
  s_waitcnt lgkmcnt(0)
  v_mfma_f32_16x16x32_bf16 v[96:99], a[48:51], a[0:3], v[144:147]
  v_cvt_pk_bf16_f32 v136, v136, v137
  v_cvt_pk_bf16_f32 v137, v138, v139
  v_mfma_f32_16x16x32_bf16 v[96:99], a[52:55], a[4:7], v[96:99]
  v_exp_f32 v141, v141
  v_mfma_f32_16x16x32_bf16 v[96:99], a[56:59], a[8:11], v[96:99]
  v_exp_f32 v142, v142
  v_mfma_f32_16x16x32_bf16 v[96:99], a[60:63], a[12:15], v[96:99]
  v_exp_f32 v143, v143
  v_mfma_f32_16x16x32_bf16 v[100:103], a[64:67], a[0:3], v[144:147]
  s_waitcnt vmcnt(4) lgkmcnt(0)
  s_barrier
  v_mfma_f32_16x16x32_bf16 v[100:103], a[68:71], a[4:7], v[100:103]
  v_cvt_pk_bf16_f32 v138, v140, v141
  v_cvt_pk_bf16_f32 v139, v142, v143
  v_mfma_f32_16x16x32_bf16 v[100:103], a[72:75], a[8:11], v[100:103]
  ds_read_b64_tr_b16 a[112:113], v176
  ds_read_b64_tr_b16 a[114:115], v176 offset:1024
  v_mfma_f32_16x16x32_bf16 v[100:103], a[76:79], a[12:15], v[100:103]
  v_mfma_f32_16x16x32_bf16 v[32:35], a[144:147], v[128:131], v[32:35]
  v_mfma_f32_16x16x32_bf16 v[36:39], a[148:151], v[128:131], v[36:39]
  ds_read_b64_tr_b16 a[116:117], v177
  ds_read_b64_tr_b16 a[118:119], v177 offset:1024
  v_mfma_f32_16x16x32_bf16 v[40:43], a[152:155], v[128:131], v[40:43]
  v_mfma_f32_16x16x32_bf16 v[44:47], a[156:159], v[128:131], v[44:47]
  v_mfma_f32_16x16x32_bf16 v[48:51], a[160:163], v[128:131], v[48:51]
  ds_read_b64_tr_b16 a[120:121], v178
  ds_read_b64_tr_b16 a[122:123], v178 offset:1024
  v_mfma_f32_16x16x32_bf16 v[52:55], a[164:167], v[128:131], v[52:55]
  v_exp_f32 v96, v96
  v_mfma_f32_16x16x32_bf16 v[56:59], a[168:171], v[128:131], v[56:59]
  v_exp_f32 v97, v97
  v_mfma_f32_16x16x32_bf16 v[60:63], a[172:175], v[128:131], v[60:63]
  ds_read_b64_tr_b16 a[124:125], v179
  ds_read_b64_tr_b16 a[126:127], v179 offset:1024
  v_mfma_f32_16x16x32_bf16 v[156:159], v[164:167], v[128:131], v[156:159]
  v_exp_f32 v98, v98
  v_mfma_f32_16x16x32_bf16 v[104:107], a[48:51], a[16:19], v[148:151]
  v_exp_f32 v99, v99
  v_mfma_f32_16x16x32_bf16 v[104:107], a[52:55], a[20:23], v[104:107]
  ds_read_b64_tr_b16 a[128:129], v180
  ds_read_b128 a[80:83], v172 offset:51200
  v_mfma_f32_16x16x32_bf16 v[104:107], a[56:59], a[24:27], v[104:107]
  v_exp_f32 v100, v100
  v_mfma_f32_16x16x32_bf16 v[104:107], a[60:63], a[28:31], v[104:107]
  v_cvt_pk_bf16_f32 v96, v96, v97
  v_cvt_pk_bf16_f32 v97, v98, v99
  v_mfma_f32_16x16x32_bf16 v[108:111], a[64:67], a[16:19], v[148:151]
  ds_read_b64_tr_b16 a[130:131], v180 offset:1024
  ds_read_b128 a[84:87], v173 offset:51200
  v_mfma_f32_16x16x32_bf16 v[108:111], a[68:71], a[20:23], v[108:111]
  v_exp_f32 v101, v101
  v_mfma_f32_16x16x32_bf16 v[108:111], a[72:75], a[24:27], v[108:111]
  v_exp_f32 v102, v102
  v_mfma_f32_16x16x32_bf16 v[108:111], a[76:79], a[28:31], v[108:111]
  ds_read_b64_tr_b16 a[132:133], v181
  ds_read_b128 a[88:91], v174 offset:51200
  v_mfma_f32_16x16x32_bf16 v[64:67], a[144:147], v[136:139], v[64:67]
  v_exp_f32 v103, v103
  v_mfma_f32_16x16x32_bf16 v[68:71], a[148:151], v[136:139], v[68:71]
  v_cvt_pk_bf16_f32 v98, v100, v101
  v_cvt_pk_bf16_f32 v99, v102, v103
  v_mfma_f32_16x16x32_bf16 v[72:75], a[152:155], v[136:139], v[72:75]
  ds_read_b64_tr_b16 a[134:135], v181 offset:1024
  ds_read_b128 a[92:95], v175 offset:51200
  v_mfma_f32_16x16x32_bf16 v[76:79], a[156:159], v[136:139], v[76:79]
  v_mfma_f32_16x16x32_bf16 v[80:83], a[160:163], v[136:139], v[80:83]
  v_exp_f32 v104, v104
  v_mfma_f32_16x16x32_bf16 v[84:87], a[164:167], v[136:139], v[84:87]
  ds_read_b64_tr_b16 a[136:137], v182
  ds_read_b128 a[96:99], v172 offset:52224
  v_mfma_f32_16x16x32_bf16 v[88:91], a[168:171], v[136:139], v[88:91]
  v_exp_f32 v105, v105
  v_mfma_f32_16x16x32_bf16 v[92:95], a[172:175], v[136:139], v[92:95]
  v_exp_f32 v106, v106
  v_mfma_f32_16x16x32_bf16 v[156:159], v[168:171], v[136:139], v[156:159]
  ds_read_b64_tr_b16 a[138:139], v182 offset:1024
  ds_read_b128 a[100:103], v173 offset:52224
  v_mfma_f32_16x16x32_bf16 v[112:115], a[48:51], a[32:35], v[152:155]
  v_exp_f32 v107, v107
  v_mfma_f32_16x16x32_bf16 v[112:115], a[52:55], a[36:39], v[112:115]
  v_exp_f32 v108, v108
  v_mfma_f32_16x16x32_bf16 v[112:115], a[56:59], a[40:43], v[112:115]
  ds_read_b64_tr_b16 a[140:141], v183
  ds_read_b128 a[104:107], v174 offset:52224
  v_mfma_f32_16x16x32_bf16 v[112:115], a[60:63], a[44:47], v[112:115]
  v_cvt_pk_bf16_f32 v104, v104, v105
  v_cvt_pk_bf16_f32 v105, v106, v107
  v_mfma_f32_16x16x32_bf16 v[116:119], a[64:67], a[32:35], v[152:155]
  v_exp_f32 v109, v109
  v_mfma_f32_16x16x32_bf16 v[116:119], a[68:71], a[36:39], v[116:119]
  ds_read_b64_tr_b16 a[142:143], v183 offset:1024
  ds_read_b128 a[108:111], v175 offset:52224
  v_mfma_f32_16x16x32_bf16 v[116:119], a[72:75], a[40:43], v[116:119]
  v_exp_f32 v110, v110
  v_mfma_f32_16x16x32_bf16 v[116:119], a[76:79], a[44:47], v[116:119]
  v_exp_f32 v111, v111
  s_waitcnt lgkmcnt(15)
  v_mfma_f32_16x16x32_bf16 v[0:3], a[112:115], v[96:99], v[0:3]
  v_cvt_pk_bf16_f32 v106, v108, v109
  v_cvt_pk_bf16_f32 v107, v110, v111
  v_mfma_f32_16x16x32_bf16 v[4:7], a[116:119], v[96:99], v[4:7]
  v_mfma_f32_16x16x32_bf16 v[8:11], a[120:123], v[96:99], v[8:11]
  v_mfma_f32_16x16x32_bf16 v[12:15], a[124:127], v[96:99], v[12:15]
  s_waitcnt lgkmcnt(0)
  v_mfma_f32_16x16x32_bf16 v[16:19], a[128:131], v[96:99], v[16:19]
  s_add_u32 m0, s45, 16384
  v_exp_f32 v112, v112
  v_mfma_f32_16x16x32_bf16 v[20:23], a[132:135], v[96:99], v[20:23]
  buffer_load_dwordx4 v184, s[24:27], s41 offen nt lds
  v_mfma_f32_16x16x32_bf16 v[24:27], a[136:139], v[96:99], v[24:27]
  v_exp_f32 v113, v113
  v_mfma_f32_16x16x32_bf16 v[28:31], a[140:143], v[96:99], v[28:31]
  v_exp_f32 v114, v114
  v_mfma_f32_16x16x32_bf16 v[156:159], v[160:163], v[96:99], v[156:159]
  buffer_load_dwordx4 v184, s[24:27], s41 offen offset:1024 nt lds
  ds_read_b64_tr_b16 a[144:145], v176 offset:2048
  ds_read_b64_tr_b16 a[146:147], v176 offset:3072
  v_mfma_f32_16x16x32_bf16 v[120:123], a[80:83], a[0:3], v[144:147]
  v_exp_f32 v115, v115
  v_mfma_f32_16x16x32_bf16 v[120:123], a[84:87], a[4:7], v[120:123]
  v_exp_f32 v116, v116
  v_mfma_f32_16x16x32_bf16 v[120:123], a[88:91], a[8:11], v[120:123]
  buffer_load_dwordx4 v184, s[24:27], s41 offen offset:2048 nt lds
  ds_read_b64_tr_b16 a[148:149], v177 offset:2048
  ds_read_b64_tr_b16 a[150:151], v177 offset:3072
  v_mfma_f32_16x16x32_bf16 v[120:123], a[92:95], a[12:15], v[120:123]
  v_cvt_pk_bf16_f32 v112, v112, v113
  v_cvt_pk_bf16_f32 v113, v114, v115
  v_mfma_f32_16x16x32_bf16 v[124:127], a[96:99], a[0:3], v[144:147]
  v_exp_f32 v117, v117
  v_mfma_f32_16x16x32_bf16 v[124:127], a[100:103], a[4:7], v[124:127]
  buffer_load_dwordx4 v184, s[24:27], s41 offen offset:3072 nt lds
  v_mfma_f32_16x16x32_bf16 v[124:127], a[104:107], a[8:11], v[124:127]
  s_add_u32 s41, s41, 16384
  ds_read_b64_tr_b16 a[152:153], v178 offset:2048
  ds_read_b64_tr_b16 a[154:155], v178 offset:3072
  v_mfma_f32_16x16x32_bf16 v[124:127], a[108:111], a[12:15], v[124:127]
  s_add_u32 m0, s45, 98304
  v_exp_f32 v118, v118
  v_mfma_f32_16x16x32_bf16 v[32:35], a[112:115], v[104:107], v[32:35]
  buffer_load_dwordx4 v185, s[28:31], s42 offen nt lds
  v_mfma_f32_16x16x32_bf16 v[36:39], a[116:119], v[104:107], v[36:39]
  ds_read_b64_tr_b16 a[156:157], v179 offset:2048
  ds_read_b64_tr_b16 a[158:159], v179 offset:3072
  v_mfma_f32_16x16x32_bf16 v[40:43], a[120:123], v[104:107], v[40:43]
  v_exp_f32 v119, v119
  v_mfma_f32_16x16x32_bf16 v[44:47], a[124:127], v[104:107], v[44:47]
  buffer_load_dwordx4 v185, s[28:31], s42 offen offset:1024 nt lds
  v_mfma_f32_16x16x32_bf16 v[48:51], a[128:131], v[104:107], v[48:51]
  v_cvt_pk_bf16_f32 v114, v116, v117
  v_cvt_pk_bf16_f32 v115, v118, v119
  v_mfma_f32_16x16x32_bf16 v[52:55], a[132:135], v[104:107], v[52:55]
  ds_read_b64_tr_b16 a[160:161], v180 offset:2048
  ds_read_b128 a[48:51], v172 offset:32768
  v_mfma_f32_16x16x32_bf16 v[56:59], a[136:139], v[104:107], v[56:59]
  buffer_load_dwordx4 v185, s[28:31], s42 offen offset:2048 nt lds
  v_mfma_f32_16x16x32_bf16 v[60:63], a[140:143], v[104:107], v[60:63]
  v_exp_f32 v120, v120
  v_mfma_f32_16x16x32_bf16 v[156:159], v[164:167], v[104:107], v[156:159]
  ds_read_b64_tr_b16 a[162:163], v180 offset:3072
  ds_read_b128 a[52:55], v173 offset:32768
  v_mfma_f32_16x16x32_bf16 v[128:131], a[80:83], a[16:19], v[148:151]
  buffer_load_dwordx4 v185, s[28:31], s42 offen offset:3072 nt lds
  v_mfma_f32_16x16x32_bf16 v[128:131], a[84:87], a[20:23], v[128:131]
  s_add_u32 s42, s42, 16384
  v_exp_f32 v121, v121
  v_mfma_f32_16x16x32_bf16 v[128:131], a[88:91], a[24:27], v[128:131]
  v_exp_f32 v122, v122
  v_mfma_f32_16x16x32_bf16 v[128:131], a[92:95], a[28:31], v[128:131]
  ds_read_b64_tr_b16 a[164:165], v181 offset:2048
  ds_read_b128 a[56:59], v174 offset:32768
  v_mfma_f32_16x16x32_bf16 v[132:135], a[96:99], a[16:19], v[148:151]
  v_exp_f32 v123, v123
  v_mfma_f32_16x16x32_bf16 v[132:135], a[100:103], a[20:23], v[132:135]
  v_exp_f32 v124, v124
  v_mfma_f32_16x16x32_bf16 v[132:135], a[104:107], a[24:27], v[132:135]
  ds_read_b64_tr_b16 a[166:167], v181 offset:3072
  ds_read_b128 a[60:63], v175 offset:32768
  v_mfma_f32_16x16x32_bf16 v[132:135], a[108:111], a[28:31], v[132:135]
  v_cvt_pk_bf16_f32 v120, v120, v121
  v_cvt_pk_bf16_f32 v121, v122, v123
  v_mfma_f32_16x16x32_bf16 v[64:67], a[112:115], v[112:115], v[64:67]
  v_exp_f32 v125, v125
  v_mfma_f32_16x16x32_bf16 v[68:71], a[116:119], v[112:115], v[68:71]
  v_exp_f32 v126, v126
  v_mfma_f32_16x16x32_bf16 v[72:75], a[120:123], v[112:115], v[72:75]
  ds_read_b64_tr_b16 a[168:169], v182 offset:2048
  ds_read_b128 a[64:67], v172 offset:33792
  v_mfma_f32_16x16x32_bf16 v[76:79], a[124:127], v[112:115], v[76:79]
  v_exp_f32 v127, v127
  v_mfma_f32_16x16x32_bf16 v[80:83], a[128:131], v[112:115], v[80:83]
  v_cvt_pk_bf16_f32 v122, v124, v125
  v_cvt_pk_bf16_f32 v123, v126, v127
  v_mfma_f32_16x16x32_bf16 v[84:87], a[132:135], v[112:115], v[84:87]
  ds_read_b64_tr_b16 a[170:171], v182 offset:3072
  ds_read_b128 a[68:71], v173 offset:33792
  v_mfma_f32_16x16x32_bf16 v[88:91], a[136:139], v[112:115], v[88:91]
  v_exp_f32 v128, v128
  v_mfma_f32_16x16x32_bf16 v[92:95], a[140:143], v[112:115], v[92:95]
  v_exp_f32 v129, v129
  v_mfma_f32_16x16x32_bf16 v[156:159], v[168:171], v[112:115], v[156:159]
  v_exp_f32 v130, v130
  v_mfma_f32_16x16x32_bf16 v[136:139], a[80:83], a[32:35], v[152:155]
  ds_read_b64_tr_b16 a[172:173], v183 offset:2048
  ds_read_b128 a[72:75], v174 offset:33792
  v_mfma_f32_16x16x32_bf16 v[136:139], a[84:87], a[36:39], v[136:139]
  v_exp_f32 v131, v131
  v_mfma_f32_16x16x32_bf16 v[136:139], a[88:91], a[40:43], v[136:139]
  v_exp_f32 v132, v132
  v_mfma_f32_16x16x32_bf16 v[136:139], a[92:95], a[44:47], v[136:139]
  ds_read_b64_tr_b16 a[174:175], v183 offset:3072
  ds_read_b128 a[76:79], v175 offset:33792
  v_mfma_f32_16x16x32_bf16 v[140:143], a[96:99], a[32:35], v[152:155]
  v_cvt_pk_bf16_f32 v128, v128, v129
  v_cvt_pk_bf16_f32 v129, v130, v131
  v_mfma_f32_16x16x32_bf16 v[140:143], a[100:103], a[36:39], v[140:143]
  v_exp_f32 v133, v133
  v_mfma_f32_16x16x32_bf16 v[140:143], a[104:107], a[40:43], v[140:143]
  v_exp_f32 v134, v134
  v_mfma_f32_16x16x32_bf16 v[140:143], a[108:111], a[44:47], v[140:143]
  v_exp_f32 v135, v135
  s_waitcnt lgkmcnt(1)
  v_mfma_f32_16x16x32_bf16 v[0:3], a[144:147], v[120:123], v[0:3]
  v_cvt_pk_bf16_f32 v130, v132, v133
  v_cvt_pk_bf16_f32 v131, v134, v135
  v_mfma_f32_16x16x32_bf16 v[4:7], a[148:151], v[120:123], v[4:7]
  v_mfma_f32_16x16x32_bf16 v[8:11], a[152:155], v[120:123], v[8:11]
  v_mfma_f32_16x16x32_bf16 v[12:15], a[156:159], v[120:123], v[12:15]
  v_mfma_f32_16x16x32_bf16 v[16:19], a[160:163], v[120:123], v[16:19]
  v_exp_f32 v136, v136
  v_mfma_f32_16x16x32_bf16 v[20:23], a[164:167], v[120:123], v[20:23]
  v_exp_f32 v137, v137
  v_mfma_f32_16x16x32_bf16 v[24:27], a[168:171], v[120:123], v[24:27]
  v_exp_f32 v138, v138
  v_mfma_f32_16x16x32_bf16 v[28:31], a[172:175], v[120:123], v[28:31]
  v_exp_f32 v139, v139
  v_mfma_f32_16x16x32_bf16 v[156:159], v[160:163], v[120:123], v[156:159]
  v_exp_f32 v140, v140
  s_waitcnt lgkmcnt(0)
  v_mfma_f32_16x16x32_bf16 v[96:99], a[48:51], a[0:3], v[144:147]
  v_cvt_pk_bf16_f32 v136, v136, v137
  v_cvt_pk_bf16_f32 v137, v138, v139
  v_mfma_f32_16x16x32_bf16 v[96:99], a[52:55], a[4:7], v[96:99]
  v_exp_f32 v141, v141
  v_mfma_f32_16x16x32_bf16 v[96:99], a[56:59], a[8:11], v[96:99]
  v_exp_f32 v142, v142
  v_mfma_f32_16x16x32_bf16 v[96:99], a[60:63], a[12:15], v[96:99]
  v_exp_f32 v143, v143
  v_mfma_f32_16x16x32_bf16 v[100:103], a[64:67], a[0:3], v[144:147]
  s_waitcnt vmcnt(4)
  s_waitcnt lgkmcnt(0)
  s_barrier
  v_mfma_f32_16x16x32_bf16 v[100:103], a[68:71], a[4:7], v[100:103]
  v_cvt_pk_bf16_f32 v138, v140, v141
  v_cvt_pk_bf16_f32 v139, v142, v143
  v_mfma_f32_16x16x32_bf16 v[100:103], a[72:75], a[8:11], v[100:103]
  ds_read_b64_tr_b16 a[112:113], v176 offset:16384
  ds_read_b64_tr_b16 a[114:115], v176 offset:17408
  v_mfma_f32_16x16x32_bf16 v[100:103], a[76:79], a[12:15], v[100:103]
  v_mfma_f32_16x16x32_bf16 v[32:35], a[144:147], v[128:131], v[32:35]
  v_mfma_f32_16x16x32_bf16 v[36:39], a[148:151], v[128:131], v[36:39]
  ds_read_b64_tr_b16 a[116:117], v177 offset:16384
  ds_read_b64_tr_b16 a[118:119], v177 offset:17408
  v_mfma_f32_16x16x32_bf16 v[40:43], a[152:155], v[128:131], v[40:43]
  v_mfma_f32_16x16x32_bf16 v[44:47], a[156:159], v[128:131], v[44:47]
  v_mfma_f32_16x16x32_bf16 v[48:51], a[160:163], v[128:131], v[48:51]
  ds_read_b64_tr_b16 a[120:121], v178 offset:16384
  ds_read_b64_tr_b16 a[122:123], v178 offset:17408
  v_mfma_f32_16x16x32_bf16 v[52:55], a[164:167], v[128:131], v[52:55]
  v_exp_f32 v96, v96
  v_mfma_f32_16x16x32_bf16 v[56:59], a[168:171], v[128:131], v[56:59]
  v_exp_f32 v97, v97
  v_mfma_f32_16x16x32_bf16 v[60:63], a[172:175], v[128:131], v[60:63]
  ds_read_b64_tr_b16 a[124:125], v179 offset:16384
  ds_read_b64_tr_b16 a[126:127], v179 offset:17408
  v_mfma_f32_16x16x32_bf16 v[156:159], v[164:167], v[128:131], v[156:159]
  v_exp_f32 v98, v98
  v_mfma_f32_16x16x32_bf16 v[104:107], a[48:51], a[16:19], v[148:151]
  v_exp_f32 v99, v99
  v_mfma_f32_16x16x32_bf16 v[104:107], a[52:55], a[20:23], v[104:107]
  ds_read_b64_tr_b16 a[128:129], v180 offset:16384
  ds_read_b128 a[80:83], v172 offset:34816
  v_mfma_f32_16x16x32_bf16 v[104:107], a[56:59], a[24:27], v[104:107]
  v_exp_f32 v100, v100
  v_mfma_f32_16x16x32_bf16 v[104:107], a[60:63], a[28:31], v[104:107]
  v_cvt_pk_bf16_f32 v96, v96, v97
  v_cvt_pk_bf16_f32 v97, v98, v99
  v_mfma_f32_16x16x32_bf16 v[108:111], a[64:67], a[16:19], v[148:151]
  ds_read_b64_tr_b16 a[130:131], v180 offset:17408
  ds_read_b128 a[84:87], v173 offset:34816
  v_mfma_f32_16x16x32_bf16 v[108:111], a[68:71], a[20:23], v[108:111]
  v_exp_f32 v101, v101
  v_mfma_f32_16x16x32_bf16 v[108:111], a[72:75], a[24:27], v[108:111]
  v_exp_f32 v102, v102
  v_mfma_f32_16x16x32_bf16 v[108:111], a[76:79], a[28:31], v[108:111]
  ds_read_b64_tr_b16 a[132:133], v181 offset:16384
  ds_read_b128 a[88:91], v174 offset:34816
  v_mfma_f32_16x16x32_bf16 v[64:67], a[144:147], v[136:139], v[64:67]
  v_exp_f32 v103, v103
  v_mfma_f32_16x16x32_bf16 v[68:71], a[148:151], v[136:139], v[68:71]
  v_cvt_pk_bf16_f32 v98, v100, v101
  v_cvt_pk_bf16_f32 v99, v102, v103
  v_mfma_f32_16x16x32_bf16 v[72:75], a[152:155], v[136:139], v[72:75]
  ds_read_b64_tr_b16 a[134:135], v181 offset:17408
  ds_read_b128 a[92:95], v175 offset:34816
  v_mfma_f32_16x16x32_bf16 v[76:79], a[156:159], v[136:139], v[76:79]
  v_mfma_f32_16x16x32_bf16 v[80:83], a[160:163], v[136:139], v[80:83]
  v_exp_f32 v104, v104
  v_mfma_f32_16x16x32_bf16 v[84:87], a[164:167], v[136:139], v[84:87]
  ds_read_b64_tr_b16 a[136:137], v182 offset:16384
  ds_read_b128 a[96:99], v172 offset:35840
  v_mfma_f32_16x16x32_bf16 v[88:91], a[168:171], v[136:139], v[88:91]
  v_exp_f32 v105, v105
  v_mfma_f32_16x16x32_bf16 v[92:95], a[172:175], v[136:139], v[92:95]
  v_exp_f32 v106, v106
  v_mfma_f32_16x16x32_bf16 v[156:159], v[168:171], v[136:139], v[156:159]
  ds_read_b64_tr_b16 a[138:139], v182 offset:17408
  ds_read_b128 a[100:103], v173 offset:35840
  v_mfma_f32_16x16x32_bf16 v[112:115], a[48:51], a[32:35], v[152:155]
  v_exp_f32 v107, v107
  v_mfma_f32_16x16x32_bf16 v[112:115], a[52:55], a[36:39], v[112:115]
  v_exp_f32 v108, v108
  v_mfma_f32_16x16x32_bf16 v[112:115], a[56:59], a[40:43], v[112:115]
  ds_read_b64_tr_b16 a[140:141], v183 offset:16384
  ds_read_b128 a[104:107], v174 offset:35840
  v_mfma_f32_16x16x32_bf16 v[112:115], a[60:63], a[44:47], v[112:115]
  v_cvt_pk_bf16_f32 v104, v104, v105
  v_cvt_pk_bf16_f32 v105, v106, v107
  v_mfma_f32_16x16x32_bf16 v[116:119], a[64:67], a[32:35], v[152:155]
  v_exp_f32 v109, v109
  v_mfma_f32_16x16x32_bf16 v[116:119], a[68:71], a[36:39], v[116:119]
  ds_read_b64_tr_b16 a[142:143], v183 offset:17408
  ds_read_b128 a[108:111], v175 offset:35840
  v_mfma_f32_16x16x32_bf16 v[116:119], a[72:75], a[40:43], v[116:119]
  v_exp_f32 v110, v110
  v_mfma_f32_16x16x32_bf16 v[116:119], a[76:79], a[44:47], v[116:119]
  v_exp_f32 v111, v111
  s_waitcnt lgkmcnt(15)
  v_mfma_f32_16x16x32_bf16 v[0:3], a[112:115], v[96:99], v[0:3]
  v_cvt_pk_bf16_f32 v106, v108, v109
  v_cvt_pk_bf16_f32 v107, v110, v111
  v_mfma_f32_16x16x32_bf16 v[4:7], a[116:119], v[96:99], v[4:7]
  v_mfma_f32_16x16x32_bf16 v[8:11], a[120:123], v[96:99], v[8:11]
  v_mfma_f32_16x16x32_bf16 v[12:15], a[124:127], v[96:99], v[12:15]
  s_waitcnt lgkmcnt(0)
  v_mfma_f32_16x16x32_bf16 v[16:19], a[128:131], v[96:99], v[16:19]
  s_add_u32 m0, s45, 0
  v_exp_f32 v112, v112
  v_mfma_f32_16x16x32_bf16 v[20:23], a[132:135], v[96:99], v[20:23]
  buffer_load_dwordx4 v184, s[24:27], s41 offen nt lds
  v_mfma_f32_16x16x32_bf16 v[24:27], a[136:139], v[96:99], v[24:27]
  v_exp_f32 v113, v113
  v_mfma_f32_16x16x32_bf16 v[28:31], a[140:143], v[96:99], v[28:31]
  v_exp_f32 v114, v114
  v_mfma_f32_16x16x32_bf16 v[156:159], v[160:163], v[96:99], v[156:159]
  buffer_load_dwordx4 v184, s[24:27], s41 offen offset:1024 nt lds
  ds_read_b64_tr_b16 a[144:145], v176 offset:18432
  ds_read_b64_tr_b16 a[146:147], v176 offset:19456
  v_mfma_f32_16x16x32_bf16 v[120:123], a[80:83], a[0:3], v[144:147]
  v_exp_f32 v115, v115
  v_mfma_f32_16x16x32_bf16 v[120:123], a[84:87], a[4:7], v[120:123]
  v_exp_f32 v116, v116
  v_mfma_f32_16x16x32_bf16 v[120:123], a[88:91], a[8:11], v[120:123]
  buffer_load_dwordx4 v184, s[24:27], s41 offen offset:2048 nt lds
  ds_read_b64_tr_b16 a[148:149], v177 offset:18432
  ds_read_b64_tr_b16 a[150:151], v177 offset:19456
  v_mfma_f32_16x16x32_bf16 v[120:123], a[92:95], a[12:15], v[120:123]
  v_cvt_pk_bf16_f32 v112, v112, v113
  v_cvt_pk_bf16_f32 v113, v114, v115
  v_mfma_f32_16x16x32_bf16 v[124:127], a[96:99], a[0:3], v[144:147]
  v_exp_f32 v117, v117
  v_mfma_f32_16x16x32_bf16 v[124:127], a[100:103], a[4:7], v[124:127]
  buffer_load_dwordx4 v184, s[24:27], s41 offen offset:3072 nt lds
  v_mfma_f32_16x16x32_bf16 v[124:127], a[104:107], a[8:11], v[124:127]
  s_add_u32 s41, s41, 16384
  ds_read_b64_tr_b16 a[152:153], v178 offset:18432
  ds_read_b64_tr_b16 a[154:155], v178 offset:19456
  v_mfma_f32_16x16x32_bf16 v[124:127], a[108:111], a[12:15], v[124:127]
  s_add_u32 m0, s45, 114688
  v_exp_f32 v118, v118
  v_mfma_f32_16x16x32_bf16 v[32:35], a[112:115], v[104:107], v[32:35]
  buffer_load_dwordx4 v185, s[28:31], s42 offen nt lds
  v_mfma_f32_16x16x32_bf16 v[36:39], a[116:119], v[104:107], v[36:39]
  ds_read_b64_tr_b16 a[156:157], v179 offset:18432
  ds_read_b64_tr_b16 a[158:159], v179 offset:19456
  v_mfma_f32_16x16x32_bf16 v[40:43], a[120:123], v[104:107], v[40:43]
  v_exp_f32 v119, v119
  v_mfma_f32_16x16x32_bf16 v[44:47], a[124:127], v[104:107], v[44:47]
  buffer_load_dwordx4 v185, s[28:31], s42 offen offset:1024 nt lds
  v_mfma_f32_16x16x32_bf16 v[48:51], a[128:131], v[104:107], v[48:51]
  v_cvt_pk_bf16_f32 v114, v116, v117
  v_cvt_pk_bf16_f32 v115, v118, v119
  v_mfma_f32_16x16x32_bf16 v[52:55], a[132:135], v[104:107], v[52:55]
  ds_read_b64_tr_b16 a[160:161], v180 offset:18432
  ds_read_b128 a[48:51], v172 offset:16384
  v_mfma_f32_16x16x32_bf16 v[56:59], a[136:139], v[104:107], v[56:59]
  buffer_load_dwordx4 v185, s[28:31], s42 offen offset:2048 nt lds
  v_mfma_f32_16x16x32_bf16 v[60:63], a[140:143], v[104:107], v[60:63]
  v_exp_f32 v120, v120
  v_mfma_f32_16x16x32_bf16 v[156:159], v[164:167], v[104:107], v[156:159]
  ds_read_b64_tr_b16 a[162:163], v180 offset:19456
  ds_read_b128 a[52:55], v173 offset:16384
  v_mfma_f32_16x16x32_bf16 v[128:131], a[80:83], a[16:19], v[148:151]
  buffer_load_dwordx4 v185, s[28:31], s42 offen offset:3072 nt lds
  v_mfma_f32_16x16x32_bf16 v[128:131], a[84:87], a[20:23], v[128:131]
  s_add_u32 s42, s42, 16384
  v_exp_f32 v121, v121
  v_mfma_f32_16x16x32_bf16 v[128:131], a[88:91], a[24:27], v[128:131]
  v_exp_f32 v122, v122
  v_mfma_f32_16x16x32_bf16 v[128:131], a[92:95], a[28:31], v[128:131]
  buffer_load_dword v249, v248, s[92:95], s77 offen
  ds_read_b64_tr_b16 a[164:165], v181 offset:18432
  ds_read_b128 a[56:59], v174 offset:16384
  v_mfma_f32_16x16x32_bf16 v[132:135], a[96:99], a[16:19], v[148:151]
  v_exp_f32 v123, v123
  v_mfma_f32_16x16x32_bf16 v[132:135], a[100:103], a[20:23], v[132:135]
  v_exp_f32 v124, v124
  v_mfma_f32_16x16x32_bf16 v[132:135], a[104:107], a[24:27], v[132:135]
  buffer_load_dword v250, v248, s[92:95], s77 offen offset:256
  ds_read_b64_tr_b16 a[166:167], v181 offset:19456
  ds_read_b128 a[60:63], v175 offset:16384
  v_mfma_f32_16x16x32_bf16 v[132:135], a[108:111], a[28:31], v[132:135]
  v_cvt_pk_bf16_f32 v120, v120, v121
  v_cvt_pk_bf16_f32 v121, v122, v123
  v_mfma_f32_16x16x32_bf16 v[64:67], a[112:115], v[112:115], v[64:67]
  v_exp_f32 v125, v125
  v_mfma_f32_16x16x32_bf16 v[68:71], a[116:119], v[112:115], v[68:71]
  buffer_load_dword v251, v248, s[92:95], s77 offen offset:384
  v_exp_f32 v126, v126
  v_mfma_f32_16x16x32_bf16 v[72:75], a[120:123], v[112:115], v[72:75]
  ds_read_b64_tr_b16 a[168:169], v182 offset:18432
  ds_read_b128 a[64:67], v172 offset:17408
  v_mfma_f32_16x16x32_bf16 v[76:79], a[124:127], v[112:115], v[76:79]
  v_exp_f32 v127, v127
  v_mfma_f32_16x16x32_bf16 v[80:83], a[128:131], v[112:115], v[80:83]
  v_cvt_pk_bf16_f32 v122, v124, v125
  v_cvt_pk_bf16_f32 v123, v126, v127
  v_mfma_f32_16x16x32_bf16 v[84:87], a[132:135], v[112:115], v[84:87]
  ds_read_b64_tr_b16 a[170:171], v182 offset:19456
  ds_read_b128 a[68:71], v173 offset:17408
  v_mfma_f32_16x16x32_bf16 v[88:91], a[136:139], v[112:115], v[88:91]
  v_exp_f32 v128, v128
  v_mfma_f32_16x16x32_bf16 v[92:95], a[140:143], v[112:115], v[92:95]
  v_exp_f32 v129, v129
  v_mfma_f32_16x16x32_bf16 v[156:159], v[168:171], v[112:115], v[156:159]
  v_exp_f32 v130, v130
  v_mfma_f32_16x16x32_bf16 v[136:139], a[80:83], a[32:35], v[152:155]
  ds_read_b64_tr_b16 a[172:173], v183 offset:18432
  ds_read_b128 a[72:75], v174 offset:17408
  v_mfma_f32_16x16x32_bf16 v[136:139], a[84:87], a[36:39], v[136:139]
  v_exp_f32 v131, v131
  v_mfma_f32_16x16x32_bf16 v[136:139], a[88:91], a[40:43], v[136:139]
  v_exp_f32 v132, v132
  v_mfma_f32_16x16x32_bf16 v[136:139], a[92:95], a[44:47], v[136:139]
  ds_read_b64_tr_b16 a[174:175], v183 offset:19456
  ds_read_b128 a[76:79], v175 offset:17408
  v_mfma_f32_16x16x32_bf16 v[140:143], a[96:99], a[32:35], v[152:155]
  v_cvt_pk_bf16_f32 v128, v128, v129
  v_cvt_pk_bf16_f32 v129, v130, v131
  v_mfma_f32_16x16x32_bf16 v[140:143], a[100:103], a[36:39], v[140:143]
  v_exp_f32 v133, v133
  v_mfma_f32_16x16x32_bf16 v[140:143], a[104:107], a[40:43], v[140:143]
  v_exp_f32 v134, v134
  v_mfma_f32_16x16x32_bf16 v[140:143], a[108:111], a[44:47], v[140:143]
  v_exp_f32 v135, v135
  s_waitcnt lgkmcnt(1)
  v_mfma_f32_16x16x32_bf16 v[0:3], a[144:147], v[120:123], v[0:3]
  v_cvt_pk_bf16_f32 v130, v132, v133
  v_cvt_pk_bf16_f32 v131, v134, v135
  v_mfma_f32_16x16x32_bf16 v[4:7], a[148:151], v[120:123], v[4:7]
  v_mfma_f32_16x16x32_bf16 v[8:11], a[152:155], v[120:123], v[8:11]
  v_mfma_f32_16x16x32_bf16 v[12:15], a[156:159], v[120:123], v[12:15]
  v_mfma_f32_16x16x32_bf16 v[16:19], a[160:163], v[120:123], v[16:19]
  v_exp_f32 v136, v136
  v_mfma_f32_16x16x32_bf16 v[20:23], a[164:167], v[120:123], v[20:23]
  v_exp_f32 v137, v137
  v_mfma_f32_16x16x32_bf16 v[24:27], a[168:171], v[120:123], v[24:27]
  v_exp_f32 v138, v138
  v_mfma_f32_16x16x32_bf16 v[28:31], a[172:175], v[120:123], v[28:31]
  v_exp_f32 v139, v139
  v_mfma_f32_16x16x32_bf16 v[156:159], v[160:163], v[120:123], v[156:159]
  v_exp_f32 v140, v140
  s_waitcnt lgkmcnt(0)
  v_mfma_f32_16x16x32_bf16 v[96:99], a[48:51], a[0:3], v[144:147]
  v_cvt_pk_bf16_f32 v136, v136, v137
  v_cvt_pk_bf16_f32 v137, v138, v139
  v_mfma_f32_16x16x32_bf16 v[96:99], a[52:55], a[4:7], v[96:99]
  v_exp_f32 v141, v141
  v_mfma_f32_16x16x32_bf16 v[96:99], a[56:59], a[8:11], v[96:99]
  v_exp_f32 v142, v142
  v_mfma_f32_16x16x32_bf16 v[96:99], a[60:63], a[12:15], v[96:99]
  v_exp_f32 v143, v143
  v_mfma_f32_16x16x32_bf16 v[100:103], a[64:67], a[0:3], v[144:147]
  s_waitcnt vmcnt(7)
  s_waitcnt lgkmcnt(0)
  s_barrier
  v_mfma_f32_16x16x32_bf16 v[100:103], a[68:71], a[4:7], v[100:103]
  v_cvt_pk_bf16_f32 v138, v140, v141
  v_cvt_pk_bf16_f32 v139, v142, v143
  v_mfma_f32_16x16x32_bf16 v[100:103], a[72:75], a[8:11], v[100:103]
  ds_read_b64_tr_b16 a[112:113], v176 offset:32768
  ds_read_b64_tr_b16 a[114:115], v176 offset:33792
  v_mfma_f32_16x16x32_bf16 v[100:103], a[76:79], a[12:15], v[100:103]
  v_mfma_f32_16x16x32_bf16 v[32:35], a[144:147], v[128:131], v[32:35]
  v_mfma_f32_16x16x32_bf16 v[36:39], a[148:151], v[128:131], v[36:39]
  ds_read_b64_tr_b16 a[116:117], v177 offset:32768
  ds_read_b64_tr_b16 a[118:119], v177 offset:33792
  v_mfma_f32_16x16x32_bf16 v[40:43], a[152:155], v[128:131], v[40:43]
  v_mfma_f32_16x16x32_bf16 v[44:47], a[156:159], v[128:131], v[44:47]
  v_mfma_f32_16x16x32_bf16 v[48:51], a[160:163], v[128:131], v[48:51]
  ds_read_b64_tr_b16 a[120:121], v178 offset:32768
  ds_read_b64_tr_b16 a[122:123], v178 offset:33792
  v_mfma_f32_16x16x32_bf16 v[52:55], a[164:167], v[128:131], v[52:55]
  v_exp_f32 v96, v96
  v_mfma_f32_16x16x32_bf16 v[56:59], a[168:171], v[128:131], v[56:59]
  v_exp_f32 v97, v97
  v_mfma_f32_16x16x32_bf16 v[60:63], a[172:175], v[128:131], v[60:63]
  ds_read_b64_tr_b16 a[124:125], v179 offset:32768
  ds_read_b64_tr_b16 a[126:127], v179 offset:33792
  v_mfma_f32_16x16x32_bf16 v[156:159], v[164:167], v[128:131], v[156:159]
  v_exp_f32 v98, v98
  v_mfma_f32_16x16x32_bf16 v[104:107], a[48:51], a[16:19], v[148:151]
  v_exp_f32 v99, v99
  v_mfma_f32_16x16x32_bf16 v[104:107], a[52:55], a[20:23], v[104:107]
  ds_read_b64_tr_b16 a[128:129], v180 offset:32768
  ds_read_b128 a[80:83], v172 offset:18432
  v_mfma_f32_16x16x32_bf16 v[104:107], a[56:59], a[24:27], v[104:107]
  v_exp_f32 v100, v100
  v_mfma_f32_16x16x32_bf16 v[104:107], a[60:63], a[28:31], v[104:107]
  v_cvt_pk_bf16_f32 v96, v96, v97
  v_cvt_pk_bf16_f32 v97, v98, v99
  v_mfma_f32_16x16x32_bf16 v[108:111], a[64:67], a[16:19], v[148:151]
  ds_read_b64_tr_b16 a[130:131], v180 offset:33792
  ds_read_b128 a[84:87], v173 offset:18432
  v_mfma_f32_16x16x32_bf16 v[108:111], a[68:71], a[20:23], v[108:111]
  v_exp_f32 v101, v101
  v_mfma_f32_16x16x32_bf16 v[108:111], a[72:75], a[24:27], v[108:111]
  v_exp_f32 v102, v102
  v_mfma_f32_16x16x32_bf16 v[108:111], a[76:79], a[28:31], v[108:111]
  ds_read_b64_tr_b16 a[132:133], v181 offset:32768
  ds_read_b128 a[88:91], v174 offset:18432
  v_mfma_f32_16x16x32_bf16 v[64:67], a[144:147], v[136:139], v[64:67]
  v_exp_f32 v103, v103
  v_mfma_f32_16x16x32_bf16 v[68:71], a[148:151], v[136:139], v[68:71]
  v_cvt_pk_bf16_f32 v98, v100, v101
  v_cvt_pk_bf16_f32 v99, v102, v103
  v_mfma_f32_16x16x32_bf16 v[72:75], a[152:155], v[136:139], v[72:75]
  ds_read_b64_tr_b16 a[134:135], v181 offset:33792
  ds_read_b128 a[92:95], v175 offset:18432
  v_mfma_f32_16x16x32_bf16 v[76:79], a[156:159], v[136:139], v[76:79]
  v_mfma_f32_16x16x32_bf16 v[80:83], a[160:163], v[136:139], v[80:83]
  v_exp_f32 v104, v104
  v_mfma_f32_16x16x32_bf16 v[84:87], a[164:167], v[136:139], v[84:87]
  ds_read_b64_tr_b16 a[136:137], v182 offset:32768
  ds_read_b128 a[96:99], v172 offset:19456
  v_mfma_f32_16x16x32_bf16 v[88:91], a[168:171], v[136:139], v[88:91]
  v_exp_f32 v105, v105
  v_mfma_f32_16x16x32_bf16 v[92:95], a[172:175], v[136:139], v[92:95]
  v_exp_f32 v106, v106
  v_mfma_f32_16x16x32_bf16 v[156:159], v[168:171], v[136:139], v[156:159]
  ds_read_b64_tr_b16 a[138:139], v182 offset:33792
  ds_read_b128 a[100:103], v173 offset:19456
  v_mfma_f32_16x16x32_bf16 v[112:115], a[48:51], a[32:35], v[152:155]
  v_exp_f32 v107, v107
  v_mfma_f32_16x16x32_bf16 v[112:115], a[52:55], a[36:39], v[112:115]
  v_exp_f32 v108, v108
  v_mfma_f32_16x16x32_bf16 v[112:115], a[56:59], a[40:43], v[112:115]
  ds_read_b64_tr_b16 a[140:141], v183 offset:32768
  ds_read_b128 a[104:107], v174 offset:19456
  v_mfma_f32_16x16x32_bf16 v[112:115], a[60:63], a[44:47], v[112:115]
  v_cvt_pk_bf16_f32 v104, v104, v105
  v_cvt_pk_bf16_f32 v105, v106, v107
  v_mfma_f32_16x16x32_bf16 v[116:119], a[64:67], a[32:35], v[152:155]
  v_exp_f32 v109, v109
  v_mfma_f32_16x16x32_bf16 v[116:119], a[68:71], a[36:39], v[116:119]
  ds_read_b64_tr_b16 a[142:143], v183 offset:33792
  ds_read_b128 a[108:111], v175 offset:19456
  v_mfma_f32_16x16x32_bf16 v[116:119], a[72:75], a[40:43], v[116:119]
  v_exp_f32 v110, v110
  v_mfma_f32_16x16x32_bf16 v[116:119], a[76:79], a[44:47], v[116:119]
  v_exp_f32 v111, v111
  s_waitcnt lgkmcnt(15)
  v_mfma_f32_16x16x32_bf16 v[0:3], a[112:115], v[96:99], v[0:3]
  v_cvt_pk_bf16_f32 v106, v108, v109
  v_cvt_pk_bf16_f32 v107, v110, v111
  v_mfma_f32_16x16x32_bf16 v[4:7], a[116:119], v[96:99], v[4:7]
  v_mfma_f32_16x16x32_bf16 v[8:11], a[120:123], v[96:99], v[8:11]
  v_mfma_f32_16x16x32_bf16 v[12:15], a[124:127], v[96:99], v[12:15]
  s_waitcnt lgkmcnt(0)
  v_mfma_f32_16x16x32_bf16 v[16:19], a[128:131], v[96:99], v[16:19]
  v_exp_f32 v112, v112
  v_mfma_f32_16x16x32_bf16 v[20:23], a[132:135], v[96:99], v[20:23]
  v_mfma_f32_16x16x32_bf16 v[24:27], a[136:139], v[96:99], v[24:27]
  v_exp_f32 v113, v113
  v_mfma_f32_16x16x32_bf16 v[28:31], a[140:143], v[96:99], v[28:31]
  v_exp_f32 v114, v114
  v_mfma_f32_16x16x32_bf16 v[156:159], v[160:163], v[96:99], v[156:159]
  ds_read_b64_tr_b16 a[144:145], v176 offset:34816
  ds_read_b64_tr_b16 a[146:147], v176 offset:35840
  v_mfma_f32_16x16x32_bf16 v[120:123], a[80:83], a[0:3], v[144:147]
  v_exp_f32 v115, v115
  v_mfma_f32_16x16x32_bf16 v[120:123], a[84:87], a[4:7], v[120:123]
  v_exp_f32 v116, v116
  v_mfma_f32_16x16x32_bf16 v[120:123], a[88:91], a[8:11], v[120:123]
  ds_read_b64_tr_b16 a[148:149], v177 offset:34816
  ds_read_b64_tr_b16 a[150:151], v177 offset:35840
  v_mfma_f32_16x16x32_bf16 v[120:123], a[92:95], a[12:15], v[120:123]
  v_cvt_pk_bf16_f32 v112, v112, v113
  v_cvt_pk_bf16_f32 v113, v114, v115
  v_mfma_f32_16x16x32_bf16 v[124:127], a[96:99], a[0:3], v[144:147]
  v_exp_f32 v117, v117
  v_mfma_f32_16x16x32_bf16 v[124:127], a[100:103], a[4:7], v[124:127]
  v_mfma_f32_16x16x32_bf16 v[124:127], a[104:107], a[8:11], v[124:127]
  ds_read_b64_tr_b16 a[152:153], v178 offset:34816
  ds_read_b64_tr_b16 a[154:155], v178 offset:35840
  v_mfma_f32_16x16x32_bf16 v[124:127], a[108:111], a[12:15], v[124:127]
  v_exp_f32 v118, v118
  v_mfma_f32_16x16x32_bf16 v[32:35], a[112:115], v[104:107], v[32:35]
  v_mfma_f32_16x16x32_bf16 v[36:39], a[116:119], v[104:107], v[36:39]
  ds_read_b64_tr_b16 a[156:157], v179 offset:34816
  ds_read_b64_tr_b16 a[158:159], v179 offset:35840
  v_mfma_f32_16x16x32_bf16 v[40:43], a[120:123], v[104:107], v[40:43]
  v_exp_f32 v119, v119
  v_mfma_f32_16x16x32_bf16 v[44:47], a[124:127], v[104:107], v[44:47]
  v_mfma_f32_16x16x32_bf16 v[48:51], a[128:131], v[104:107], v[48:51]
  v_cvt_pk_bf16_f32 v114, v116, v117
  v_cvt_pk_bf16_f32 v115, v118, v119
  v_mfma_f32_16x16x32_bf16 v[52:55], a[132:135], v[104:107], v[52:55]
  ds_read_b64_tr_b16 a[160:161], v180 offset:34816
  ds_read_b128 a[48:51], v172
  v_mfma_f32_16x16x32_bf16 v[56:59], a[136:139], v[104:107], v[56:59]
  v_mfma_f32_16x16x32_bf16 v[60:63], a[140:143], v[104:107], v[60:63]
  v_exp_f32 v120, v120
  v_mfma_f32_16x16x32_bf16 v[156:159], v[164:167], v[104:107], v[156:159]
  ds_read_b64_tr_b16 a[162:163], v180 offset:35840
  ds_read_b128 a[52:55], v173
  v_mfma_f32_16x16x32_bf16 v[128:131], a[80:83], a[16:19], v[148:151]
  v_mfma_f32_16x16x32_bf16 v[128:131], a[84:87], a[20:23], v[128:131]
  v_exp_f32 v121, v121
  v_mfma_f32_16x16x32_bf16 v[128:131], a[88:91], a[24:27], v[128:131]
  v_exp_f32 v122, v122
  v_mfma_f32_16x16x32_bf16 v[128:131], a[92:95], a[28:31], v[128:131]
  ds_read_b64_tr_b16 a[164:165], v181 offset:34816
  ds_read_b128 a[56:59], v174
  v_mfma_f32_16x16x32_bf16 v[132:135], a[96:99], a[16:19], v[148:151]
  v_exp_f32 v123, v123
  v_mfma_f32_16x16x32_bf16 v[132:135], a[100:103], a[20:23], v[132:135]
  v_exp_f32 v124, v124
  v_mfma_f32_16x16x32_bf16 v[132:135], a[104:107], a[24:27], v[132:135]
  ds_read_b64_tr_b16 a[166:167], v181 offset:35840
  ds_read_b128 a[60:63], v175
  v_mfma_f32_16x16x32_bf16 v[132:135], a[108:111], a[28:31], v[132:135]
  v_cvt_pk_bf16_f32 v120, v120, v121
  v_cvt_pk_bf16_f32 v121, v122, v123
  v_mfma_f32_16x16x32_bf16 v[64:67], a[112:115], v[112:115], v[64:67]
  v_exp_f32 v125, v125
  v_mfma_f32_16x16x32_bf16 v[68:71], a[116:119], v[112:115], v[68:71]
  v_exp_f32 v126, v126
  v_mfma_f32_16x16x32_bf16 v[72:75], a[120:123], v[112:115], v[72:75]
  ds_read_b64_tr_b16 a[168:169], v182 offset:34816
  ds_read_b128 a[64:67], v172 offset:1024
  v_mfma_f32_16x16x32_bf16 v[76:79], a[124:127], v[112:115], v[76:79]
  v_exp_f32 v127, v127
  v_mfma_f32_16x16x32_bf16 v[80:83], a[128:131], v[112:115], v[80:83]
  v_cvt_pk_bf16_f32 v122, v124, v125
  v_cvt_pk_bf16_f32 v123, v126, v127
  v_mfma_f32_16x16x32_bf16 v[84:87], a[132:135], v[112:115], v[84:87]
  ds_read_b64_tr_b16 a[170:171], v182 offset:35840
  ds_read_b128 a[68:71], v173 offset:1024
  v_mfma_f32_16x16x32_bf16 v[88:91], a[136:139], v[112:115], v[88:91]
  v_exp_f32 v128, v128
  v_mfma_f32_16x16x32_bf16 v[92:95], a[140:143], v[112:115], v[92:95]
  v_exp_f32 v129, v129
  v_mfma_f32_16x16x32_bf16 v[156:159], v[168:171], v[112:115], v[156:159]
  v_exp_f32 v130, v130
  v_mfma_f32_16x16x32_bf16 v[136:139], a[80:83], a[32:35], v[152:155]
  ds_read_b64_tr_b16 a[172:173], v183 offset:34816
  ds_read_b128 a[72:75], v174 offset:1024
  v_mfma_f32_16x16x32_bf16 v[136:139], a[84:87], a[36:39], v[136:139]
  v_exp_f32 v131, v131
  v_mfma_f32_16x16x32_bf16 v[136:139], a[88:91], a[40:43], v[136:139]
  v_exp_f32 v132, v132
  v_mfma_f32_16x16x32_bf16 v[136:139], a[92:95], a[44:47], v[136:139]
  ds_read_b64_tr_b16 a[174:175], v183 offset:35840
  ds_read_b128 a[76:79], v175 offset:1024
  v_mfma_f32_16x16x32_bf16 v[140:143], a[96:99], a[32:35], v[152:155]
  v_cvt_pk_bf16_f32 v128, v128, v129
  v_cvt_pk_bf16_f32 v129, v130, v131
  v_mfma_f32_16x16x32_bf16 v[140:143], a[100:103], a[36:39], v[140:143]
  v_exp_f32 v133, v133
  v_mfma_f32_16x16x32_bf16 v[140:143], a[104:107], a[40:43], v[140:143]
  v_exp_f32 v134, v134
  v_mfma_f32_16x16x32_bf16 v[140:143], a[108:111], a[44:47], v[140:143]
  v_exp_f32 v135, v135
  s_waitcnt lgkmcnt(1)
  v_mfma_f32_16x16x32_bf16 v[0:3], a[144:147], v[120:123], v[0:3]
  v_cvt_pk_bf16_f32 v130, v132, v133
  v_cvt_pk_bf16_f32 v131, v134, v135
  v_mfma_f32_16x16x32_bf16 v[4:7], a[148:151], v[120:123], v[4:7]
  v_mfma_f32_16x16x32_bf16 v[8:11], a[152:155], v[120:123], v[8:11]
  v_mfma_f32_16x16x32_bf16 v[12:15], a[156:159], v[120:123], v[12:15]
  v_mfma_f32_16x16x32_bf16 v[16:19], a[160:163], v[120:123], v[16:19]
  v_exp_f32 v136, v136
  v_mfma_f32_16x16x32_bf16 v[20:23], a[164:167], v[120:123], v[20:23]
  v_exp_f32 v137, v137
  v_mfma_f32_16x16x32_bf16 v[24:27], a[168:171], v[120:123], v[24:27]
  v_exp_f32 v138, v138
  v_mfma_f32_16x16x32_bf16 v[28:31], a[172:175], v[120:123], v[28:31]
  v_exp_f32 v139, v139
  v_mfma_f32_16x16x32_bf16 v[156:159], v[160:163], v[120:123], v[156:159]
  v_exp_f32 v140, v140
  s_waitcnt lgkmcnt(0)
  v_mfma_f32_16x16x32_bf16 v[96:99], a[48:51], a[0:3], v[144:147]
  v_cvt_pk_bf16_f32 v136, v136, v137
  v_cvt_pk_bf16_f32 v137, v138, v139
  v_mfma_f32_16x16x32_bf16 v[96:99], a[52:55], a[4:7], v[96:99]
  v_exp_f32 v141, v141
  v_mfma_f32_16x16x32_bf16 v[96:99], a[56:59], a[8:11], v[96:99]
  v_exp_f32 v142, v142
  v_mfma_f32_16x16x32_bf16 v[96:99], a[60:63], a[12:15], v[96:99]
  v_exp_f32 v143, v143
  v_mfma_f32_16x16x32_bf16 v[100:103], a[64:67], a[0:3], v[144:147]
  s_waitcnt vmcnt(3)
  s_waitcnt lgkmcnt(0)
  s_barrier
  v_mfma_f32_16x16x32_bf16 v[100:103], a[68:71], a[4:7], v[100:103]
  v_cvt_pk_bf16_f32 v138, v140, v141
  v_cvt_pk_bf16_f32 v139, v142, v143
  v_mfma_f32_16x16x32_bf16 v[100:103], a[72:75], a[8:11], v[100:103]
  s_add_u32 m0, s45, 131072
  s_add_u32 s71, s67, 10
  s_and_b32 s71, s71, 7
  ds_read_b64_tr_b16 a[112:113], v176 offset:49152
  ds_read_b64_tr_b16 a[114:115], v176 offset:50176
  v_mfma_f32_16x16x32_bf16 v[100:103], a[76:79], a[12:15], v[100:103]
  s_add_u32 s71, s71, 8
  s_mul_i32 s71, s71, 40960
  v_mfma_f32_16x16x32_bf16 v[32:35], a[144:147], v[128:131], v[32:35]
  buffer_load_dwordx4 v188, s[92:95], s71 offen lds
  v_mfma_f32_16x16x32_bf16 v[36:39], a[148:151], v[128:131], v[36:39]
  ds_read_b64_tr_b16 a[116:117], v177 offset:49152
  ds_read_b64_tr_b16 a[118:119], v177 offset:50176
  v_mfma_f32_16x16x32_bf16 v[40:43], a[152:155], v[128:131], v[40:43]
  v_mfma_f32_16x16x32_bf16 v[44:47], a[156:159], v[128:131], v[44:47]
  buffer_load_dwordx4 v189, s[92:95], s71 offen offset:1024 lds
  v_mfma_f32_16x16x32_bf16 v[48:51], a[160:163], v[128:131], v[48:51]
  ds_read_b64_tr_b16 a[120:121], v178 offset:49152
  ds_read_b64_tr_b16 a[122:123], v178 offset:50176
  v_mfma_f32_16x16x32_bf16 v[52:55], a[164:167], v[128:131], v[52:55]
  v_exp_f32 v96, v96
  v_mfma_f32_16x16x32_bf16 v[56:59], a[168:171], v[128:131], v[56:59]
  buffer_load_dwordx4 v190, s[92:95], s71 offen offset:2048 lds
  v_exp_f32 v97, v97
  v_mfma_f32_16x16x32_bf16 v[60:63], a[172:175], v[128:131], v[60:63]
  ds_read_b64_tr_b16 a[124:125], v179 offset:49152
  ds_read_b64_tr_b16 a[126:127], v179 offset:50176
  v_mfma_f32_16x16x32_bf16 v[156:159], v[164:167], v[128:131], v[156:159]
  v_exp_f32 v98, v98
  v_mfma_f32_16x16x32_bf16 v[104:107], a[48:51], a[16:19], v[148:151]
  buffer_load_dwordx4 v191, s[92:95], s71 offen offset:3072 lds
  v_exp_f32 v99, v99
  v_mfma_f32_16x16x32_bf16 v[104:107], a[52:55], a[20:23], v[104:107]
  ds_read_b64_tr_b16 a[128:129], v180 offset:49152
  ds_read_b128 a[80:83], v172 offset:2048
  v_mfma_f32_16x16x32_bf16 v[104:107], a[56:59], a[24:27], v[104:107]
  v_exp_f32 v100, v100
  v_mfma_f32_16x16x32_bf16 v[104:107], a[60:63], a[28:31], v[104:107]
  v_cvt_pk_bf16_f32 v96, v96, v97
  v_cvt_pk_bf16_f32 v97, v98, v99
  v_mfma_f32_16x16x32_bf16 v[108:111], a[64:67], a[16:19], v[148:151]
  s_add_u32 m0, s45, 147456
  s_add_u32 s71, s67, 12
  s_and_b32 s71, s71, 7
  ds_read_b64_tr_b16 a[130:131], v180 offset:50176
  ds_read_b128 a[84:87], v173 offset:2048
  v_mfma_f32_16x16x32_bf16 v[108:111], a[68:71], a[20:23], v[108:111]
  s_add_u32 s71, s71, 8
  s_mul_i32 s71, s71, 40960
  v_exp_f32 v101, v101
  v_mfma_f32_16x16x32_bf16 v[108:111], a[72:75], a[24:27], v[108:111]
  buffer_load_dwordx4 v188, s[92:95], s71 offen lds
  v_exp_f32 v102, v102
  v_mfma_f32_16x16x32_bf16 v[108:111], a[76:79], a[28:31], v[108:111]
  ds_read_b64_tr_b16 a[132:133], v181 offset:49152
  ds_read_b128 a[88:91], v174 offset:2048
  v_mfma_f32_16x16x32_bf16 v[64:67], a[144:147], v[136:139], v[64:67]
  v_exp_f32 v103, v103
  v_mfma_f32_16x16x32_bf16 v[68:71], a[148:151], v[136:139], v[68:71]
  buffer_load_dwordx4 v189, s[92:95], s71 offen offset:1024 lds
  v_cvt_pk_bf16_f32 v98, v100, v101
  v_cvt_pk_bf16_f32 v99, v102, v103
  v_mfma_f32_16x16x32_bf16 v[72:75], a[152:155], v[136:139], v[72:75]
  ds_read_b64_tr_b16 a[134:135], v181 offset:50176
  ds_read_b128 a[92:95], v175 offset:2048
  v_mfma_f32_16x16x32_bf16 v[76:79], a[156:159], v[136:139], v[76:79]
  v_mfma_f32_16x16x32_bf16 v[80:83], a[160:163], v[136:139], v[80:83]
  buffer_load_dwordx4 v190, s[92:95], s71 offen offset:2048 lds
  v_exp_f32 v104, v104
  v_mfma_f32_16x16x32_bf16 v[84:87], a[164:167], v[136:139], v[84:87]
  ds_read_b64_tr_b16 a[136:137], v182 offset:49152
  ds_read_b128 a[96:99], v172 offset:3072
  v_mfma_f32_16x16x32_bf16 v[88:91], a[168:171], v[136:139], v[88:91]
  v_exp_f32 v105, v105
  v_mfma_f32_16x16x32_bf16 v[92:95], a[172:175], v[136:139], v[92:95]
  buffer_load_dwordx4 v191, s[92:95], s71 offen offset:3072 lds
  v_exp_f32 v106, v106
  v_mfma_f32_16x16x32_bf16 v[156:159], v[168:171], v[136:139], v[156:159]
  ds_read_b64_tr_b16 a[138:139], v182 offset:50176
  ds_read_b128 a[100:103], v173 offset:3072
  v_mfma_f32_16x16x32_bf16 v[112:115], a[48:51], a[32:35], v[152:155]
  v_exp_f32 v107, v107
  v_mfma_f32_16x16x32_bf16 v[112:115], a[52:55], a[36:39], v[112:115]
  v_exp_f32 v108, v108
  v_mfma_f32_16x16x32_bf16 v[112:115], a[56:59], a[40:43], v[112:115]
  s_add_u32 m0, s45, 49152
  s_add_u32 s71, s67, 14
  s_and_b32 s71, s71, 7
  ds_read_b64_tr_b16 a[140:141], v183 offset:49152
  ds_read_b128 a[104:107], v174 offset:3072
  v_mfma_f32_16x16x32_bf16 v[112:115], a[60:63], a[44:47], v[112:115]
  s_add_u32 s71, s71, 8
  s_mul_i32 s71, s71, 40960
  v_cvt_pk_bf16_f32 v104, v104, v105
  v_cvt_pk_bf16_f32 v105, v106, v107
  v_mfma_f32_16x16x32_bf16 v[116:119], a[64:67], a[32:35], v[152:155]
  buffer_load_dwordx4 v188, s[92:95], s71 offen lds
  v_exp_f32 v109, v109
  v_mfma_f32_16x16x32_bf16 v[116:119], a[68:71], a[36:39], v[116:119]
  ds_read_b64_tr_b16 a[142:143], v183 offset:50176
  ds_read_b128 a[108:111], v175 offset:3072
  v_mfma_f32_16x16x32_bf16 v[116:119], a[72:75], a[40:43], v[116:119]
  v_exp_f32 v110, v110
  v_mfma_f32_16x16x32_bf16 v[116:119], a[76:79], a[44:47], v[116:119]
  buffer_load_dwordx4 v189, s[92:95], s71 offen offset:1024 lds
  v_exp_f32 v111, v111
  s_waitcnt lgkmcnt(15)
  v_mfma_f32_16x16x32_bf16 v[0:3], a[112:115], v[96:99], v[0:3]
  v_cvt_pk_bf16_f32 v106, v108, v109
  v_cvt_pk_bf16_f32 v107, v110, v111
  v_mfma_f32_16x16x32_bf16 v[4:7], a[116:119], v[96:99], v[4:7]
  v_mfma_f32_16x16x32_bf16 v[8:11], a[120:123], v[96:99], v[8:11]
  buffer_load_dwordx4 v190, s[92:95], s71 offen offset:2048 lds
  v_mfma_f32_16x16x32_bf16 v[12:15], a[124:127], v[96:99], v[12:15]
  s_waitcnt lgkmcnt(0)
  v_mfma_f32_16x16x32_bf16 v[16:19], a[128:131], v[96:99], v[16:19]
  v_exp_f32 v112, v112
  v_mfma_f32_16x16x32_bf16 v[20:23], a[132:135], v[96:99], v[20:23]
  buffer_load_dwordx4 v191, s[92:95], s71 offen offset:3072 lds
  v_mfma_f32_16x16x32_bf16 v[24:27], a[136:139], v[96:99], v[24:27]
  v_exp_f32 v113, v113
  v_mfma_f32_16x16x32_bf16 v[28:31], a[140:143], v[96:99], v[28:31]
  v_exp_f32 v114, v114
  v_mfma_f32_16x16x32_bf16 v[156:159], v[160:163], v[96:99], v[156:159]
  ds_read_b64_tr_b16 a[144:145], v176 offset:51200
  ds_read_b64_tr_b16 a[146:147], v176 offset:52224
  v_mfma_f32_16x16x32_bf16 v[120:123], a[80:83], a[0:3], v[144:147]
  s_add_u32 m0, s45, 65536
  s_add_u32 s71, s67, 16
  s_and_b32 s71, s71, 7
  v_exp_f32 v115, v115
  v_mfma_f32_16x16x32_bf16 v[120:123], a[84:87], a[4:7], v[120:123]
  s_add_u32 s71, s71, 16
  s_mul_i32 s71, s71, 40960
  v_exp_f32 v116, v116
  v_mfma_f32_16x16x32_bf16 v[120:123], a[88:91], a[8:11], v[120:123]
  buffer_load_dwordx4 v188, s[92:95], s71 offen lds
  ds_read_b64_tr_b16 a[148:149], v177 offset:51200
  ds_read_b64_tr_b16 a[150:151], v177 offset:52224
  v_mfma_f32_16x16x32_bf16 v[120:123], a[92:95], a[12:15], v[120:123]
  v_cvt_pk_bf16_f32 v112, v112, v113
  v_cvt_pk_bf16_f32 v113, v114, v115
  v_mfma_f32_16x16x32_bf16 v[124:127], a[96:99], a[0:3], v[144:147]
  v_exp_f32 v117, v117
  v_mfma_f32_16x16x32_bf16 v[124:127], a[100:103], a[4:7], v[124:127]
  buffer_load_dwordx4 v189, s[92:95], s71 offen offset:1024 lds
  v_mfma_f32_16x16x32_bf16 v[124:127], a[104:107], a[8:11], v[124:127]
  ds_read_b64_tr_b16 a[152:153], v178 offset:51200
  ds_read_b64_tr_b16 a[154:155], v178 offset:52224
  v_mfma_f32_16x16x32_bf16 v[124:127], a[108:111], a[12:15], v[124:127]
  v_exp_f32 v118, v118
  v_mfma_f32_16x16x32_bf16 v[32:35], a[112:115], v[104:107], v[32:35]
  buffer_load_dwordx4 v190, s[92:95], s71 offen offset:2048 lds
  v_mfma_f32_16x16x32_bf16 v[36:39], a[116:119], v[104:107], v[36:39]
  ds_read_b64_tr_b16 a[156:157], v179 offset:51200
  ds_read_b64_tr_b16 a[158:159], v179 offset:52224
  v_mfma_f32_16x16x32_bf16 v[40:43], a[120:123], v[104:107], v[40:43]
  v_exp_f32 v119, v119
  v_mfma_f32_16x16x32_bf16 v[44:47], a[124:127], v[104:107], v[44:47]
  buffer_load_dwordx4 v191, s[92:95], s71 offen offset:3072 lds
  v_mfma_f32_16x16x32_bf16 v[48:51], a[128:131], v[104:107], v[48:51]
  v_cvt_pk_bf16_f32 v114, v116, v117
  v_cvt_pk_bf16_f32 v115, v118, v119
  v_mfma_f32_16x16x32_bf16 v[52:55], a[132:135], v[104:107], v[52:55]
  ds_read_b64_tr_b16 a[160:161], v180 offset:51200
  v_mfma_f32_16x16x32_bf16 v[56:59], a[136:139], v[104:107], v[56:59]
  v_mfma_f32_16x16x32_bf16 v[60:63], a[140:143], v[104:107], v[60:63]
  s_add_u32 m0, s45, 32768
  s_add_u32 s71, s67, 18
  s_and_b32 s71, s71, 7
  v_exp_f32 v120, v120
  v_mfma_f32_16x16x32_bf16 v[156:159], v[164:167], v[104:107], v[156:159]
  s_add_u32 s71, s71, 16
  s_mul_i32 s71, s71, 40960
  ds_read_b64_tr_b16 a[162:163], v180 offset:52224
  v_mfma_f32_16x16x32_bf16 v[128:131], a[80:83], a[16:19], v[148:151]
  buffer_load_dwordx4 v188, s[92:95], s71 offen lds
  v_mfma_f32_16x16x32_bf16 v[128:131], a[84:87], a[20:23], v[128:131]
  v_exp_f32 v121, v121
  v_mfma_f32_16x16x32_bf16 v[128:131], a[88:91], a[24:27], v[128:131]
  v_exp_f32 v122, v122
  v_mfma_f32_16x16x32_bf16 v[128:131], a[92:95], a[28:31], v[128:131]
  buffer_load_dwordx4 v189, s[92:95], s71 offen offset:1024 lds
  ds_read_b64_tr_b16 a[164:165], v181 offset:51200
  v_mfma_f32_16x16x32_bf16 v[132:135], a[96:99], a[16:19], v[148:151]
  v_exp_f32 v123, v123
  v_mfma_f32_16x16x32_bf16 v[132:135], a[100:103], a[20:23], v[132:135]
  v_exp_f32 v124, v124
  v_mfma_f32_16x16x32_bf16 v[132:135], a[104:107], a[24:27], v[132:135]
  buffer_load_dwordx4 v190, s[92:95], s71 offen offset:2048 lds
  ds_read_b64_tr_b16 a[166:167], v181 offset:52224
  v_mfma_f32_16x16x32_bf16 v[132:135], a[108:111], a[28:31], v[132:135]
  v_cvt_pk_bf16_f32 v120, v120, v121
  v_cvt_pk_bf16_f32 v121, v122, v123
  v_mfma_f32_16x16x32_bf16 v[64:67], a[112:115], v[112:115], v[64:67]
  v_exp_f32 v125, v125
  v_mfma_f32_16x16x32_bf16 v[68:71], a[116:119], v[112:115], v[68:71]
  buffer_load_dwordx4 v191, s[92:95], s71 offen offset:3072 lds
  v_exp_f32 v126, v126
  v_mfma_f32_16x16x32_bf16 v[72:75], a[120:123], v[112:115], v[72:75]
  ds_read_b64_tr_b16 a[168:169], v182 offset:51200
  v_mfma_f32_16x16x32_bf16 v[76:79], a[124:127], v[112:115], v[76:79]
  v_exp_f32 v127, v127
  v_mfma_f32_16x16x32_bf16 v[80:83], a[128:131], v[112:115], v[80:83]
  v_cvt_pk_bf16_f32 v122, v124, v125
  v_cvt_pk_bf16_f32 v123, v126, v127
  v_mfma_f32_16x16x32_bf16 v[84:87], a[132:135], v[112:115], v[84:87]
  s_add_u32 m0, s45, 81920
  s_add_u32 s71, s67, 20
  s_and_b32 s71, s71, 7
  ds_read_b64_tr_b16 a[170:171], v182 offset:52224
  v_mfma_f32_16x16x32_bf16 v[88:91], a[136:139], v[112:115], v[88:91]
  s_add_u32 s71, s71, 16
  s_mul_i32 s71, s71, 40960
  v_exp_f32 v128, v128
  v_mfma_f32_16x16x32_bf16 v[92:95], a[140:143], v[112:115], v[92:95]
  buffer_load_dwordx4 v188, s[92:95], s71 offen lds
  v_exp_f32 v129, v129
  v_mfma_f32_16x16x32_bf16 v[156:159], v[168:171], v[112:115], v[156:159]
  v_exp_f32 v130, v130
  v_mfma_f32_16x16x32_bf16 v[136:139], a[80:83], a[32:35], v[152:155]
  ds_read_b64_tr_b16 a[172:173], v183 offset:51200
  v_mfma_f32_16x16x32_bf16 v[136:139], a[84:87], a[36:39], v[136:139]
  buffer_load_dwordx4 v189, s[92:95], s71 offen offset:1024 lds
  v_exp_f32 v131, v131
  v_mfma_f32_16x16x32_bf16 v[136:139], a[88:91], a[40:43], v[136:139]
  v_exp_f32 v132, v132
  v_mfma_f32_16x16x32_bf16 v[136:139], a[92:95], a[44:47], v[136:139]
  ds_read_b64_tr_b16 a[174:175], v183 offset:52224
  v_mfma_f32_16x16x32_bf16 v[140:143], a[96:99], a[32:35], v[152:155]
  buffer_load_dwordx4 v190, s[92:95], s71 offen offset:2048 lds
  v_cvt_pk_bf16_f32 v128, v128, v129
  v_cvt_pk_bf16_f32 v129, v130, v131
  v_mfma_f32_16x16x32_bf16 v[140:143], a[100:103], a[36:39], v[140:143]
  v_exp_f32 v133, v133
  v_mfma_f32_16x16x32_bf16 v[140:143], a[104:107], a[40:43], v[140:143]
  v_exp_f32 v134, v134
  v_mfma_f32_16x16x32_bf16 v[140:143], a[108:111], a[44:47], v[140:143]
  buffer_load_dwordx4 v191, s[92:95], s71 offen offset:3072 lds
  v_exp_f32 v135, v135
  s_waitcnt lgkmcnt(0)
  v_mfma_f32_16x16x32_bf16 v[0:3], a[144:147], v[120:123], v[0:3]
  v_cvt_pk_bf16_f32 v130, v132, v133
  v_cvt_pk_bf16_f32 v131, v134, v135
  v_mfma_f32_16x16x32_bf16 v[4:7], a[148:151], v[120:123], v[4:7]
  v_mfma_f32_16x16x32_bf16 v[8:11], a[152:155], v[120:123], v[8:11]
  v_mfma_f32_16x16x32_bf16 v[12:15], a[156:159], v[120:123], v[12:15]
  s_waitcnt lgkmcnt(0)
  s_barrier
  v_mfma_f32_16x16x32_bf16 v[16:19], a[160:163], v[120:123], v[16:19]
  v_exp_f32 v136, v136
  v_mfma_f32_16x16x32_bf16 v[20:23], a[164:167], v[120:123], v[20:23]
  v_exp_f32 v137, v137
  v_mfma_f32_16x16x32_bf16 v[24:27], a[168:171], v[120:123], v[24:27]
  v_exp_f32 v138, v138
  v_mfma_f32_16x16x32_bf16 v[28:31], a[172:175], v[120:123], v[28:31]
  v_exp_f32 v139, v139
  v_mfma_f32_16x16x32_bf16 v[156:159], v[160:163], v[120:123], v[156:159]
  v_exp_f32 v140, v140
K1_epi:
  s_mul_i32 s46, s39, 12
  s_mul_i32 s47, s36, 3
  s_add_u32 s46, s46, s47
  s_lshl_b32 s46, s46, 17
  s_lshl_b32 s47, s40, 12
  s_add_u32 s46, s46, s47
  v_cvt_pk_bf16_f32 v136, v136, v137
  v_cvt_pk_bf16_f32 v137, v138, v139
  v_exp_f32 v141, v141
  v_exp_f32 v142, v142
  v_exp_f32 v143, v143
  v_cvt_pk_bf16_f32 v138, v140, v141
  v_rcp_f32 v208, v156
  v_mfma_f32_16x16x32_bf16 v[32:35], a[144:147], v[128:131], v[32:35]
  v_cvt_pk_bf16_f32 v139, v142, v143
  v_mfma_f32_16x16x32_bf16 v[36:39], a[148:151], v[128:131], v[36:39]
  v_pk_mul_f32 v[0:1], v[0:1], v[208:209] op_sel_hi:[1,0]
  v_pk_mul_f32 v[2:3], v[2:3], v[208:209] op_sel_hi:[1,0]
  v_mfma_f32_16x16x32_bf16 v[40:43], a[152:155], v[128:131], v[40:43]
  v_pk_mul_f32 v[4:5], v[4:5], v[208:209] op_sel_hi:[1,0]
  v_mfma_f32_16x16x32_bf16 v[44:47], a[156:159], v[128:131], v[44:47]
  v_pk_mul_f32 v[6:7], v[6:7], v[208:209] op_sel_hi:[1,0]
  v_cvt_pk_bf16_f32 v0, v0, v1
  v_mfma_f32_16x16x32_bf16 v[48:51], a[160:163], v[128:131], v[48:51]
  v_cvt_pk_bf16_f32 v1, v2, v3
  v_mfma_f32_16x16x32_bf16 v[52:55], a[164:167], v[128:131], v[52:55]
  v_cvt_pk_bf16_f32 v2, v4, v5
  v_cvt_pk_bf16_f32 v3, v6, v7
  v_mfma_f32_16x16x32_bf16 v[56:59], a[168:171], v[128:131], v[56:59]
  v_mfma_f32_16x16x32_bf16 v[60:63], a[172:175], v[128:131], v[60:63]
  buffer_store_dwordx4 v[0:3], v186, s[32:35], s46 offen sc1
  v_mfma_f32_16x16x32_bf16 v[156:159], v[164:167], v[128:131], v[156:159]
  v_mfma_f32_16x16x32_bf16 v[64:67], a[144:147], v[136:139], v[64:67]
  v_pk_mul_f32 v[8:9], v[8:9], v[208:209] op_sel_hi:[1,0]
  v_pk_mul_f32 v[10:11], v[10:11], v[208:209] op_sel_hi:[1,0]
  v_pk_mul_f32 v[12:13], v[12:13], v[208:209] op_sel_hi:[1,0]
  v_pk_mul_f32 v[14:15], v[14:15], v[208:209] op_sel_hi:[1,0]
  v_cvt_pk_bf16_f32 v8, v8, v9
  v_mfma_f32_16x16x32_bf16 v[68:71], a[148:151], v[136:139], v[68:71]
  v_cvt_pk_bf16_f32 v9, v10, v11
  v_cvt_pk_bf16_f32 v10, v12, v13
  v_cvt_pk_bf16_f32 v11, v14, v15
  v_mfma_f32_16x16x32_bf16 v[72:75], a[152:155], v[136:139], v[72:75]
  buffer_store_dwordx4 v[8:11], v186, s[32:35], s46 offen offset:1024 sc1
  v_pk_mul_f32 v[16:17], v[16:17], v[208:209] op_sel_hi:[1,0]
  v_pk_mul_f32 v[18:19], v[18:19], v[208:209] op_sel_hi:[1,0]
  v_mfma_f32_16x16x32_bf16 v[76:79], a[156:159], v[136:139], v[76:79]
  v_pk_mul_f32 v[20:21], v[20:21], v[208:209] op_sel_hi:[1,0]
  v_pk_mul_f32 v[22:23], v[22:23], v[208:209] op_sel_hi:[1,0]
  v_cvt_pk_bf16_f32 v16, v16, v17
  v_cvt_pk_bf16_f32 v17, v18, v19
  v_cvt_pk_bf16_f32 v18, v20, v21
  v_mfma_f32_16x16x32_bf16 v[80:83], a[160:163], v[136:139], v[80:83]
  v_cvt_pk_bf16_f32 v19, v22, v23
  buffer_store_dwordx4 v[16:19], v186, s[32:35], s46 offen offset:2048 sc1
  v_mfma_f32_16x16x32_bf16 v[84:87], a[164:167], v[136:139], v[84:87]
  v_pk_mul_f32 v[24:25], v[24:25], v[208:209] op_sel_hi:[1,0]
  v_pk_mul_f32 v[26:27], v[26:27], v[208:209] op_sel_hi:[1,0]
  v_pk_mul_f32 v[28:29], v[28:29], v[208:209] op_sel_hi:[1,0]
  v_pk_mul_f32 v[30:31], v[30:31], v[208:209] op_sel_hi:[1,0]
  v_mfma_f32_16x16x32_bf16 v[88:91], a[168:171], v[136:139], v[88:91]
  v_cvt_pk_bf16_f32 v24, v24, v25
  v_cvt_pk_bf16_f32 v25, v26, v27
  v_cvt_pk_bf16_f32 v26, v28, v29
  v_cvt_pk_bf16_f32 v27, v30, v31
  v_mfma_f32_16x16x32_bf16 v[92:95], a[172:175], v[136:139], v[92:95]
  buffer_store_dwordx4 v[24:27], v186, s[32:35], s46 offen offset:3072 sc1
  s_add_u32 s46, s46, 131072
  v_rcp_f32 v210, v157
  v_mfma_f32_16x16x32_bf16 v[156:159], v[168:171], v[136:139], v[156:159]
  v_pk_mul_f32 v[32:33], v[32:33], v[210:211] op_sel_hi:[1,0]
  v_pk_mul_f32 v[34:35], v[34:35], v[210:211] op_sel_hi:[1,0]
  v_pk_mul_f32 v[36:37], v[36:37], v[210:211] op_sel_hi:[1,0]
  v_pk_mul_f32 v[38:39], v[38:39], v[210:211] op_sel_hi:[1,0]
  v_cvt_pk_bf16_f32 v32, v32, v33
  v_cvt_pk_bf16_f32 v33, v34, v35
  v_cvt_pk_bf16_f32 v34, v36, v37
  v_cvt_pk_bf16_f32 v35, v38, v39
  buffer_store_dwordx4 v[32:35], v186, s[32:35], s46 offen sc1
  v_pk_mul_f32 v[40:41], v[40:41], v[210:211] op_sel_hi:[1,0]
  v_pk_mul_f32 v[42:43], v[42:43], v[210:211] op_sel_hi:[1,0]
  v_pk_mul_f32 v[44:45], v[44:45], v[210:211] op_sel_hi:[1,0]
  v_pk_mul_f32 v[46:47], v[46:47], v[210:211] op_sel_hi:[1,0]
  v_cvt_pk_bf16_f32 v40, v40, v41
  v_cvt_pk_bf16_f32 v41, v42, v43
  v_cvt_pk_bf16_f32 v42, v44, v45
  v_cvt_pk_bf16_f32 v43, v46, v47
  buffer_store_dwordx4 v[40:43], v186, s[32:35], s46 offen offset:1024 sc1
  v_pk_mul_f32 v[48:49], v[48:49], v[210:211] op_sel_hi:[1,0]
  v_pk_mul_f32 v[50:51], v[50:51], v[210:211] op_sel_hi:[1,0]
  v_pk_mul_f32 v[52:53], v[52:53], v[210:211] op_sel_hi:[1,0]
  v_pk_mul_f32 v[54:55], v[54:55], v[210:211] op_sel_hi:[1,0]
  v_cvt_pk_bf16_f32 v48, v48, v49
  v_cvt_pk_bf16_f32 v49, v50, v51
  v_cvt_pk_bf16_f32 v50, v52, v53
  v_cvt_pk_bf16_f32 v51, v54, v55
  buffer_store_dwordx4 v[48:51], v186, s[32:35], s46 offen offset:2048 sc1
  v_pk_mul_f32 v[56:57], v[56:57], v[210:211] op_sel_hi:[1,0]
  v_pk_mul_f32 v[58:59], v[58:59], v[210:211] op_sel_hi:[1,0]
  v_pk_mul_f32 v[60:61], v[60:61], v[210:211] op_sel_hi:[1,0]
  v_pk_mul_f32 v[62:63], v[62:63], v[210:211] op_sel_hi:[1,0]
  v_cvt_pk_bf16_f32 v56, v56, v57
  v_cvt_pk_bf16_f32 v57, v58, v59
  v_cvt_pk_bf16_f32 v58, v60, v61
  v_cvt_pk_bf16_f32 v59, v62, v63
  buffer_store_dwordx4 v[56:59], v186, s[32:35], s46 offen offset:3072 sc1
  s_add_u32 s46, s46, 131072
  v_mov_b32 v214, 0x53800000
  v_add_f32 v215, v156, v157
  v_add_f32 v215, v215, v158
  v_cmp_nle_f32 vcc, v215, v214
  v_and_b32 v216, 3, v187
  v_lshlrev_b32 v216, 12, v216
  s_cmp_lg_u64 vcc, 0
  s_cselect_b32 s47, 1, 0
  s_andn2_b32 s47, s47, s44
  v_mov_b32 v215, s47
  s_lshl_b32 s47, s36, 2
  v_add_u32 v216, s47, v216
  ds_write_b32 v216, v215
  v_mov_b32 v217, s45
  v_rcp_f32 v212, v158
  s_nop 0
  v_pk_mul_f32 v[64:65], v[64:65], v[212:213] op_sel_hi:[1,0]
  v_pk_mul_f32 v[66:67], v[66:67], v[212:213] op_sel_hi:[1,0]
  v_pk_mul_f32 v[68:69], v[68:69], v[212:213] op_sel_hi:[1,0]
  v_pk_mul_f32 v[70:71], v[70:71], v[212:213] op_sel_hi:[1,0]
  v_cvt_pk_bf16_f32 v64, v64, v65
  v_cvt_pk_bf16_f32 v65, v66, v67
  v_cvt_pk_bf16_f32 v66, v68, v69
  v_cvt_pk_bf16_f32 v67, v70, v71
  buffer_store_dwordx4 v[64:67], v186, s[32:35], s46 offen sc1
  v_pk_mul_f32 v[72:73], v[72:73], v[212:213] op_sel_hi:[1,0]
  v_pk_mul_f32 v[74:75], v[74:75], v[212:213] op_sel_hi:[1,0]
  v_pk_mul_f32 v[76:77], v[76:77], v[212:213] op_sel_hi:[1,0]
  v_pk_mul_f32 v[78:79], v[78:79], v[212:213] op_sel_hi:[1,0]
  v_cvt_pk_bf16_f32 v72, v72, v73
  v_cvt_pk_bf16_f32 v73, v74, v75
  v_cvt_pk_bf16_f32 v74, v76, v77
  v_cvt_pk_bf16_f32 v75, v78, v79
  buffer_store_dwordx4 v[72:75], v186, s[32:35], s46 offen offset:1024 sc1
  v_pk_mul_f32 v[80:81], v[80:81], v[212:213] op_sel_hi:[1,0]
  v_pk_mul_f32 v[82:83], v[82:83], v[212:213] op_sel_hi:[1,0]
  v_pk_mul_f32 v[84:85], v[84:85], v[212:213] op_sel_hi:[1,0]
  v_pk_mul_f32 v[86:87], v[86:87], v[212:213] op_sel_hi:[1,0]
  v_cvt_pk_bf16_f32 v80, v80, v81
  v_cvt_pk_bf16_f32 v81, v82, v83
  v_cvt_pk_bf16_f32 v82, v84, v85
  v_cvt_pk_bf16_f32 v83, v86, v87
  buffer_store_dwordx4 v[80:83], v186, s[32:35], s46 offen offset:2048 sc1
  v_pk_mul_f32 v[88:89], v[88:89], v[212:213] op_sel_hi:[1,0]
  v_pk_mul_f32 v[90:91], v[90:91], v[212:213] op_sel_hi:[1,0]
  v_pk_mul_f32 v[92:93], v[92:93], v[212:213] op_sel_hi:[1,0]
  v_pk_mul_f32 v[94:95], v[94:95], v[212:213] op_sel_hi:[1,0]
  v_cvt_pk_bf16_f32 v88, v88, v89
  v_cvt_pk_bf16_f32 v89, v90, v91
  v_cvt_pk_bf16_f32 v90, v92, v93
  v_cvt_pk_bf16_f32 v91, v94, v95
  buffer_store_dwordx4 v[88:91], v186, s[32:35], s46 offen offset:3072 sc1
  s_add_u32 s46, s46, 131072
  s_add_u32 m0, s45, 16384
  s_add_u32 s71, s67, 22
  s_and_b32 s71, s71, 7
  s_add_u32 s71, s71, 16
  s_mul_i32 s71, s71, 40960
  buffer_load_dwordx4 v188, s[92:95], s71 offen lds
  buffer_load_dwordx4 v189, s[92:95], s71 offen offset:1024 lds
  buffer_load_dwordx4 v190, s[92:95], s71 offen offset:2048 lds
  buffer_load_dwordx4 v191, s[92:95], s71 offen offset:3072 lds
  s_add_u32 m0, s45, 98304
  s_add_u32 s71, s67, 23
  s_and_b32 s71, s71, 7
  s_add_u32 s71, s71, 16
  s_mul_i32 s71, s71, 40960
  buffer_load_dwordx4 v188, s[92:95], s71 offen lds
  buffer_load_dwordx4 v189, s[92:95], s71 offen offset:1024 lds
  buffer_load_dwordx4 v190, s[92:95], s71 offen offset:2048 lds
  buffer_load_dwordx4 v191, s[92:95], s71 offen offset:3072 lds
  s_add_u32 m0, s45, 114688
  s_add_u32 s71, s67, 24
  s_and_b32 s71, s71, 7
  s_add_u32 s71, s71, 24
  s_mul_i32 s71, s71, 40960
  buffer_load_dwordx4 v188, s[92:95], s71 offen lds
  buffer_load_dwordx4 v189, s[92:95], s71 offen offset:1024 lds
  buffer_load_dwordx4 v190, s[92:95], s71 offen offset:2048 lds
  buffer_load_dwordx4 v191, s[92:95], s71 offen offset:3072 lds
  s_waitcnt vmcnt(12)
  s_waitcnt lgkmcnt(0)
  s_barrier
  ds_read_b128 v[220:223], v217
  s_lshl_b32 s47, s39, 5
  v_mov_b32 v218, 1
  s_waitcnt lgkmcnt(0)
  v_or3_b32 v220, v220, v221, v222
  v_or_b32 v220, v220, v223
  v_cmp_ne_u32 vcc, 0, v220
  s_nop 0
  s_cbranch_vccnz K1_safe
  s_cmp_lg_u32 s36, 0
  s_cbranch_scc1 K1_nopub
  s_mov_b64 exec, 1
  buffer_atomic_add v218, off, s[52:55], s47
  s_mov_b64 exec, -1
K1_nopub:
  s_cmp_ge_u32 s2, 240
  s_cbranch_scc1 K1_fin
  s_add_u32 m0, s45, 0
  s_add_u32 s71, s67, 25
  s_and_b32 s71, s71, 7
  s_add_u32 s71, s71, 24
  s_mul_i32 s71, s71, 40960
  buffer_load_dwordx4 v188, s[92:95], s71 offen lds
  buffer_load_dwordx4 v189, s[92:95], s71 offen offset:1024 lds
  buffer_load_dwordx4 v190, s[92:95], s71 offen offset:2048 lds
  buffer_load_dwordx4 v191, s[92:95], s71 offen offset:3072 lds
  s_lshl_b32 s47, s66, 5
  s_mov_b32 s73, 0
  ds_read_b64_tr_b16 a[176:177], v200
  ds_read_b64_tr_b16 a[178:179], v200 offset:2048
  ds_read_b64_tr_b16 a[180:181], v201
  ds_read_b64_tr_b16 a[182:183], v201 offset:2048
  ds_read_b64_tr_b16 a[184:185], v202
  ds_read_b64_tr_b16 a[186:187], v202 offset:2048
  ds_read_b64_tr_b16 a[188:189], v203
  ds_read_b64_tr_b16 a[190:191], v203 offset:2048
  ds_read_b64_tr_b16 a[192:193], v200 offset:16384
  ds_read_b64_tr_b16 a[194:195], v200 offset:18432
  ds_read_b64_tr_b16 a[196:197], v201 offset:16384
  ds_read_b64_tr_b16 a[198:199], v201 offset:18432
  ds_read_b64_tr_b16 a[200:201], v202 offset:16384
  ds_read_b64_tr_b16 a[202:203], v202 offset:18432
  ds_read_b64_tr_b16 a[204:205], v203 offset:16384
  ds_read_b64_tr_b16 a[206:207], v203 offset:18432
  s_add_u32 m0, s45, 131072
  s_add_u32 s71, s67, 26
  s_and_b32 s71, s71, 7
  s_add_u32 s71, s71, 24
  s_mul_i32 s71, s71, 40960
  s_waitcnt lgkmcnt(8)
  buffer_load_dwordx4 v188, s[92:95], s71 offen lds
  buffer_load_dwordx4 v189, s[92:95], s71 offen offset:1024 lds
  buffer_load_dwordx4 v190, s[92:95], s71 offen offset:2048 lds
  buffer_load_dwordx4 v191, s[92:95], s71 offen offset:3072 lds
  ds_read_b64_tr_b16 a[208:209], v192 offset:49152
  ds_read_b64_tr_b16 a[210:211], v192 offset:51200
  ds_read_b64_tr_b16 a[212:213], v193 offset:49152
  ds_read_b64_tr_b16 a[214:215], v193 offset:51200
  ds_read_b64_tr_b16 a[216:217], v194 offset:49152
  ds_read_b64_tr_b16 a[218:219], v194 offset:51200
  ds_read_b64_tr_b16 a[220:221], v195 offset:49152
  ds_read_b64_tr_b16 a[222:223], v195 offset:51200
  s_add_u32 m0, s45, 147456
  s_add_u32 s71, s67, 27
  s_and_b32 s71, s71, 7
  s_add_u32 s71, s71, 24
  s_mul_i32 s71, s71, 40960
  s_waitcnt lgkmcnt(8)
  buffer_load_dwordx4 v188, s[92:95], s71 offen lds
  buffer_load_dwordx4 v189, s[92:95], s71 offen offset:1024 lds
  buffer_load_dwordx4 v190, s[92:95], s71 offen offset:2048 lds
  buffer_load_dwordx4 v191, s[92:95], s71 offen offset:3072 lds
  ds_read_b64_tr_b16 a[224:225], v196
  ds_read_b64_tr_b16 a[226:227], v196 offset:2048
  ds_read_b64_tr_b16 a[228:229], v197
  ds_read_b64_tr_b16 a[230:231], v197 offset:2048
  ds_read_b64_tr_b16 a[232:233], v198
  ds_read_b64_tr_b16 a[234:235], v198 offset:2048
  ds_read_b64_tr_b16 a[236:237], v199
  ds_read_b64_tr_b16 a[238:239], v199 offset:2048
  s_add_u32 m0, s45, 49152
  s_add_u32 s71, s67, 28
  s_and_b32 s71, s71, 7
  s_add_u32 s71, s71, 24
  s_mul_i32 s71, s71, 40960
  s_waitcnt lgkmcnt(8)
  buffer_load_dwordx4 v188, s[92:95], s71 offen lds
  buffer_load_dwordx4 v189, s[92:95], s71 offen offset:1024 lds
  buffer_load_dwordx4 v190, s[92:95], s71 offen offset:2048 lds
  buffer_load_dwordx4 v191, s[92:95], s71 offen offset:3072 lds
  ds_read_b64_tr_b16 a[240:241], v192 offset:32768
  ds_read_b64_tr_b16 a[242:243], v192 offset:34816
  ds_read_b64_tr_b16 a[244:245], v193 offset:32768
  ds_read_b64_tr_b16 a[246:247], v193 offset:34816
  ds_read_b64_tr_b16 a[248:249], v194 offset:32768
  ds_read_b64_tr_b16 a[250:251], v194 offset:34816
  ds_read_b64_tr_b16 a[252:253], v195 offset:32768
  ds_read_b64_tr_b16 a[254:255], v195 offset:34816
  s_add_u32 m0, s45, 65536
  s_add_u32 s71, s67, 29
  s_and_b32 s71, s71, 7
  s_add_u32 s71, s71, 24
  s_mul_i32 s71, s71, 40960
  s_waitcnt lgkmcnt(8)
  buffer_load_dwordx4 v188, s[92:95], s71 offen lds
  buffer_load_dwordx4 v189, s[92:95], s71 offen offset:1024 lds
  buffer_load_dwordx4 v190, s[92:95], s71 offen offset:2048 lds
  buffer_load_dwordx4 v191, s[92:95], s71 offen offset:3072 lds
  ds_read_b64_tr_b16 a[48:49], v196 offset:16384
  ds_read_b64_tr_b16 a[50:51], v196 offset:18432
  ds_read_b64_tr_b16 a[52:53], v197 offset:16384
  ds_read_b64_tr_b16 a[54:55], v197 offset:18432
  ds_read_b64_tr_b16 a[56:57], v198 offset:16384
  ds_read_b64_tr_b16 a[58:59], v198 offset:18432
  ds_read_b64_tr_b16 a[60:61], v199 offset:16384
  ds_read_b64_tr_b16 a[62:63], v199 offset:18432
  s_add_u32 m0, s45, 32768
  s_add_u32 s71, s67, 30
  s_and_b32 s71, s71, 7
  s_add_u32 s71, s71, 24
  s_mul_i32 s71, s71, 40960
  s_waitcnt lgkmcnt(8)
  buffer_load_dwordx4 v188, s[92:95], s71 offen lds
  buffer_load_dwordx4 v189, s[92:95], s71 offen offset:1024 lds
  buffer_load_dwordx4 v190, s[92:95], s71 offen offset:2048 lds
  buffer_load_dwordx4 v191, s[92:95], s71 offen offset:3072 lds
  s_waitcnt vmcnt(32)
  ds_read_b64_tr_b16 a[64:65], v192 offset:16384
  ds_read_b64_tr_b16 a[66:67], v192 offset:18432
  ds_read_b64_tr_b16 a[68:69], v193 offset:16384
  ds_read_b64_tr_b16 a[70:71], v193 offset:18432
  ds_read_b64_tr_b16 a[72:73], v194 offset:16384
  ds_read_b64_tr_b16 a[74:75], v194 offset:18432
  ds_read_b64_tr_b16 a[76:77], v195 offset:16384
  ds_read_b64_tr_b16 a[78:79], v195 offset:18432
  s_add_u32 m0, s45, 81920
  s_add_u32 s71, s67, 31
  s_and_b32 s71, s71, 7
  s_add_u32 s71, s71, 24
  s_mul_i32 s71, s71, 40960
  s_waitcnt lgkmcnt(8)
  buffer_load_dwordx4 v188, s[92:95], s71 offen lds
  buffer_load_dwordx4 v189, s[92:95], s71 offen offset:1024 lds
  buffer_load_dwordx4 v190, s[92:95], s71 offen offset:2048 lds
  buffer_load_dwordx4 v191, s[92:95], s71 offen offset:3072 lds
  s_waitcnt vmcnt(32)
  ds_read_b64_tr_b16 a[80:81], v196 offset:32768
  ds_read_b64_tr_b16 a[82:83], v196 offset:34816
  ds_read_b64_tr_b16 a[84:85], v197 offset:32768
  ds_read_b64_tr_b16 a[86:87], v197 offset:34816
  ds_read_b64_tr_b16 a[88:89], v198 offset:32768
  ds_read_b64_tr_b16 a[90:91], v198 offset:34816
  ds_read_b64_tr_b16 a[92:93], v199 offset:32768
  ds_read_b64_tr_b16 a[94:95], v199 offset:34816
  s_add_u32 m0, s45, 16384
  s_add_u32 s71, s67, 0
  s_and_b32 s71, s71, 7
  s_add_u32 s71, s71, 0
  s_mul_i32 s71, s71, 40960
  s_waitcnt lgkmcnt(8)
  buffer_load_dwordx4 v188, s[92:95], s71 offen lds
  buffer_load_dwordx4 v189, s[92:95], s71 offen offset:1024 lds
  buffer_load_dwordx4 v190, s[92:95], s71 offen offset:2048 lds
  buffer_load_dwordx4 v191, s[92:95], s71 offen offset:3072 lds
  s_waitcnt vmcnt(32)
  ds_read_b64_tr_b16 a[96:97], v196 offset:49152
  ds_read_b64_tr_b16 a[98:99], v196 offset:51200
  ds_read_b64_tr_b16 a[100:101], v197 offset:49152
  ds_read_b64_tr_b16 a[102:103], v197 offset:51200
  ds_read_b64_tr_b16 a[104:105], v198 offset:49152
  ds_read_b64_tr_b16 a[106:107], v198 offset:51200
  ds_read_b64_tr_b16 a[108:109], v199 offset:49152
  ds_read_b64_tr_b16 a[110:111], v199 offset:51200
  s_add_u32 m0, s45, 98304
  s_add_u32 s71, s67, 1
  s_and_b32 s71, s71, 7
  s_add_u32 s71, s71, 0
  s_mul_i32 s71, s71, 40960
  s_waitcnt lgkmcnt(8)
  buffer_load_dwordx4 v188, s[92:95], s71 offen lds
  buffer_load_dwordx4 v189, s[92:95], s71 offen offset:1024 lds
  buffer_load_dwordx4 v190, s[92:95], s71 offen offset:2048 lds
  buffer_load_dwordx4 v191, s[92:95], s71 offen offset:3072 lds
  s_waitcnt vmcnt(32)
  ds_read_b64_tr_b16 a[0:1], v192
  ds_read_b64_tr_b16 a[2:3], v192 offset:2048
  ds_read_b64_tr_b16 a[4:5], v193
  ds_read_b64_tr_b16 a[6:7], v193 offset:2048
  ds_read_b64_tr_b16 a[8:9], v194
  ds_read_b64_tr_b16 a[10:11], v194 offset:2048
  ds_read_b64_tr_b16 a[12:13], v195
  ds_read_b64_tr_b16 a[14:15], v195 offset:2048
  s_add_u32 m0, s45, 114688
  s_add_u32 s71, s67, 2
  s_and_b32 s71, s71, 7
  s_add_u32 s71, s71, 0
  s_mul_i32 s71, s71, 40960
  s_waitcnt lgkmcnt(8)
  buffer_load_dwordx4 v188, s[92:95], s71 offen lds
  buffer_load_dwordx4 v189, s[92:95], s71 offen offset:1024 lds
  buffer_load_dwordx4 v190, s[92:95], s71 offen offset:2048 lds
  buffer_load_dwordx4 v191, s[92:95], s71 offen offset:3072 lds
  s_waitcnt vmcnt(32)
  ds_read_b64_tr_b16 a[16:17], v200
  ds_read_b64_tr_b16 a[18:19], v200 offset:2048
  ds_read_b64_tr_b16 a[20:21], v201
  ds_read_b64_tr_b16 a[22:23], v201 offset:2048
  ds_read_b64_tr_b16 a[24:25], v202
  ds_read_b64_tr_b16 a[26:27], v202 offset:2048
  ds_read_b64_tr_b16 a[28:29], v203
  ds_read_b64_tr_b16 a[30:31], v203 offset:2048
  s_add_u32 m0, s45, 0
  s_add_u32 s71, s67, 3
  s_and_b32 s71, s71, 7
  s_add_u32 s71, s71, 0
  s_mul_i32 s71, s71, 40960
  s_waitcnt lgkmcnt(8)
  buffer_load_dwordx4 v188, s[92:95], s71 offen lds
  buffer_load_dwordx4 v189, s[92:95], s71 offen offset:1024 lds
  buffer_load_dwordx4 v190, s[92:95], s71 offen offset:2048 lds
  buffer_load_dwordx4 v191, s[92:95], s71 offen offset:3072 lds
  s_waitcnt vmcnt(32)
  ds_read_b64_tr_b16 a[32:33], v200 offset:16384
  ds_read_b64_tr_b16 a[34:35], v200 offset:18432
  ds_read_b64_tr_b16 a[36:37], v201 offset:16384
  ds_read_b64_tr_b16 a[38:39], v201 offset:18432
  ds_read_b64_tr_b16 a[40:41], v202 offset:16384
  ds_read_b64_tr_b16 a[42:43], v202 offset:18432
  ds_read_b64_tr_b16 a[44:45], v203 offset:16384
  ds_read_b64_tr_b16 a[46:47], v203 offset:18432
  s_add_u32 m0, s45, 131072
  s_add_u32 s71, s67, 4
  s_and_b32 s71, s71, 7
  s_add_u32 s71, s71, 0
  s_mul_i32 s71, s71, 40960
  s_waitcnt lgkmcnt(8)
  buffer_load_dwordx4 v188, s[92:95], s71 offen lds
  buffer_load_dwordx4 v189, s[92:95], s71 offen offset:1024 lds
  buffer_load_dwordx4 v190, s[92:95], s71 offen offset:2048 lds
  buffer_load_dwordx4 v191, s[92:95], s71 offen offset:3072 lds
  s_waitcnt vmcnt(32)
  ds_read_b64_tr_b16 a[112:113], v192 offset:49152
  ds_read_b64_tr_b16 a[114:115], v192 offset:51200
  ds_read_b64_tr_b16 a[116:117], v193 offset:49152
  ds_read_b64_tr_b16 a[118:119], v193 offset:51200
  ds_read_b64_tr_b16 a[120:121], v194 offset:49152
  ds_read_b64_tr_b16 a[122:123], v194 offset:51200
  ds_read_b64_tr_b16 a[124:125], v195 offset:49152
  ds_read_b64_tr_b16 a[126:127], v195 offset:51200
  s_add_u32 m0, s45, 147456
  s_add_u32 s71, s67, 5
  s_and_b32 s71, s71, 7
  s_add_u32 s71, s71, 0
  s_mul_i32 s71, s71, 40960
  s_waitcnt lgkmcnt(8)
  buffer_load_dwordx4 v188, s[92:95], s71 offen lds
  buffer_load_dwordx4 v189, s[92:95], s71 offen offset:1024 lds
  buffer_load_dwordx4 v190, s[92:95], s71 offen offset:2048 lds
  buffer_load_dwordx4 v191, s[92:95], s71 offen offset:3072 lds
  s_cmp_lg_u32 s36, 0
  s_cbranch_scc1 K1_noep
  buffer_load_dword v248, off, s[52:55], s47 sc1
K1_noep:
  s_waitcnt vmcnt(32)
  ds_read_b64_tr_b16 a[128:129], v196
  ds_read_b64_tr_b16 a[130:131], v196 offset:2048
  ds_read_b64_tr_b16 a[132:133], v197
  ds_read_b64_tr_b16 a[134:135], v197 offset:2048
  ds_read_b64_tr_b16 a[136:137], v198
  ds_read_b64_tr_b16 a[138:139], v198 offset:2048
  ds_read_b64_tr_b16 a[140:141], v199
  ds_read_b64_tr_b16 a[142:143], v199 offset:2048
  s_add_u32 m0, s45, 49152
  s_add_u32 s71, s67, 6
  s_and_b32 s71, s71, 7
  s_add_u32 s71, s71, 0
  s_mul_i32 s71, s71, 40960
  s_waitcnt lgkmcnt(8)
  buffer_load_dwordx4 v188, s[92:95], s71 offen lds
  buffer_load_dwordx4 v189, s[92:95], s71 offen offset:1024 lds
  buffer_load_dwordx4 v190, s[92:95], s71 offen offset:2048 lds
  buffer_load_dwordx4 v191, s[92:95], s71 offen offset:3072 lds
  s_waitcnt vmcnt(32)
  ds_read_b64_tr_b16 a[144:145], v192 offset:32768
  ds_read_b64_tr_b16 a[146:147], v192 offset:34816
  ds_read_b64_tr_b16 a[148:149], v193 offset:32768
  ds_read_b64_tr_b16 a[150:151], v193 offset:34816
  ds_read_b64_tr_b16 a[152:153], v194 offset:32768
  ds_read_b64_tr_b16 a[154:155], v194 offset:34816
  ds_read_b64_tr_b16 a[156:157], v195 offset:32768
  ds_read_b64_tr_b16 a[158:159], v195 offset:34816
  s_add_u32 m0, s45, 65536
  s_add_u32 s71, s67, 7
  s_and_b32 s71, s71, 7
  s_add_u32 s71, s71, 0
  s_mul_i32 s71, s71, 40960
  s_waitcnt lgkmcnt(8)
  buffer_load_dwordx4 v188, s[92:95], s71 offen lds
  buffer_load_dwordx4 v189, s[92:95], s71 offen offset:1024 lds
  buffer_load_dwordx4 v190, s[92:95], s71 offen offset:2048 lds
  buffer_load_dwordx4 v191, s[92:95], s71 offen offset:3072 lds
  s_waitcnt vmcnt(32)
  ds_read_b64_tr_b16 a[160:161], v196 offset:16384
  ds_read_b64_tr_b16 a[162:163], v196 offset:18432
  ds_read_b64_tr_b16 a[164:165], v197 offset:16384
  ds_read_b64_tr_b16 a[166:167], v197 offset:18432
  ds_read_b64_tr_b16 a[168:169], v198 offset:16384
  ds_read_b64_tr_b16 a[170:171], v198 offset:18432
  ds_read_b64_tr_b16 a[172:173], v199 offset:16384
  ds_read_b64_tr_b16 a[174:175], v199 offset:18432
  s_add_u32 m0, s45, 32768
  s_add_u32 s71, s67, 8
  s_and_b32 s71, s71, 7
  s_add_u32 s71, s71, 8
  s_mul_i32 s71, s71, 40960
  s_waitcnt lgkmcnt(8)
  buffer_load_dwordx4 v188, s[92:95], s71 offen lds
  buffer_load_dwordx4 v189, s[92:95], s71 offen offset:1024 lds
  buffer_load_dwordx4 v190, s[92:95], s71 offen offset:2048 lds
  buffer_load_dwordx4 v191, s[92:95], s71 offen offset:3072 lds
  s_add_u32 m0, s45, 81920
  s_add_u32 s71, s67, 9
  s_and_b32 s71, s71, 7
  s_add_u32 s71, s71, 8
  s_mul_i32 s71, s71, 40960
  s_waitcnt lgkmcnt(0)
  buffer_load_dwordx4 v188, s[92:95], s71 offen lds
  buffer_load_dwordx4 v189, s[92:95], s71 offen offset:1024 lds
  buffer_load_dwordx4 v190, s[92:95], s71 offen offset:2048 lds
  buffer_load_dwordx4 v191, s[92:95], s71 offen offset:3072 lds
  s_cmp_lg_u32 s36, 0
  s_cbranch_scc1 K1_polled
  s_waitcnt vmcnt(16)
  v_readfirstlane_b32 s74, v248
  s_nop 1
  s_cmp_ge_u32 s74, 32
  s_cbranch_scc1 K1_polled
K1_poll:
  buffer_load_dword v248, off, s[52:55], s47 sc1
  s_add_u32 s73, s73, 1
  s_cmp_ge_u32 s73, 131072
  s_cbranch_scc1 K1_polled
  s_waitcnt vmcnt(0)
  v_readfirstlane_b32 s74, v248
  s_nop 1
  s_cmp_ge_u32 s74, 32
  s_cbranch_scc1 K1_polled
  s_sleep 6
  s_branch K1_poll
K1_polled:
  s_barrier
  s_add_u32 s72, s67, 0
  s_and_b32 s72, s72, 7
  s_add_u32 s72, s72, 0
  s_lshl_b32 s72, s72, 10
  buffer_load_dwordx4 v[64:67], v204, s[32:35], s72 offen sc1
  buffer_load_dwordx4 v[68:71], v205, s[32:35], s72 offen sc1
  buffer_load_dwordx4 v[72:75], v206, s[32:35], s72 offen sc1
  buffer_load_dwordx4 v[76:79], v207, s[32:35], s72 offen sc1
  s_add_u32 s72, s67, 1
  s_and_b32 s72, s72, 7
  s_add_u32 s72, s72, 0
  s_lshl_b32 s72, s72, 10
  buffer_load_dwordx4 v[80:83], v204, s[32:35], s72 offen sc1
  buffer_load_dwordx4 v[84:87], v205, s[32:35], s72 offen sc1
  buffer_load_dwordx4 v[88:91], v206, s[32:35], s72 offen sc1
  buffer_load_dwordx4 v[92:95], v207, s[32:35], s72 offen sc1
  s_add_u32 s72, s67, 2
  s_and_b32 s72, s72, 7
  s_add_u32 s72, s72, 0
  s_lshl_b32 s72, s72, 10
  buffer_load_dwordx4 v[96:99], v204, s[32:35], s72 offen sc1
  buffer_load_dwordx4 v[100:103], v205, s[32:35], s72 offen sc1
  buffer_load_dwordx4 v[104:107], v206, s[32:35], s72 offen sc1
  buffer_load_dwordx4 v[108:111], v207, s[32:35], s72 offen sc1
  s_add_u32 s72, s67, 3
  s_and_b32 s72, s72, 7
  s_add_u32 s72, s72, 0
  s_lshl_b32 s72, s72, 10
  buffer_load_dwordx4 v[112:115], v204, s[32:35], s72 offen sc1
  buffer_load_dwordx4 v[116:119], v205, s[32:35], s72 offen sc1
  buffer_load_dwordx4 v[120:123], v206, s[32:35], s72 offen sc1
  buffer_load_dwordx4 v[124:127], v207, s[32:35], s72 offen sc1
  s_add_u32 s72, s67, 4
  s_and_b32 s72, s72, 7
  s_add_u32 s72, s72, 0
  s_lshl_b32 s72, s72, 10
  buffer_load_dwordx4 v[128:131], v204, s[32:35], s72 offen sc1
  buffer_load_dwordx4 v[132:135], v205, s[32:35], s72 offen sc1
  buffer_load_dwordx4 v[136:139], v206, s[32:35], s72 offen sc1
  buffer_load_dwordx4 v[140:143], v207, s[32:35], s72 offen sc1
  s_waitcnt vmcnt(56)
  ds_read_b64_tr_b16 v[208:209], v192 offset:16384
  ds_read_b64_tr_b16 v[210:211], v192 offset:18432
  ds_read_b64_tr_b16 v[212:213], v193 offset:16384
  ds_read_b64_tr_b16 v[214:215], v193 offset:18432
  ds_read_b64_tr_b16 v[216:217], v194 offset:16384
  ds_read_b64_tr_b16 v[218:219], v194 offset:18432
  ds_read_b64_tr_b16 v[220:221], v195 offset:16384
  ds_read_b64_tr_b16 v[222:223], v195 offset:18432
  v_add_u32 v240, s45, v186
  v_xor_b32 v241, 4096, v240
  v_xor_b32 v242, 8192, v240
  v_xor_b32 v243, 12288, v240
  v_and_b32 v245, 15, v187
  v_mul_u32_u24 v245, 1280, v245
  v_lshrrev_b32 v244, 4, v187
  v_lshl_add_u32 v245, v244, 3, v245
  s_waitcnt vmcnt(16) lgkmcnt(0)
  v_mfma_f32_16x16x32_bf16 v[0:3], v[208:211], v[64:67], 0
  ds_read_b64_tr_b16 v[224:225], v196 offset:32768
  ds_read_b64_tr_b16 v[226:227], v196 offset:34816
  v_mfma_f32_16x16x32_bf16 v[4:7], v[212:215], v[64:67], 0
  s_add_u32 s72, s67, 5
  s_and_b32 s72, s72, 7
  s_add_u32 s72, s72, 0
  s_lshl_b32 s72, s72, 10
  buffer_load_dwordx4 v[144:147], v204, s[32:35], s72 offen sc1
  v_mfma_f32_16x16x32_bf16 v[8:11], v[216:219], v[64:67], 0
  ds_read_b64_tr_b16 v[228:229], v197 offset:32768
  ds_read_b64_tr_b16 v[230:231], v197 offset:34816
  v_mfma_f32_16x16x32_bf16 v[12:15], v[220:223], v[64:67], 0
  buffer_load_dwordx4 v[148:151], v205, s[32:35], s72 offen sc1
  v_mfma_f32_16x16x32_bf16 v[16:19], v[208:211], v[68:71], 0
  ds_read_b64_tr_b16 v[232:233], v198 offset:32768
  ds_read_b64_tr_b16 v[234:235], v198 offset:34816
  v_mfma_f32_16x16x32_bf16 v[20:23], v[212:215], v[68:71], 0
  buffer_load_dwordx4 v[152:155], v206, s[32:35], s72 offen sc1
  v_mfma_f32_16x16x32_bf16 v[24:27], v[216:219], v[68:71], 0
  ds_read_b64_tr_b16 v[236:237], v199 offset:32768
  ds_read_b64_tr_b16 v[238:239], v199 offset:34816
  v_mfma_f32_16x16x32_bf16 v[28:31], v[220:223], v[68:71], 0
  buffer_load_dwordx4 v[156:159], v207, s[32:35], s72 offen sc1
  v_mfma_f32_16x16x32_bf16 v[32:35], v[208:211], v[72:75], 0
  v_mfma_f32_16x16x32_bf16 v[36:39], v[212:215], v[72:75], 0
  s_add_u32 m0, s45, 16384
  s_add_u32 s71, s67, 11
  s_and_b32 s71, s71, 7
  s_add_u32 s71, s71, 8
  s_mul_i32 s71, s71, 40960
  buffer_load_dwordx4 v188, s[92:95], s71 offen lds
  v_mfma_f32_16x16x32_bf16 v[40:43], v[216:219], v[72:75], 0
  v_mfma_f32_16x16x32_bf16 v[44:47], v[220:223], v[72:75], 0
  buffer_load_dwordx4 v189, s[92:95], s71 offen offset:1024 lds
  v_mfma_f32_16x16x32_bf16 v[48:51], v[208:211], v[76:79], 0
  v_mfma_f32_16x16x32_bf16 v[52:55], v[212:215], v[76:79], 0
  buffer_load_dwordx4 v190, s[92:95], s71 offen offset:2048 lds
  v_mfma_f32_16x16x32_bf16 v[56:59], v[216:219], v[76:79], 0
  v_mfma_f32_16x16x32_bf16 v[60:63], v[220:223], v[76:79], 0
  buffer_load_dwordx4 v191, s[92:95], s71 offen offset:3072 lds
  s_waitcnt vmcnt(20) lgkmcnt(0)
  v_mfma_f32_16x16x32_bf16 v[0:3], v[224:227], v[80:83], v[0:3]
  ds_read_b64_tr_b16 v[208:209], v196 offset:49152
  ds_read_b64_tr_b16 v[210:211], v196 offset:51200
  v_mfma_f32_16x16x32_bf16 v[4:7], v[228:231], v[80:83], v[4:7]
  s_add_u32 s72, s67, 6
  s_and_b32 s72, s72, 7
  s_add_u32 s72, s72, 0
  s_lshl_b32 s72, s72, 10
  buffer_load_dwordx4 v[64:67], v204, s[32:35], s72 offen sc1
  v_mfma_f32_16x16x32_bf16 v[8:11], v[232:235], v[80:83], v[8:11]
  ds_read_b64_tr_b16 v[212:213], v197 offset:49152
  ds_read_b64_tr_b16 v[214:215], v197 offset:51200
  v_mfma_f32_16x16x32_bf16 v[12:15], v[236:239], v[80:83], v[12:15]
  buffer_load_dwordx4 v[68:71], v205, s[32:35], s72 offen sc1
  v_mfma_f32_16x16x32_bf16 v[16:19], v[224:227], v[84:87], v[16:19]
  ds_read_b64_tr_b16 v[216:217], v198 offset:49152
  ds_read_b64_tr_b16 v[218:219], v198 offset:51200
  v_mfma_f32_16x16x32_bf16 v[20:23], v[228:231], v[84:87], v[20:23]
  buffer_load_dwordx4 v[72:75], v206, s[32:35], s72 offen sc1
  v_mfma_f32_16x16x32_bf16 v[24:27], v[232:235], v[84:87], v[24:27]
  ds_read_b64_tr_b16 v[220:221], v199 offset:49152
  ds_read_b64_tr_b16 v[222:223], v199 offset:51200
  v_mfma_f32_16x16x32_bf16 v[28:31], v[236:239], v[84:87], v[28:31]
  buffer_load_dwordx4 v[76:79], v207, s[32:35], s72 offen sc1
  v_mfma_f32_16x16x32_bf16 v[32:35], v[224:227], v[88:91], v[32:35]
  v_mfma_f32_16x16x32_bf16 v[36:39], v[228:231], v[88:91], v[36:39]
  s_add_u32 m0, s45, 98304
  s_add_u32 s71, s67, 13
  s_and_b32 s71, s71, 7
  s_add_u32 s71, s71, 8
  s_mul_i32 s71, s71, 40960
  buffer_load_dwordx4 v188, s[92:95], s71 offen lds
  v_mfma_f32_16x16x32_bf16 v[40:43], v[232:235], v[88:91], v[40:43]
  v_mfma_f32_16x16x32_bf16 v[44:47], v[236:239], v[88:91], v[44:47]
  buffer_load_dwordx4 v189, s[92:95], s71 offen offset:1024 lds
  v_mfma_f32_16x16x32_bf16 v[48:51], v[224:227], v[92:95], v[48:51]
  v_mfma_f32_16x16x32_bf16 v[52:55], v[228:231], v[92:95], v[52:55]
  buffer_load_dwordx4 v190, s[92:95], s71 offen offset:2048 lds
  v_mfma_f32_16x16x32_bf16 v[56:59], v[232:235], v[92:95], v[56:59]
  v_mfma_f32_16x16x32_bf16 v[60:63], v[236:239], v[92:95], v[60:63]
  buffer_load_dwordx4 v191, s[92:95], s71 offen offset:3072 lds
  s_waitcnt vmcnt(24) lgkmcnt(0)
  v_mfma_f32_16x16x32_bf16 v[0:3], v[208:211], v[96:99], v[0:3]
  ds_read_b64_tr_b16 v[224:225], v192
  ds_read_b64_tr_b16 v[226:227], v192 offset:2048
  v_mfma_f32_16x16x32_bf16 v[4:7], v[212:215], v[96:99], v[4:7]
  s_add_u32 s72, s67, 7
  s_and_b32 s72, s72, 7
  s_add_u32 s72, s72, 0
  s_lshl_b32 s72, s72, 10
  buffer_load_dwordx4 v[80:83], v204, s[32:35], s72 offen sc1
  v_mfma_f32_16x16x32_bf16 v[8:11], v[216:219], v[96:99], v[8:11]
  ds_read_b64_tr_b16 v[228:229], v193
  ds_read_b64_tr_b16 v[230:231], v193 offset:2048
  v_mfma_f32_16x16x32_bf16 v[12:15], v[220:223], v[96:99], v[12:15]
  buffer_load_dwordx4 v[84:87], v205, s[32:35], s72 offen sc1
  v_mfma_f32_16x16x32_bf16 v[16:19], v[208:211], v[100:103], v[16:19]
  ds_read_b64_tr_b16 v[232:233], v194
  ds_read_b64_tr_b16 v[234:235], v194 offset:2048
  v_mfma_f32_16x16x32_bf16 v[20:23], v[212:215], v[100:103], v[20:23]
  buffer_load_dwordx4 v[88:91], v206, s[32:35], s72 offen sc1
  v_mfma_f32_16x16x32_bf16 v[24:27], v[216:219], v[100:103], v[24:27]
  ds_read_b64_tr_b16 v[236:237], v195
  ds_read_b64_tr_b16 v[238:239], v195 offset:2048
  v_mfma_f32_16x16x32_bf16 v[28:31], v[220:223], v[100:103], v[28:31]
  buffer_load_dwordx4 v[92:95], v207, s[32:35], s72 offen sc1
  v_mfma_f32_16x16x32_bf16 v[32:35], v[208:211], v[104:107], v[32:35]
  v_mfma_f32_16x16x32_bf16 v[36:39], v[212:215], v[104:107], v[36:39]
  s_add_u32 m0, s45, 114688
  s_add_u32 s71, s67, 15
  s_and_b32 s71, s71, 7
  s_add_u32 s71, s71, 8
  s_mul_i32 s71, s71, 40960
  buffer_load_dwordx4 v188, s[92:95], s71 offen lds
  v_mfma_f32_16x16x32_bf16 v[40:43], v[216:219], v[104:107], v[40:43]
  v_mfma_f32_16x16x32_bf16 v[44:47], v[220:223], v[104:107], v[44:47]
  buffer_load_dwordx4 v189, s[92:95], s71 offen offset:1024 lds
  v_mfma_f32_16x16x32_bf16 v[48:51], v[208:211], v[108:111], v[48:51]
  v_mfma_f32_16x16x32_bf16 v[52:55], v[212:215], v[108:111], v[52:55]
  buffer_load_dwordx4 v190, s[92:95], s71 offen offset:2048 lds
  v_mfma_f32_16x16x32_bf16 v[56:59], v[216:219], v[108:111], v[56:59]
  v_mfma_f32_16x16x32_bf16 v[60:63], v[220:223], v[108:111], v[60:63]
  buffer_load_dwordx4 v191, s[92:95], s71 offen offset:3072 lds
  s_waitcnt vmcnt(28) lgkmcnt(0)
  v_mfma_f32_16x16x32_bf16 v[0:3], v[224:227], v[112:115], v[0:3]
  ds_read_b64_tr_b16 v[208:209], v200
  ds_read_b64_tr_b16 v[210:211], v200 offset:2048
  v_mfma_f32_16x16x32_bf16 v[4:7], v[228:231], v[112:115], v[4:7]
  s_add_u32 s72, s67, 8
  s_and_b32 s72, s72, 7
  s_add_u32 s72, s72, 8
  s_lshl_b32 s72, s72, 10
  buffer_load_dwordx4 v[96:99], v204, s[32:35], s72 offen sc1
  v_mfma_f32_16x16x32_bf16 v[8:11], v[232:235], v[112:115], v[8:11]
  ds_read_b64_tr_b16 v[212:213], v201
  ds_read_b64_tr_b16 v[214:215], v201 offset:2048
  v_mfma_f32_16x16x32_bf16 v[12:15], v[236:239], v[112:115], v[12:15]
  buffer_load_dwordx4 v[100:103], v205, s[32:35], s72 offen sc1
  v_mfma_f32_16x16x32_bf16 v[16:19], v[224:227], v[116:119], v[16:19]
  ds_read_b64_tr_b16 v[216:217], v202
  ds_read_b64_tr_b16 v[218:219], v202 offset:2048
  v_mfma_f32_16x16x32_bf16 v[20:23], v[228:231], v[116:119], v[20:23]
  buffer_load_dwordx4 v[104:107], v206, s[32:35], s72 offen sc1
  v_mfma_f32_16x16x32_bf16 v[24:27], v[232:235], v[116:119], v[24:27]
  ds_read_b64_tr_b16 v[220:221], v203
  ds_read_b64_tr_b16 v[222:223], v203 offset:2048
  v_mfma_f32_16x16x32_bf16 v[28:31], v[236:239], v[116:119], v[28:31]
  buffer_load_dwordx4 v[108:111], v207, s[32:35], s72 offen sc1
  v_mfma_f32_16x16x32_bf16 v[32:35], v[224:227], v[120:123], v[32:35]
  v_mfma_f32_16x16x32_bf16 v[36:39], v[228:231], v[120:123], v[36:39]
  s_add_u32 m0, s45, 0
  s_add_u32 s71, s67, 17
  s_and_b32 s71, s71, 7
  s_add_u32 s71, s71, 16
  s_mul_i32 s71, s71, 40960
  buffer_load_dwordx4 v188, s[92:95], s71 offen lds
  v_mfma_f32_16x16x32_bf16 v[40:43], v[232:235], v[120:123], v[40:43]
  v_mfma_f32_16x16x32_bf16 v[44:47], v[236:239], v[120:123], v[44:47]
  buffer_load_dwordx4 v189, s[92:95], s71 offen offset:1024 lds
  v_mfma_f32_16x16x32_bf16 v[48:51], v[224:227], v[124:127], v[48:51]
  v_mfma_f32_16x16x32_bf16 v[52:55], v[228:231], v[124:127], v[52:55]
  buffer_load_dwordx4 v190, s[92:95], s71 offen offset:2048 lds
  v_mfma_f32_16x16x32_bf16 v[56:59], v[232:235], v[124:127], v[56:59]
  v_mfma_f32_16x16x32_bf16 v[60:63], v[236:239], v[124:127], v[60:63]
  buffer_load_dwordx4 v191, s[92:95], s71 offen offset:3072 lds
  s_waitcnt vmcnt(32) lgkmcnt(0)
  v_mfma_f32_16x16x32_bf16 v[0:3], v[208:211], v[128:131], v[0:3]
  ds_read_b64_tr_b16 v[224:225], v200 offset:16384
  ds_read_b64_tr_b16 v[226:227], v200 offset:18432
  v_mfma_f32_16x16x32_bf16 v[4:7], v[212:215], v[128:131], v[4:7]
  s_add_u32 s72, s67, 9
  s_and_b32 s72, s72, 7
  s_add_u32 s72, s72, 8
  s_lshl_b32 s72, s72, 10
  buffer_load_dwordx4 v[112:115], v204, s[32:35], s72 offen sc1
  v_mfma_f32_16x16x32_bf16 v[8:11], v[216:219], v[128:131], v[8:11]
  ds_read_b64_tr_b16 v[228:229], v201 offset:16384
  ds_read_b64_tr_b16 v[230:231], v201 offset:18432
  v_mfma_f32_16x16x32_bf16 v[12:15], v[220:223], v[128:131], v[12:15]
  buffer_load_dwordx4 v[116:119], v205, s[32:35], s72 offen sc1
  v_mfma_f32_16x16x32_bf16 v[16:19], v[208:211], v[132:135], v[16:19]
  ds_read_b64_tr_b16 v[232:233], v202 offset:16384
  ds_read_b64_tr_b16 v[234:235], v202 offset:18432
  v_mfma_f32_16x16x32_bf16 v[20:23], v[212:215], v[132:135], v[20:23]
  buffer_load_dwordx4 v[120:123], v206, s[32:35], s72 offen sc1
  v_mfma_f32_16x16x32_bf16 v[24:27], v[216:219], v[132:135], v[24:27]
  ds_read_b64_tr_b16 v[236:237], v203 offset:16384
  ds_read_b64_tr_b16 v[238:239], v203 offset:18432
  v_mfma_f32_16x16x32_bf16 v[28:31], v[220:223], v[132:135], v[28:31]
  buffer_load_dwordx4 v[124:127], v207, s[32:35], s72 offen sc1
  v_mfma_f32_16x16x32_bf16 v[32:35], v[208:211], v[136:139], v[32:35]
  v_mfma_f32_16x16x32_bf16 v[36:39], v[212:215], v[136:139], v[36:39]
  s_add_u32 m0, s45, 131072
  s_add_u32 s71, s67, 19
  s_and_b32 s71, s71, 7
  s_add_u32 s71, s71, 16
  s_mul_i32 s71, s71, 40960
  buffer_load_dwordx4 v188, s[92:95], s71 offen lds
  v_mfma_f32_16x16x32_bf16 v[40:43], v[216:219], v[136:139], v[40:43]
  v_mfma_f32_16x16x32_bf16 v[44:47], v[220:223], v[136:139], v[44:47]
  buffer_load_dwordx4 v189, s[92:95], s71 offen offset:1024 lds
  v_mfma_f32_16x16x32_bf16 v[48:51], v[208:211], v[140:143], v[48:51]
  v_mfma_f32_16x16x32_bf16 v[52:55], v[212:215], v[140:143], v[52:55]
  buffer_load_dwordx4 v190, s[92:95], s71 offen offset:2048 lds
  v_mfma_f32_16x16x32_bf16 v[56:59], v[216:219], v[140:143], v[56:59]
  v_mfma_f32_16x16x32_bf16 v[60:63], v[220:223], v[140:143], v[60:63]
  buffer_load_dwordx4 v191, s[92:95], s71 offen offset:3072 lds
  s_waitcnt vmcnt(36) lgkmcnt(0)
  v_mfma_f32_16x16x32_bf16 v[0:3], v[224:227], v[144:147], v[0:3]
  ds_read_b64_tr_b16 v[208:209], v192 offset:49152
  ds_read_b64_tr_b16 v[210:211], v192 offset:51200
  v_mfma_f32_16x16x32_bf16 v[4:7], v[228:231], v[144:147], v[4:7]
  s_add_u32 s72, s67, 10
  s_and_b32 s72, s72, 7
  s_add_u32 s72, s72, 8
  s_lshl_b32 s72, s72, 10
  buffer_load_dwordx4 v[128:131], v204, s[32:35], s72 offen sc1
  v_mfma_f32_16x16x32_bf16 v[8:11], v[232:235], v[144:147], v[8:11]
  ds_read_b64_tr_b16 v[212:213], v193 offset:49152
  ds_read_b64_tr_b16 v[214:215], v193 offset:51200
  v_mfma_f32_16x16x32_bf16 v[12:15], v[236:239], v[144:147], v[12:15]
  buffer_load_dwordx4 v[132:135], v205, s[32:35], s72 offen sc1
  v_mfma_f32_16x16x32_bf16 v[16:19], v[224:227], v[148:151], v[16:19]
  ds_read_b64_tr_b16 v[216:217], v194 offset:49152
  ds_read_b64_tr_b16 v[218:219], v194 offset:51200
  v_mfma_f32_16x16x32_bf16 v[20:23], v[228:231], v[148:151], v[20:23]
  buffer_load_dwordx4 v[136:139], v206, s[32:35], s72 offen sc1
  v_mfma_f32_16x16x32_bf16 v[24:27], v[232:235], v[148:151], v[24:27]
  ds_read_b64_tr_b16 v[220:221], v195 offset:49152
  ds_read_b64_tr_b16 v[222:223], v195 offset:51200
  v_mfma_f32_16x16x32_bf16 v[28:31], v[236:239], v[148:151], v[28:31]
  buffer_load_dwordx4 v[140:143], v207, s[32:35], s72 offen sc1
  v_mfma_f32_16x16x32_bf16 v[32:35], v[224:227], v[152:155], v[32:35]
  v_mfma_f32_16x16x32_bf16 v[36:39], v[228:231], v[152:155], v[36:39]
  s_add_u32 m0, s45, 147456
  s_add_u32 s71, s67, 21
  s_and_b32 s71, s71, 7
  s_add_u32 s71, s71, 16
  s_mul_i32 s71, s71, 40960
  buffer_load_dwordx4 v188, s[92:95], s71 offen lds
  v_mfma_f32_16x16x32_bf16 v[40:43], v[232:235], v[152:155], v[40:43]
  v_mfma_f32_16x16x32_bf16 v[44:47], v[236:239], v[152:155], v[44:47]
  buffer_load_dwordx4 v189, s[92:95], s71 offen offset:1024 lds
  v_mfma_f32_16x16x32_bf16 v[48:51], v[224:227], v[156:159], v[48:51]
  v_mfma_f32_16x16x32_bf16 v[52:55], v[228:231], v[156:159], v[52:55]
  buffer_load_dwordx4 v190, s[92:95], s71 offen offset:2048 lds
  v_mfma_f32_16x16x32_bf16 v[56:59], v[232:235], v[156:159], v[56:59]
  v_mfma_f32_16x16x32_bf16 v[60:63], v[236:239], v[156:159], v[60:63]
  buffer_load_dwordx4 v191, s[92:95], s71 offen offset:3072 lds
  s_waitcnt vmcnt(36) lgkmcnt(0)
  v_mfma_f32_16x16x32_bf16 v[0:3], v[208:211], v[64:67], v[0:3]
  ds_read_b64_tr_b16 v[224:225], v196
  ds_read_b64_tr_b16 v[226:227], v196 offset:2048
  v_mfma_f32_16x16x32_bf16 v[4:7], v[212:215], v[64:67], v[4:7]
  s_add_u32 s72, s67, 11
  s_and_b32 s72, s72, 7
  s_add_u32 s72, s72, 8
  s_lshl_b32 s72, s72, 10
  buffer_load_dwordx4 v[144:147], v204, s[32:35], s72 offen sc1
  v_mfma_f32_16x16x32_bf16 v[8:11], v[216:219], v[64:67], v[8:11]
  ds_read_b64_tr_b16 v[228:229], v197
  ds_read_b64_tr_b16 v[230:231], v197 offset:2048
  v_mfma_f32_16x16x32_bf16 v[12:15], v[220:223], v[64:67], v[12:15]
  v_mfma_f32_16x16x32_bf16 v[16:19], v[208:211], v[68:71], v[16:19]
  ds_read_b64_tr_b16 v[232:233], v198
  ds_read_b64_tr_b16 v[234:235], v198 offset:2048
  v_mfma_f32_16x16x32_bf16 v[20:23], v[212:215], v[68:71], v[20:23]
  buffer_load_dwordx4 v[148:151], v205, s[32:35], s72 offen sc1
  v_mfma_f32_16x16x32_bf16 v[24:27], v[216:219], v[68:71], v[24:27]
  ds_read_b64_tr_b16 v[236:237], v199
  ds_read_b64_tr_b16 v[238:239], v199 offset:2048
  v_mfma_f32_16x16x32_bf16 v[28:31], v[220:223], v[68:71], v[28:31]
  v_mfma_f32_16x16x32_bf16 v[32:35], v[208:211], v[72:75], v[32:35]
  v_mfma_f32_16x16x32_bf16 v[36:39], v[212:215], v[72:75], v[36:39]
  buffer_load_dwordx4 v[152:155], v206, s[32:35], s72 offen sc1
  v_mfma_f32_16x16x32_bf16 v[40:43], v[216:219], v[72:75], v[40:43]
  v_mfma_f32_16x16x32_bf16 v[44:47], v[220:223], v[72:75], v[44:47]
  v_mfma_f32_16x16x32_bf16 v[48:51], v[208:211], v[76:79], v[48:51]
  v_mfma_f32_16x16x32_bf16 v[52:55], v[212:215], v[76:79], v[52:55]
  buffer_load_dwordx4 v[156:159], v207, s[32:35], s72 offen sc1
  v_mfma_f32_16x16x32_bf16 v[56:59], v[216:219], v[76:79], v[56:59]
  v_mfma_f32_16x16x32_bf16 v[60:63], v[220:223], v[76:79], v[60:63]
  s_waitcnt vmcnt(32) lgkmcnt(0)
  v_mfma_f32_16x16x32_bf16 v[0:3], v[224:227], v[80:83], v[0:3]
  ds_read_b64_tr_b16 v[208:209], v192 offset:32768
  ds_read_b64_tr_b16 v[210:211], v192 offset:34816
  v_mfma_f32_16x16x32_bf16 v[4:7], v[228:231], v[80:83], v[4:7]
  s_add_u32 s72, s67, 12
  s_and_b32 s72, s72, 7
  s_add_u32 s72, s72, 8
  s_lshl_b32 s72, s72, 10
  buffer_load_dwordx4 v[64:67], v204, s[32:35], s72 offen sc1
  v_mfma_f32_16x16x32_bf16 v[8:11], v[232:235], v[80:83], v[8:11]
  ds_read_b64_tr_b16 v[212:213], v193 offset:32768
  ds_read_b64_tr_b16 v[214:215], v193 offset:34816
  v_mfma_f32_16x16x32_bf16 v[12:15], v[236:239], v[80:83], v[12:15]
  v_mfma_f32_16x16x32_bf16 v[16:19], v[224:227], v[84:87], v[16:19]
  ds_read_b64_tr_b16 v[216:217], v194 offset:32768
  ds_read_b64_tr_b16 v[218:219], v194 offset:34816
  v_mfma_f32_16x16x32_bf16 v[20:23], v[228:231], v[84:87], v[20:23]
  buffer_load_dwordx4 v[68:71], v205, s[32:35], s72 offen sc1
  v_mfma_f32_16x16x32_bf16 v[24:27], v[232:235], v[84:87], v[24:27]
  ds_read_b64_tr_b16 v[220:221], v195 offset:32768
  ds_read_b64_tr_b16 v[222:223], v195 offset:34816
  v_mfma_f32_16x16x32_bf16 v[28:31], v[236:239], v[84:87], v[28:31]
  v_mfma_f32_16x16x32_bf16 v[32:35], v[224:227], v[88:91], v[32:35]
  v_mfma_f32_16x16x32_bf16 v[36:39], v[228:231], v[88:91], v[36:39]
  buffer_load_dwordx4 v[72:75], v206, s[32:35], s72 offen sc1
  v_mfma_f32_16x16x32_bf16 v[40:43], v[232:235], v[88:91], v[40:43]
  v_mfma_f32_16x16x32_bf16 v[44:47], v[236:239], v[88:91], v[44:47]
  v_mfma_f32_16x16x32_bf16 v[48:51], v[224:227], v[92:95], v[48:51]
  v_mfma_f32_16x16x32_bf16 v[52:55], v[228:231], v[92:95], v[52:55]
  buffer_load_dwordx4 v[76:79], v207, s[32:35], s72 offen sc1
  v_mfma_f32_16x16x32_bf16 v[56:59], v[232:235], v[92:95], v[56:59]
  v_mfma_f32_16x16x32_bf16 v[60:63], v[236:239], v[92:95], v[60:63]
  s_waitcnt vmcnt(28) lgkmcnt(0)
  v_mfma_f32_16x16x32_bf16 v[0:3], v[208:211], v[96:99], v[0:3]
  ds_read_b64_tr_b16 v[224:225], v196 offset:16384
  ds_read_b64_tr_b16 v[226:227], v196 offset:18432
  v_mfma_f32_16x16x32_bf16 v[4:7], v[212:215], v[96:99], v[4:7]
  s_add_u32 s72, s67, 13
  s_and_b32 s72, s72, 7
  s_add_u32 s72, s72, 8
  s_lshl_b32 s72, s72, 10
  buffer_load_dwordx4 v[80:83], v204, s[32:35], s72 offen sc1
  v_mfma_f32_16x16x32_bf16 v[8:11], v[216:219], v[96:99], v[8:11]
  ds_read_b64_tr_b16 v[228:229], v197 offset:16384
  ds_read_b64_tr_b16 v[230:231], v197 offset:18432
  v_mfma_f32_16x16x32_bf16 v[12:15], v[220:223], v[96:99], v[12:15]
  v_mfma_f32_16x16x32_bf16 v[16:19], v[208:211], v[100:103], v[16:19]
  ds_read_b64_tr_b16 v[232:233], v198 offset:16384
  ds_read_b64_tr_b16 v[234:235], v198 offset:18432
  v_mfma_f32_16x16x32_bf16 v[20:23], v[212:215], v[100:103], v[20:23]
  buffer_load_dwordx4 v[84:87], v205, s[32:35], s72 offen sc1
  v_mfma_f32_16x16x32_bf16 v[24:27], v[216:219], v[100:103], v[24:27]
  ds_read_b64_tr_b16 v[236:237], v199 offset:16384
  ds_read_b64_tr_b16 v[238:239], v199 offset:18432
  v_mfma_f32_16x16x32_bf16 v[28:31], v[220:223], v[100:103], v[28:31]
  v_mfma_f32_16x16x32_bf16 v[32:35], v[208:211], v[104:107], v[32:35]
  v_mfma_f32_16x16x32_bf16 v[36:39], v[212:215], v[104:107], v[36:39]
  buffer_load_dwordx4 v[88:91], v206, s[32:35], s72 offen sc1
  v_mfma_f32_16x16x32_bf16 v[40:43], v[216:219], v[104:107], v[40:43]
  v_mfma_f32_16x16x32_bf16 v[44:47], v[220:223], v[104:107], v[44:47]
  v_mfma_f32_16x16x32_bf16 v[48:51], v[208:211], v[108:111], v[48:51]
  v_mfma_f32_16x16x32_bf16 v[52:55], v[212:215], v[108:111], v[52:55]
  buffer_load_dwordx4 v[92:95], v207, s[32:35], s72 offen sc1
  v_mfma_f32_16x16x32_bf16 v[56:59], v[216:219], v[108:111], v[56:59]
  v_mfma_f32_16x16x32_bf16 v[60:63], v[220:223], v[108:111], v[60:63]
  s_waitcnt vmcnt(24) lgkmcnt(0)
  v_mfma_f32_16x16x32_bf16 v[0:3], v[224:227], v[112:115], v[0:3]
  v_mfma_f32_16x16x32_bf16 v[4:7], v[228:231], v[112:115], v[4:7]
  s_add_u32 s72, s67, 14
  s_and_b32 s72, s72, 7
  s_add_u32 s72, s72, 8
  s_lshl_b32 s72, s72, 10
  buffer_load_dwordx4 v[96:99], v204, s[32:35], s72 offen sc1
  v_mfma_f32_16x16x32_bf16 v[8:11], v[232:235], v[112:115], v[8:11]
  v_mfma_f32_16x16x32_bf16 v[12:15], v[236:239], v[112:115], v[12:15]
  v_mfma_f32_16x16x32_bf16 v[16:19], v[224:227], v[116:119], v[16:19]
  v_mfma_f32_16x16x32_bf16 v[20:23], v[228:231], v[116:119], v[20:23]
  buffer_load_dwordx4 v[100:103], v205, s[32:35], s72 offen sc1
  v_mfma_f32_16x16x32_bf16 v[24:27], v[232:235], v[116:119], v[24:27]
  v_mfma_f32_16x16x32_bf16 v[28:31], v[236:239], v[116:119], v[28:31]
  v_mfma_f32_16x16x32_bf16 v[32:35], v[224:227], v[120:123], v[32:35]
  v_mfma_f32_16x16x32_bf16 v[36:39], v[228:231], v[120:123], v[36:39]
  buffer_load_dwordx4 v[104:107], v206, s[32:35], s72 offen sc1
  v_mfma_f32_16x16x32_bf16 v[40:43], v[232:235], v[120:123], v[40:43]
  v_mfma_f32_16x16x32_bf16 v[44:47], v[236:239], v[120:123], v[44:47]
  v_mfma_f32_16x16x32_bf16 v[48:51], v[224:227], v[124:127], v[48:51]
  v_mfma_f32_16x16x32_bf16 v[52:55], v[228:231], v[124:127], v[52:55]
  buffer_load_dwordx4 v[108:111], v207, s[32:35], s72 offen sc1
  v_mfma_f32_16x16x32_bf16 v[56:59], v[232:235], v[124:127], v[56:59]
  v_mfma_f32_16x16x32_bf16 v[60:63], v[236:239], v[124:127], v[60:63]
  s_waitcnt vmcnt(20)
  v_mfma_f32_16x16x32_bf16 v[0:3], a[176:179], v[128:131], v[0:3]
  ds_read_b64_tr_b16 v[208:209], v192 offset:16384
  ds_read_b64_tr_b16 v[210:211], v192 offset:18432
  v_mfma_f32_16x16x32_bf16 v[4:7], a[180:183], v[128:131], v[4:7]
  s_add_u32 s72, s67, 15
  s_and_b32 s72, s72, 7
  s_add_u32 s72, s72, 8
  s_lshl_b32 s72, s72, 10
  buffer_load_dwordx4 v[112:115], v204, s[32:35], s72 offen sc1
  v_mfma_f32_16x16x32_bf16 v[8:11], a[184:187], v[128:131], v[8:11]
  ds_read_b64_tr_b16 v[212:213], v193 offset:16384
  ds_read_b64_tr_b16 v[214:215], v193 offset:18432
  v_mfma_f32_16x16x32_bf16 v[12:15], a[188:191], v[128:131], v[12:15]
  v_mfma_f32_16x16x32_bf16 v[16:19], a[176:179], v[132:135], v[16:19]
  ds_read_b64_tr_b16 v[216:217], v194 offset:16384
  ds_read_b64_tr_b16 v[218:219], v194 offset:18432
  v_mfma_f32_16x16x32_bf16 v[20:23], a[180:183], v[132:135], v[20:23]
  buffer_load_dwordx4 v[116:119], v205, s[32:35], s72 offen sc1
  v_mfma_f32_16x16x32_bf16 v[24:27], a[184:187], v[132:135], v[24:27]
  ds_read_b64_tr_b16 v[220:221], v195 offset:16384
  ds_read_b64_tr_b16 v[222:223], v195 offset:18432
  v_mfma_f32_16x16x32_bf16 v[28:31], a[188:191], v[132:135], v[28:31]
  v_mfma_f32_16x16x32_bf16 v[32:35], a[176:179], v[136:139], v[32:35]
  v_mfma_f32_16x16x32_bf16 v[36:39], a[180:183], v[136:139], v[36:39]
  buffer_load_dwordx4 v[120:123], v206, s[32:35], s72 offen sc1
  v_mfma_f32_16x16x32_bf16 v[40:43], a[184:187], v[136:139], v[40:43]
  v_mfma_f32_16x16x32_bf16 v[44:47], a[188:191], v[136:139], v[44:47]
  v_mfma_f32_16x16x32_bf16 v[48:51], a[176:179], v[140:143], v[48:51]
  v_mfma_f32_16x16x32_bf16 v[52:55], a[180:183], v[140:143], v[52:55]
  buffer_load_dwordx4 v[124:127], v207, s[32:35], s72 offen sc1
  v_mfma_f32_16x16x32_bf16 v[56:59], a[184:187], v[140:143], v[56:59]
  v_mfma_f32_16x16x32_bf16 v[60:63], a[188:191], v[140:143], v[60:63]
  s_waitcnt vmcnt(16) lgkmcnt(0)
  v_mfma_f32_16x16x32_bf16 v[0:3], v[208:211], v[144:147], v[0:3]
  v_mfma_f32_16x16x32_bf16 v[4:7], v[212:215], v[144:147], v[4:7]
  s_add_u32 s72, s67, 16
  s_and_b32 s72, s72, 7
  s_add_u32 s72, s72, 16
  s_lshl_b32 s72, s72, 10
  buffer_load_dwordx4 v[128:131], v204, s[32:35], s72 offen sc1
  v_mfma_f32_16x16x32_bf16 v[8:11], v[216:219], v[144:147], v[8:11]
  v_mfma_f32_16x16x32_bf16 v[12:15], v[220:223], v[144:147], v[12:15]
  v_mfma_f32_16x16x32_bf16 v[16:19], v[208:211], v[148:151], v[16:19]
  v_mfma_f32_16x16x32_bf16 v[20:23], v[212:215], v[148:151], v[20:23]
  buffer_load_dwordx4 v[132:135], v205, s[32:35], s72 offen sc1
  v_mfma_f32_16x16x32_bf16 v[24:27], v[216:219], v[148:151], v[24:27]
  v_mfma_f32_16x16x32_bf16 v[28:31], v[220:223], v[148:151], v[28:31]
  v_mfma_f32_16x16x32_bf16 v[32:35], v[208:211], v[152:155], v[32:35]
  v_mfma_f32_16x16x32_bf16 v[36:39], v[212:215], v[152:155], v[36:39]
  buffer_load_dwordx4 v[136:139], v206, s[32:35], s72 offen sc1
  v_mfma_f32_16x16x32_bf16 v[40:43], v[216:219], v[152:155], v[40:43]
  v_mfma_f32_16x16x32_bf16 v[44:47], v[220:223], v[152:155], v[44:47]
  v_mfma_f32_16x16x32_bf16 v[48:51], v[208:211], v[156:159], v[48:51]
  v_mfma_f32_16x16x32_bf16 v[52:55], v[212:215], v[156:159], v[52:55]
  buffer_load_dwordx4 v[140:143], v207, s[32:35], s72 offen sc1
  v_mfma_f32_16x16x32_bf16 v[56:59], v[216:219], v[156:159], v[56:59]
  v_mfma_f32_16x16x32_bf16 v[60:63], v[220:223], v[156:159], v[60:63]
  s_waitcnt vmcnt(16)
  v_mfma_f32_16x16x32_bf16 v[0:3], a[192:195], v[64:67], v[0:3]
  ds_read_b64_tr_b16 v[224:225], v196 offset:32768
  ds_read_b64_tr_b16 v[226:227], v196 offset:34816
  v_mfma_f32_16x16x32_bf16 v[4:7], a[196:199], v[64:67], v[4:7]
  s_add_u32 s72, s67, 17
  s_and_b32 s72, s72, 7
  s_add_u32 s72, s72, 16
  s_lshl_b32 s72, s72, 10
  buffer_load_dwordx4 v[144:147], v204, s[32:35], s72 offen sc1
  v_mfma_f32_16x16x32_bf16 v[8:11], a[200:203], v[64:67], v[8:11]
  ds_read_b64_tr_b16 v[228:229], v197 offset:32768
  ds_read_b64_tr_b16 v[230:231], v197 offset:34816
  v_mfma_f32_16x16x32_bf16 v[12:15], a[204:207], v[64:67], v[12:15]
  v_mfma_f32_16x16x32_bf16 v[16:19], a[192:195], v[68:71], v[16:19]
  ds_read_b64_tr_b16 v[232:233], v198 offset:32768
  ds_read_b64_tr_b16 v[234:235], v198 offset:34816
  v_mfma_f32_16x16x32_bf16 v[20:23], a[196:199], v[68:71], v[20:23]
  buffer_load_dwordx4 v[148:151], v205, s[32:35], s72 offen sc1
  v_mfma_f32_16x16x32_bf16 v[24:27], a[200:203], v[68:71], v[24:27]
  ds_read_b64_tr_b16 v[236:237], v199 offset:32768
  ds_read_b64_tr_b16 v[238:239], v199 offset:34816
  v_mfma_f32_16x16x32_bf16 v[28:31], a[204:207], v[68:71], v[28:31]
  v_mfma_f32_16x16x32_bf16 v[32:35], a[192:195], v[72:75], v[32:35]
  v_mfma_f32_16x16x32_bf16 v[36:39], a[196:199], v[72:75], v[36:39]
  buffer_load_dwordx4 v[152:155], v206, s[32:35], s72 offen sc1
  v_mfma_f32_16x16x32_bf16 v[40:43], a[200:203], v[72:75], v[40:43]
  v_mfma_f32_16x16x32_bf16 v[44:47], a[204:207], v[72:75], v[44:47]
  v_mfma_f32_16x16x32_bf16 v[48:51], a[192:195], v[76:79], v[48:51]
  v_mfma_f32_16x16x32_bf16 v[52:55], a[196:199], v[76:79], v[52:55]
  buffer_load_dwordx4 v[156:159], v207, s[32:35], s72 offen sc1
  v_mfma_f32_16x16x32_bf16 v[56:59], a[200:203], v[76:79], v[56:59]
  v_mfma_f32_16x16x32_bf16 v[60:63], a[204:207], v[76:79], v[60:63]
  s_waitcnt vmcnt(16) lgkmcnt(0)
  v_mfma_f32_16x16x32_bf16 v[0:3], v[224:227], v[80:83], v[0:3]
  v_mfma_f32_16x16x32_bf16 v[4:7], v[228:231], v[80:83], v[4:7]
  s_add_u32 s72, s67, 18
  s_and_b32 s72, s72, 7
  s_add_u32 s72, s72, 16
  s_lshl_b32 s72, s72, 10
  buffer_load_dwordx4 v[64:67], v204, s[32:35], s72 offen sc1
  v_mfma_f32_16x16x32_bf16 v[8:11], v[232:235], v[80:83], v[8:11]
  v_mfma_f32_16x16x32_bf16 v[12:15], v[236:239], v[80:83], v[12:15]
  v_mfma_f32_16x16x32_bf16 v[16:19], v[224:227], v[84:87], v[16:19]
  v_mfma_f32_16x16x32_bf16 v[20:23], v[228:231], v[84:87], v[20:23]
  buffer_load_dwordx4 v[68:71], v205, s[32:35], s72 offen sc1
  v_mfma_f32_16x16x32_bf16 v[24:27], v[232:235], v[84:87], v[24:27]
  v_mfma_f32_16x16x32_bf16 v[28:31], v[236:239], v[84:87], v[28:31]
  v_mfma_f32_16x16x32_bf16 v[32:35], v[224:227], v[88:91], v[32:35]
  v_mfma_f32_16x16x32_bf16 v[36:39], v[228:231], v[88:91], v[36:39]
  buffer_load_dwordx4 v[72:75], v206, s[32:35], s72 offen sc1
  v_mfma_f32_16x16x32_bf16 v[40:43], v[232:235], v[88:91], v[40:43]
  v_mfma_f32_16x16x32_bf16 v[44:47], v[236:239], v[88:91], v[44:47]
  v_mfma_f32_16x16x32_bf16 v[48:51], v[224:227], v[92:95], v[48:51]
  v_mfma_f32_16x16x32_bf16 v[52:55], v[228:231], v[92:95], v[52:55]
  buffer_load_dwordx4 v[76:79], v207, s[32:35], s72 offen sc1
  v_mfma_f32_16x16x32_bf16 v[56:59], v[232:235], v[92:95], v[56:59]
  v_mfma_f32_16x16x32_bf16 v[60:63], v[236:239], v[92:95], v[60:63]
  s_waitcnt vmcnt(16)
  v_mfma_f32_16x16x32_bf16 v[0:3], a[208:211], v[96:99], v[0:3]
  ds_read_b64_tr_b16 v[208:209], v196 offset:49152
  ds_read_b64_tr_b16 v[210:211], v196 offset:51200
  v_mfma_f32_16x16x32_bf16 v[4:7], a[212:215], v[96:99], v[4:7]
  s_add_u32 s72, s67, 19
  s_and_b32 s72, s72, 7
  s_add_u32 s72, s72, 16
  s_lshl_b32 s72, s72, 10
  buffer_load_dwordx4 v[80:83], v204, s[32:35], s72 offen sc1
  v_mfma_f32_16x16x32_bf16 v[8:11], a[216:219], v[96:99], v[8:11]
  ds_read_b64_tr_b16 v[212:213], v197 offset:49152
  ds_read_b64_tr_b16 v[214:215], v197 offset:51200
  v_mfma_f32_16x16x32_bf16 v[12:15], a[220:223], v[96:99], v[12:15]
  v_mfma_f32_16x16x32_bf16 v[16:19], a[208:211], v[100:103], v[16:19]
  ds_read_b64_tr_b16 v[216:217], v198 offset:49152
  ds_read_b64_tr_b16 v[218:219], v198 offset:51200
  v_mfma_f32_16x16x32_bf16 v[20:23], a[212:215], v[100:103], v[20:23]
  buffer_load_dwordx4 v[84:87], v205, s[32:35], s72 offen sc1
  v_mfma_f32_16x16x32_bf16 v[24:27], a[216:219], v[100:103], v[24:27]
  ds_read_b64_tr_b16 v[220:221], v199 offset:49152
  ds_read_b64_tr_b16 v[222:223], v199 offset:51200
  v_mfma_f32_16x16x32_bf16 v[28:31], a[220:223], v[100:103], v[28:31]
  v_mfma_f32_16x16x32_bf16 v[32:35], a[208:211], v[104:107], v[32:35]
  v_mfma_f32_16x16x32_bf16 v[36:39], a[212:215], v[104:107], v[36:39]
  buffer_load_dwordx4 v[88:91], v206, s[32:35], s72 offen sc1
  v_mfma_f32_16x16x32_bf16 v[40:43], a[216:219], v[104:107], v[40:43]
  v_mfma_f32_16x16x32_bf16 v[44:47], a[220:223], v[104:107], v[44:47]
  v_mfma_f32_16x16x32_bf16 v[48:51], a[208:211], v[108:111], v[48:51]
  v_mfma_f32_16x16x32_bf16 v[52:55], a[212:215], v[108:111], v[52:55]
  buffer_load_dwordx4 v[92:95], v207, s[32:35], s72 offen sc1
  v_mfma_f32_16x16x32_bf16 v[56:59], a[216:219], v[108:111], v[56:59]
  v_mfma_f32_16x16x32_bf16 v[60:63], a[220:223], v[108:111], v[60:63]
  s_waitcnt vmcnt(16) lgkmcnt(0)
  v_mfma_f32_16x16x32_bf16 v[0:3], v[208:211], v[112:115], v[0:3]
  v_mfma_f32_16x16x32_bf16 v[4:7], v[212:215], v[112:115], v[4:7]
  s_add_u32 s72, s67, 20
  s_and_b32 s72, s72, 7
  s_add_u32 s72, s72, 16
  s_lshl_b32 s72, s72, 10
  buffer_load_dwordx4 v[96:99], v204, s[32:35], s72 offen sc1
  v_mfma_f32_16x16x32_bf16 v[8:11], v[216:219], v[112:115], v[8:11]
  v_mfma_f32_16x16x32_bf16 v[12:15], v[220:223], v[112:115], v[12:15]
  v_mfma_f32_16x16x32_bf16 v[16:19], v[208:211], v[116:119], v[16:19]
  v_mfma_f32_16x16x32_bf16 v[20:23], v[212:215], v[116:119], v[20:23]
  buffer_load_dwordx4 v[100:103], v205, s[32:35], s72 offen sc1
  v_mfma_f32_16x16x32_bf16 v[24:27], v[216:219], v[116:119], v[24:27]
  v_mfma_f32_16x16x32_bf16 v[28:31], v[220:223], v[116:119], v[28:31]
  v_mfma_f32_16x16x32_bf16 v[32:35], v[208:211], v[120:123], v[32:35]
  v_mfma_f32_16x16x32_bf16 v[36:39], v[212:215], v[120:123], v[36:39]
  buffer_load_dwordx4 v[104:107], v206, s[32:35], s72 offen sc1
  v_mfma_f32_16x16x32_bf16 v[40:43], v[216:219], v[120:123], v[40:43]
  v_mfma_f32_16x16x32_bf16 v[44:47], v[220:223], v[120:123], v[44:47]
  v_mfma_f32_16x16x32_bf16 v[48:51], v[208:211], v[124:127], v[48:51]
  v_mfma_f32_16x16x32_bf16 v[52:55], v[212:215], v[124:127], v[52:55]
  buffer_load_dwordx4 v[108:111], v207, s[32:35], s72 offen sc1
  v_mfma_f32_16x16x32_bf16 v[56:59], v[216:219], v[124:127], v[56:59]
  v_mfma_f32_16x16x32_bf16 v[60:63], v[220:223], v[124:127], v[60:63]
  s_waitcnt vmcnt(16)
  v_mfma_f32_16x16x32_bf16 v[0:3], a[224:227], v[128:131], v[0:3]
  ds_read_b64_tr_b16 v[224:225], v192
  ds_read_b64_tr_b16 v[226:227], v192 offset:2048
  v_mfma_f32_16x16x32_bf16 v[4:7], a[228:231], v[128:131], v[4:7]
  s_add_u32 s72, s67, 21
  s_and_b32 s72, s72, 7
  s_add_u32 s72, s72, 16
  s_lshl_b32 s72, s72, 10
  buffer_load_dwordx4 v[112:115], v204, s[32:35], s72 offen sc1
  v_mfma_f32_16x16x32_bf16 v[8:11], a[232:235], v[128:131], v[8:11]
  ds_read_b64_tr_b16 v[228:229], v193
  ds_read_b64_tr_b16 v[230:231], v193 offset:2048
  v_mfma_f32_16x16x32_bf16 v[12:15], a[236:239], v[128:131], v[12:15]
  v_mfma_f32_16x16x32_bf16 v[16:19], a[224:227], v[132:135], v[16:19]
  ds_read_b64_tr_b16 v[232:233], v194
  ds_read_b64_tr_b16 v[234:235], v194 offset:2048
  v_mfma_f32_16x16x32_bf16 v[20:23], a[228:231], v[132:135], v[20:23]
  buffer_load_dwordx4 v[116:119], v205, s[32:35], s72 offen sc1
  v_mfma_f32_16x16x32_bf16 v[24:27], a[232:235], v[132:135], v[24:27]
  ds_read_b64_tr_b16 v[236:237], v195
  ds_read_b64_tr_b16 v[238:239], v195 offset:2048
  v_mfma_f32_16x16x32_bf16 v[28:31], a[236:239], v[132:135], v[28:31]
  v_mfma_f32_16x16x32_bf16 v[32:35], a[224:227], v[136:139], v[32:35]
  v_mfma_f32_16x16x32_bf16 v[36:39], a[228:231], v[136:139], v[36:39]
  buffer_load_dwordx4 v[120:123], v206, s[32:35], s72 offen sc1
  v_mfma_f32_16x16x32_bf16 v[40:43], a[232:235], v[136:139], v[40:43]
  v_mfma_f32_16x16x32_bf16 v[44:47], a[236:239], v[136:139], v[44:47]
  v_mfma_f32_16x16x32_bf16 v[48:51], a[224:227], v[140:143], v[48:51]
  v_mfma_f32_16x16x32_bf16 v[52:55], a[228:231], v[140:143], v[52:55]
  buffer_load_dwordx4 v[124:127], v207, s[32:35], s72 offen sc1
  v_mfma_f32_16x16x32_bf16 v[56:59], a[232:235], v[140:143], v[56:59]
  v_mfma_f32_16x16x32_bf16 v[60:63], a[236:239], v[140:143], v[60:63]
  s_waitcnt vmcnt(16) lgkmcnt(0)
  v_mfma_f32_16x16x32_bf16 v[0:3], v[224:227], v[144:147], v[0:3]
  v_mfma_f32_16x16x32_bf16 v[4:7], v[228:231], v[144:147], v[4:7]
  s_add_u32 s72, s67, 22
  s_and_b32 s72, s72, 7
  s_add_u32 s72, s72, 16
  s_lshl_b32 s72, s72, 10
  buffer_load_dwordx4 v[128:131], v204, s[32:35], s72 offen sc1
  v_mfma_f32_16x16x32_bf16 v[8:11], v[232:235], v[144:147], v[8:11]
  v_mfma_f32_16x16x32_bf16 v[12:15], v[236:239], v[144:147], v[12:15]
  v_mfma_f32_16x16x32_bf16 v[16:19], v[224:227], v[148:151], v[16:19]
  v_mfma_f32_16x16x32_bf16 v[20:23], v[228:231], v[148:151], v[20:23]
  buffer_load_dwordx4 v[132:135], v205, s[32:35], s72 offen sc1
  v_mfma_f32_16x16x32_bf16 v[24:27], v[232:235], v[148:151], v[24:27]
  v_mfma_f32_16x16x32_bf16 v[28:31], v[236:239], v[148:151], v[28:31]
  v_mfma_f32_16x16x32_bf16 v[32:35], v[224:227], v[152:155], v[32:35]
  v_mfma_f32_16x16x32_bf16 v[36:39], v[228:231], v[152:155], v[36:39]
  buffer_load_dwordx4 v[136:139], v206, s[32:35], s72 offen sc1
  v_mfma_f32_16x16x32_bf16 v[40:43], v[232:235], v[152:155], v[40:43]
  v_mfma_f32_16x16x32_bf16 v[44:47], v[236:239], v[152:155], v[44:47]
  v_mfma_f32_16x16x32_bf16 v[48:51], v[224:227], v[156:159], v[48:51]
  v_mfma_f32_16x16x32_bf16 v[52:55], v[228:231], v[156:159], v[52:55]
  buffer_load_dwordx4 v[140:143], v207, s[32:35], s72 offen sc1
  v_mfma_f32_16x16x32_bf16 v[56:59], v[232:235], v[156:159], v[56:59]
  v_mfma_f32_16x16x32_bf16 v[60:63], v[236:239], v[156:159], v[60:63]
  s_waitcnt vmcnt(16)
  v_mfma_f32_16x16x32_bf16 v[0:3], a[240:243], v[64:67], v[0:3]
  ds_read_b64_tr_b16 v[208:209], v200
  ds_read_b64_tr_b16 v[210:211], v200 offset:2048
  v_mfma_f32_16x16x32_bf16 v[4:7], a[244:247], v[64:67], v[4:7]
  s_add_u32 s72, s67, 23
  s_and_b32 s72, s72, 7
  s_add_u32 s72, s72, 16
  s_lshl_b32 s72, s72, 10
  buffer_load_dwordx4 v[144:147], v204, s[32:35], s72 offen sc1
  v_mfma_f32_16x16x32_bf16 v[8:11], a[248:251], v[64:67], v[8:11]
  ds_read_b64_tr_b16 v[212:213], v201
  ds_read_b64_tr_b16 v[214:215], v201 offset:2048
  v_mfma_f32_16x16x32_bf16 v[12:15], a[252:255], v[64:67], v[12:15]
  v_mfma_f32_16x16x32_bf16 v[16:19], a[240:243], v[68:71], v[16:19]
  ds_read_b64_tr_b16 v[216:217], v202
  ds_read_b64_tr_b16 v[218:219], v202 offset:2048
  v_mfma_f32_16x16x32_bf16 v[20:23], a[244:247], v[68:71], v[20:23]
  buffer_load_dwordx4 v[148:151], v205, s[32:35], s72 offen sc1
  v_mfma_f32_16x16x32_bf16 v[24:27], a[248:251], v[68:71], v[24:27]
  ds_read_b64_tr_b16 v[220:221], v203
  ds_read_b64_tr_b16 v[222:223], v203 offset:2048
  v_mfma_f32_16x16x32_bf16 v[28:31], a[252:255], v[68:71], v[28:31]
  v_mfma_f32_16x16x32_bf16 v[32:35], a[240:243], v[72:75], v[32:35]
  v_mfma_f32_16x16x32_bf16 v[36:39], a[244:247], v[72:75], v[36:39]
  buffer_load_dwordx4 v[152:155], v206, s[32:35], s72 offen sc1
  v_mfma_f32_16x16x32_bf16 v[40:43], a[248:251], v[72:75], v[40:43]
  v_mfma_f32_16x16x32_bf16 v[44:47], a[252:255], v[72:75], v[44:47]
  v_mfma_f32_16x16x32_bf16 v[48:51], a[240:243], v[76:79], v[48:51]
  v_mfma_f32_16x16x32_bf16 v[52:55], a[244:247], v[76:79], v[52:55]
  buffer_load_dwordx4 v[156:159], v207, s[32:35], s72 offen sc1
  v_mfma_f32_16x16x32_bf16 v[56:59], a[248:251], v[76:79], v[56:59]
  v_mfma_f32_16x16x32_bf16 v[60:63], a[252:255], v[76:79], v[60:63]
  s_waitcnt vmcnt(16) lgkmcnt(0)
  v_mfma_f32_16x16x32_bf16 v[0:3], v[208:211], v[80:83], v[0:3]
  v_mfma_f32_16x16x32_bf16 v[4:7], v[212:215], v[80:83], v[4:7]
  s_add_u32 s72, s67, 24
  s_and_b32 s72, s72, 7
  s_add_u32 s72, s72, 24
  s_lshl_b32 s72, s72, 10
  buffer_load_dwordx4 v[64:67], v204, s[32:35], s72 offen sc1
  v_mfma_f32_16x16x32_bf16 v[8:11], v[216:219], v[80:83], v[8:11]
  v_mfma_f32_16x16x32_bf16 v[12:15], v[220:223], v[80:83], v[12:15]
  v_mfma_f32_16x16x32_bf16 v[16:19], v[208:211], v[84:87], v[16:19]
  v_mfma_f32_16x16x32_bf16 v[20:23], v[212:215], v[84:87], v[20:23]
  buffer_load_dwordx4 v[68:71], v205, s[32:35], s72 offen sc1
  v_mfma_f32_16x16x32_bf16 v[24:27], v[216:219], v[84:87], v[24:27]
  v_mfma_f32_16x16x32_bf16 v[28:31], v[220:223], v[84:87], v[28:31]
  v_mfma_f32_16x16x32_bf16 v[32:35], v[208:211], v[88:91], v[32:35]
  v_mfma_f32_16x16x32_bf16 v[36:39], v[212:215], v[88:91], v[36:39]
  buffer_load_dwordx4 v[72:75], v206, s[32:35], s72 offen sc1
  v_mfma_f32_16x16x32_bf16 v[40:43], v[216:219], v[88:91], v[40:43]
  v_mfma_f32_16x16x32_bf16 v[44:47], v[220:223], v[88:91], v[44:47]
  v_mfma_f32_16x16x32_bf16 v[48:51], v[208:211], v[92:95], v[48:51]
  v_mfma_f32_16x16x32_bf16 v[52:55], v[212:215], v[92:95], v[52:55]
  buffer_load_dwordx4 v[76:79], v207, s[32:35], s72 offen sc1
  v_mfma_f32_16x16x32_bf16 v[56:59], v[216:219], v[92:95], v[56:59]
  v_mfma_f32_16x16x32_bf16 v[60:63], v[220:223], v[92:95], v[60:63]
  s_waitcnt vmcnt(16)
  v_mfma_f32_16x16x32_bf16 v[0:3], a[48:51], v[96:99], v[0:3]
  ds_read_b64_tr_b16 v[224:225], v200 offset:16384
  ds_read_b64_tr_b16 v[226:227], v200 offset:18432
  v_mfma_f32_16x16x32_bf16 v[4:7], a[52:55], v[96:99], v[4:7]
  s_add_u32 s72, s67, 25
  s_and_b32 s72, s72, 7
  s_add_u32 s72, s72, 24
  s_lshl_b32 s72, s72, 10
  buffer_load_dwordx4 v[80:83], v204, s[32:35], s72 offen sc1
  v_mfma_f32_16x16x32_bf16 v[8:11], a[56:59], v[96:99], v[8:11]
  ds_read_b64_tr_b16 v[228:229], v201 offset:16384
  ds_read_b64_tr_b16 v[230:231], v201 offset:18432
  v_mfma_f32_16x16x32_bf16 v[12:15], a[60:63], v[96:99], v[12:15]
  v_mfma_f32_16x16x32_bf16 v[16:19], a[48:51], v[100:103], v[16:19]
  ds_read_b64_tr_b16 v[232:233], v202 offset:16384
  ds_read_b64_tr_b16 v[234:235], v202 offset:18432
  v_mfma_f32_16x16x32_bf16 v[20:23], a[52:55], v[100:103], v[20:23]
  buffer_load_dwordx4 v[84:87], v205, s[32:35], s72 offen sc1
  v_mfma_f32_16x16x32_bf16 v[24:27], a[56:59], v[100:103], v[24:27]
  ds_read_b64_tr_b16 v[236:237], v203 offset:16384
  ds_read_b64_tr_b16 v[238:239], v203 offset:18432
  v_mfma_f32_16x16x32_bf16 v[28:31], a[60:63], v[100:103], v[28:31]
  v_mfma_f32_16x16x32_bf16 v[32:35], a[48:51], v[104:107], v[32:35]
  v_mfma_f32_16x16x32_bf16 v[36:39], a[52:55], v[104:107], v[36:39]
  buffer_load_dwordx4 v[88:91], v206, s[32:35], s72 offen sc1
  v_mfma_f32_16x16x32_bf16 v[40:43], a[56:59], v[104:107], v[40:43]
  v_mfma_f32_16x16x32_bf16 v[44:47], a[60:63], v[104:107], v[44:47]
  v_mfma_f32_16x16x32_bf16 v[48:51], a[48:51], v[108:111], v[48:51]
  v_mfma_f32_16x16x32_bf16 v[52:55], a[52:55], v[108:111], v[52:55]
  buffer_load_dwordx4 v[92:95], v207, s[32:35], s72 offen sc1
  v_mfma_f32_16x16x32_bf16 v[56:59], a[56:59], v[108:111], v[56:59]
  v_mfma_f32_16x16x32_bf16 v[60:63], a[60:63], v[108:111], v[60:63]
  s_waitcnt vmcnt(16) lgkmcnt(0)
  v_mfma_f32_16x16x32_bf16 v[0:3], v[224:227], v[112:115], v[0:3]
  v_mfma_f32_16x16x32_bf16 v[4:7], v[228:231], v[112:115], v[4:7]
  s_add_u32 s72, s67, 26
  s_and_b32 s72, s72, 7
  s_add_u32 s72, s72, 24
  s_lshl_b32 s72, s72, 10
  buffer_load_dwordx4 v[96:99], v204, s[32:35], s72 offen sc1
  v_mfma_f32_16x16x32_bf16 v[8:11], v[232:235], v[112:115], v[8:11]
  v_mfma_f32_16x16x32_bf16 v[12:15], v[236:239], v[112:115], v[12:15]
  v_mfma_f32_16x16x32_bf16 v[16:19], v[224:227], v[116:119], v[16:19]
  v_mfma_f32_16x16x32_bf16 v[20:23], v[228:231], v[116:119], v[20:23]
  buffer_load_dwordx4 v[100:103], v205, s[32:35], s72 offen sc1
  v_mfma_f32_16x16x32_bf16 v[24:27], v[232:235], v[116:119], v[24:27]
  v_mfma_f32_16x16x32_bf16 v[28:31], v[236:239], v[116:119], v[28:31]
  v_mfma_f32_16x16x32_bf16 v[32:35], v[224:227], v[120:123], v[32:35]
  v_mfma_f32_16x16x32_bf16 v[36:39], v[228:231], v[120:123], v[36:39]
  buffer_load_dwordx4 v[104:107], v206, s[32:35], s72 offen sc1
  v_mfma_f32_16x16x32_bf16 v[40:43], v[232:235], v[120:123], v[40:43]
  v_mfma_f32_16x16x32_bf16 v[44:47], v[236:239], v[120:123], v[44:47]
  v_mfma_f32_16x16x32_bf16 v[48:51], v[224:227], v[124:127], v[48:51]
  v_mfma_f32_16x16x32_bf16 v[52:55], v[228:231], v[124:127], v[52:55]
  buffer_load_dwordx4 v[108:111], v207, s[32:35], s72 offen sc1
  v_mfma_f32_16x16x32_bf16 v[56:59], v[232:235], v[124:127], v[56:59]
  v_mfma_f32_16x16x32_bf16 v[60:63], v[236:239], v[124:127], v[60:63]
  s_waitcnt vmcnt(16)
  v_mfma_f32_16x16x32_bf16 v[0:3], a[64:67], v[128:131], v[0:3]
  v_mfma_f32_16x16x32_bf16 v[4:7], a[68:71], v[128:131], v[4:7]
  s_add_u32 s72, s67, 27
  s_and_b32 s72, s72, 7
  s_add_u32 s72, s72, 24
  s_lshl_b32 s72, s72, 10
  buffer_load_dwordx4 v[112:115], v204, s[32:35], s72 offen sc1
  v_mfma_f32_16x16x32_bf16 v[8:11], a[72:75], v[128:131], v[8:11]
  v_mfma_f32_16x16x32_bf16 v[12:15], a[76:79], v[128:131], v[12:15]
  v_mfma_f32_16x16x32_bf16 v[16:19], a[64:67], v[132:135], v[16:19]
  v_mfma_f32_16x16x32_bf16 v[20:23], a[68:71], v[132:135], v[20:23]
  buffer_load_dwordx4 v[116:119], v205, s[32:35], s72 offen sc1
  v_mfma_f32_16x16x32_bf16 v[24:27], a[72:75], v[132:135], v[24:27]
  v_mfma_f32_16x16x32_bf16 v[28:31], a[76:79], v[132:135], v[28:31]
  v_mfma_f32_16x16x32_bf16 v[32:35], a[64:67], v[136:139], v[32:35]
  v_mfma_f32_16x16x32_bf16 v[36:39], a[68:71], v[136:139], v[36:39]
  buffer_load_dwordx4 v[120:123], v206, s[32:35], s72 offen sc1
  v_mfma_f32_16x16x32_bf16 v[40:43], a[72:75], v[136:139], v[40:43]
  v_mfma_f32_16x16x32_bf16 v[44:47], a[76:79], v[136:139], v[44:47]
  v_mfma_f32_16x16x32_bf16 v[48:51], a[64:67], v[140:143], v[48:51]
  v_mfma_f32_16x16x32_bf16 v[52:55], a[68:71], v[140:143], v[52:55]
  buffer_load_dwordx4 v[124:127], v207, s[32:35], s72 offen sc1
  v_mfma_f32_16x16x32_bf16 v[56:59], a[72:75], v[140:143], v[56:59]
  v_mfma_f32_16x16x32_bf16 v[60:63], a[76:79], v[140:143], v[60:63]
  s_waitcnt vmcnt(16)
  v_mfma_f32_16x16x32_bf16 v[0:3], a[80:83], v[144:147], v[0:3]
  v_mfma_f32_16x16x32_bf16 v[4:7], a[84:87], v[144:147], v[4:7]
  s_add_u32 s72, s67, 28
  s_and_b32 s72, s72, 7
  s_add_u32 s72, s72, 24
  s_lshl_b32 s72, s72, 10
  buffer_load_dwordx4 v[128:131], v204, s[32:35], s72 offen sc1
  v_mfma_f32_16x16x32_bf16 v[8:11], a[88:91], v[144:147], v[8:11]
  v_mfma_f32_16x16x32_bf16 v[12:15], a[92:95], v[144:147], v[12:15]
  v_mfma_f32_16x16x32_bf16 v[16:19], a[80:83], v[148:151], v[16:19]
  v_mfma_f32_16x16x32_bf16 v[20:23], a[84:87], v[148:151], v[20:23]
  buffer_load_dwordx4 v[132:135], v205, s[32:35], s72 offen sc1
  v_mfma_f32_16x16x32_bf16 v[24:27], a[88:91], v[148:151], v[24:27]
  v_mfma_f32_16x16x32_bf16 v[28:31], a[92:95], v[148:151], v[28:31]
  v_mfma_f32_16x16x32_bf16 v[32:35], a[80:83], v[152:155], v[32:35]
  v_mfma_f32_16x16x32_bf16 v[36:39], a[84:87], v[152:155], v[36:39]
  buffer_load_dwordx4 v[136:139], v206, s[32:35], s72 offen sc1
  v_mfma_f32_16x16x32_bf16 v[40:43], a[88:91], v[152:155], v[40:43]
  v_mfma_f32_16x16x32_bf16 v[44:47], a[92:95], v[152:155], v[44:47]
  v_mfma_f32_16x16x32_bf16 v[48:51], a[80:83], v[156:159], v[48:51]
  v_mfma_f32_16x16x32_bf16 v[52:55], a[84:87], v[156:159], v[52:55]
  buffer_load_dwordx4 v[140:143], v207, s[32:35], s72 offen sc1
  v_mfma_f32_16x16x32_bf16 v[56:59], a[88:91], v[156:159], v[56:59]
  v_mfma_f32_16x16x32_bf16 v[60:63], a[92:95], v[156:159], v[60:63]
  s_waitcnt vmcnt(16)
  v_mfma_f32_16x16x32_bf16 v[0:3], a[96:99], v[64:67], v[0:3]
  v_mfma_f32_16x16x32_bf16 v[4:7], a[100:103], v[64:67], v[4:7]
  s_add_u32 s72, s67, 29
  s_and_b32 s72, s72, 7
  s_add_u32 s72, s72, 24
  s_lshl_b32 s72, s72, 10
  buffer_load_dwordx4 v[144:147], v204, s[32:35], s72 offen sc1
  v_mfma_f32_16x16x32_bf16 v[8:11], a[104:107], v[64:67], v[8:11]
  v_mfma_f32_16x16x32_bf16 v[12:15], a[108:111], v[64:67], v[12:15]
  v_mfma_f32_16x16x32_bf16 v[16:19], a[96:99], v[68:71], v[16:19]
  v_mfma_f32_16x16x32_bf16 v[20:23], a[100:103], v[68:71], v[20:23]
  buffer_load_dwordx4 v[148:151], v205, s[32:35], s72 offen sc1
  v_mfma_f32_16x16x32_bf16 v[24:27], a[104:107], v[68:71], v[24:27]
  v_mfma_f32_16x16x32_bf16 v[28:31], a[108:111], v[68:71], v[28:31]
  v_mfma_f32_16x16x32_bf16 v[32:35], a[96:99], v[72:75], v[32:35]
  v_mfma_f32_16x16x32_bf16 v[36:39], a[100:103], v[72:75], v[36:39]
  buffer_load_dwordx4 v[152:155], v206, s[32:35], s72 offen sc1
  v_mfma_f32_16x16x32_bf16 v[40:43], a[104:107], v[72:75], v[40:43]
  v_mfma_f32_16x16x32_bf16 v[44:47], a[108:111], v[72:75], v[44:47]
  v_mfma_f32_16x16x32_bf16 v[48:51], a[96:99], v[76:79], v[48:51]
  v_mfma_f32_16x16x32_bf16 v[52:55], a[100:103], v[76:79], v[52:55]
  buffer_load_dwordx4 v[156:159], v207, s[32:35], s72 offen sc1
  v_mfma_f32_16x16x32_bf16 v[56:59], a[104:107], v[76:79], v[56:59]
  v_mfma_f32_16x16x32_bf16 v[60:63], a[108:111], v[76:79], v[60:63]
  s_waitcnt vmcnt(16)
  v_mfma_f32_16x16x32_bf16 v[0:3], a[0:3], v[80:83], v[0:3]
  v_mfma_f32_16x16x32_bf16 v[4:7], a[4:7], v[80:83], v[4:7]
  s_add_u32 s72, s67, 30
  s_and_b32 s72, s72, 7
  s_add_u32 s72, s72, 24
  s_lshl_b32 s72, s72, 10
  buffer_load_dwordx4 v[64:67], v204, s[32:35], s72 offen sc1
  v_mfma_f32_16x16x32_bf16 v[8:11], a[8:11], v[80:83], v[8:11]
  v_mfma_f32_16x16x32_bf16 v[12:15], a[12:15], v[80:83], v[12:15]
  v_mfma_f32_16x16x32_bf16 v[16:19], a[0:3], v[84:87], v[16:19]
  v_mfma_f32_16x16x32_bf16 v[20:23], a[4:7], v[84:87], v[20:23]
  buffer_load_dwordx4 v[68:71], v205, s[32:35], s72 offen sc1
  v_mfma_f32_16x16x32_bf16 v[24:27], a[8:11], v[84:87], v[24:27]
  v_mfma_f32_16x16x32_bf16 v[28:31], a[12:15], v[84:87], v[28:31]
  v_mfma_f32_16x16x32_bf16 v[32:35], a[0:3], v[88:91], v[32:35]
  v_mfma_f32_16x16x32_bf16 v[36:39], a[4:7], v[88:91], v[36:39]
  buffer_load_dwordx4 v[72:75], v206, s[32:35], s72 offen sc1
  v_mfma_f32_16x16x32_bf16 v[40:43], a[8:11], v[88:91], v[40:43]
  v_mfma_f32_16x16x32_bf16 v[44:47], a[12:15], v[88:91], v[44:47]
  v_mfma_f32_16x16x32_bf16 v[48:51], a[0:3], v[92:95], v[48:51]
  v_mfma_f32_16x16x32_bf16 v[52:55], a[4:7], v[92:95], v[52:55]
  buffer_load_dwordx4 v[76:79], v207, s[32:35], s72 offen sc1
  v_mfma_f32_16x16x32_bf16 v[56:59], a[8:11], v[92:95], v[56:59]
  v_mfma_f32_16x16x32_bf16 v[60:63], a[12:15], v[92:95], v[60:63]
  s_waitcnt vmcnt(16)
  v_mfma_f32_16x16x32_bf16 v[0:3], a[16:19], v[96:99], v[0:3]
  v_mfma_f32_16x16x32_bf16 v[4:7], a[20:23], v[96:99], v[4:7]
  s_add_u32 s72, s67, 31
  s_and_b32 s72, s72, 7
  s_add_u32 s72, s72, 24
  s_lshl_b32 s72, s72, 10
  buffer_load_dwordx4 v[80:83], v204, s[32:35], s72 offen sc1
  v_mfma_f32_16x16x32_bf16 v[8:11], a[24:27], v[96:99], v[8:11]
  v_mfma_f32_16x16x32_bf16 v[12:15], a[28:31], v[96:99], v[12:15]
  v_mfma_f32_16x16x32_bf16 v[16:19], a[16:19], v[100:103], v[16:19]
  v_mfma_f32_16x16x32_bf16 v[20:23], a[20:23], v[100:103], v[20:23]
  buffer_load_dwordx4 v[84:87], v205, s[32:35], s72 offen sc1
  v_mfma_f32_16x16x32_bf16 v[24:27], a[24:27], v[100:103], v[24:27]
  v_mfma_f32_16x16x32_bf16 v[28:31], a[28:31], v[100:103], v[28:31]
  v_mfma_f32_16x16x32_bf16 v[32:35], a[16:19], v[104:107], v[32:35]
  v_mfma_f32_16x16x32_bf16 v[36:39], a[20:23], v[104:107], v[36:39]
  buffer_load_dwordx4 v[88:91], v206, s[32:35], s72 offen sc1
  v_mfma_f32_16x16x32_bf16 v[40:43], a[24:27], v[104:107], v[40:43]
  v_mfma_f32_16x16x32_bf16 v[44:47], a[28:31], v[104:107], v[44:47]
  v_mfma_f32_16x16x32_bf16 v[48:51], a[16:19], v[108:111], v[48:51]
  v_mfma_f32_16x16x32_bf16 v[52:55], a[20:23], v[108:111], v[52:55]
  buffer_load_dwordx4 v[92:95], v207, s[32:35], s72 offen sc1
  v_mfma_f32_16x16x32_bf16 v[56:59], a[24:27], v[108:111], v[56:59]
  v_mfma_f32_16x16x32_bf16 v[60:63], a[28:31], v[108:111], v[60:63]
  s_waitcnt vmcnt(16)
  v_mfma_f32_16x16x32_bf16 v[0:3], a[32:35], v[112:115], v[0:3]
  v_mfma_f32_16x16x32_bf16 v[4:7], a[36:39], v[112:115], v[4:7]
  v_mfma_f32_16x16x32_bf16 v[8:11], a[40:43], v[112:115], v[8:11]
  v_mfma_f32_16x16x32_bf16 v[12:15], a[44:47], v[112:115], v[12:15]
  v_mfma_f32_16x16x32_bf16 v[16:19], a[32:35], v[116:119], v[16:19]
  v_mfma_f32_16x16x32_bf16 v[20:23], a[36:39], v[116:119], v[20:23]
  v_mfma_f32_16x16x32_bf16 v[24:27], a[40:43], v[116:119], v[24:27]
  v_mfma_f32_16x16x32_bf16 v[28:31], a[44:47], v[116:119], v[28:31]
  v_mfma_f32_16x16x32_bf16 v[32:35], a[32:35], v[120:123], v[32:35]
  v_mfma_f32_16x16x32_bf16 v[36:39], a[36:39], v[120:123], v[36:39]
  v_mfma_f32_16x16x32_bf16 v[40:43], a[40:43], v[120:123], v[40:43]
  v_mfma_f32_16x16x32_bf16 v[44:47], a[44:47], v[120:123], v[44:47]
  v_mfma_f32_16x16x32_bf16 v[48:51], a[32:35], v[124:127], v[48:51]
  v_mfma_f32_16x16x32_bf16 v[52:55], a[36:39], v[124:127], v[52:55]
  v_mfma_f32_16x16x32_bf16 v[56:59], a[40:43], v[124:127], v[56:59]
  v_mfma_f32_16x16x32_bf16 v[60:63], a[44:47], v[124:127], v[60:63]
  s_waitcnt vmcnt(12)
  v_mfma_f32_16x16x32_bf16 v[0:3], a[112:115], v[128:131], v[0:3]
  v_mfma_f32_16x16x32_bf16 v[4:7], a[116:119], v[128:131], v[4:7]
  v_mfma_f32_16x16x32_bf16 v[8:11], a[120:123], v[128:131], v[8:11]
  v_mfma_f32_16x16x32_bf16 v[12:15], a[124:127], v[128:131], v[12:15]
  v_mfma_f32_16x16x32_bf16 v[16:19], a[112:115], v[132:135], v[16:19]
  v_mfma_f32_16x16x32_bf16 v[20:23], a[116:119], v[132:135], v[20:23]
  v_mfma_f32_16x16x32_bf16 v[24:27], a[120:123], v[132:135], v[24:27]
  v_mfma_f32_16x16x32_bf16 v[28:31], a[124:127], v[132:135], v[28:31]
  v_mfma_f32_16x16x32_bf16 v[32:35], a[112:115], v[136:139], v[32:35]
  v_mfma_f32_16x16x32_bf16 v[36:39], a[116:119], v[136:139], v[36:39]
  v_mfma_f32_16x16x32_bf16 v[40:43], a[120:123], v[136:139], v[40:43]
  v_mfma_f32_16x16x32_bf16 v[44:47], a[124:127], v[136:139], v[44:47]
  v_mfma_f32_16x16x32_bf16 v[48:51], a[112:115], v[140:143], v[48:51]
  v_mfma_f32_16x16x32_bf16 v[52:55], a[116:119], v[140:143], v[52:55]
  v_mfma_f32_16x16x32_bf16 v[56:59], a[120:123], v[140:143], v[56:59]
  v_mfma_f32_16x16x32_bf16 v[60:63], a[124:127], v[140:143], v[60:63]
  s_waitcnt vmcnt(8)
  v_mfma_f32_16x16x32_bf16 v[0:3], a[128:131], v[144:147], v[0:3]
  v_mfma_f32_16x16x32_bf16 v[4:7], a[132:135], v[144:147], v[4:7]
  v_mfma_f32_16x16x32_bf16 v[8:11], a[136:139], v[144:147], v[8:11]
  v_mfma_f32_16x16x32_bf16 v[12:15], a[140:143], v[144:147], v[12:15]
  v_mfma_f32_16x16x32_bf16 v[16:19], a[128:131], v[148:151], v[16:19]
  v_mfma_f32_16x16x32_bf16 v[20:23], a[132:135], v[148:151], v[20:23]
  v_mfma_f32_16x16x32_bf16 v[24:27], a[136:139], v[148:151], v[24:27]
  v_mfma_f32_16x16x32_bf16 v[28:31], a[140:143], v[148:151], v[28:31]
  v_mfma_f32_16x16x32_bf16 v[32:35], a[128:131], v[152:155], v[32:35]
  v_mfma_f32_16x16x32_bf16 v[36:39], a[132:135], v[152:155], v[36:39]
  v_mfma_f32_16x16x32_bf16 v[40:43], a[136:139], v[152:155], v[40:43]
  v_mfma_f32_16x16x32_bf16 v[44:47], a[140:143], v[152:155], v[44:47]
  v_mfma_f32_16x16x32_bf16 v[48:51], a[128:131], v[156:159], v[48:51]
  v_mfma_f32_16x16x32_bf16 v[52:55], a[132:135], v[156:159], v[52:55]
  v_mfma_f32_16x16x32_bf16 v[56:59], a[136:139], v[156:159], v[56:59]
  v_mfma_f32_16x16x32_bf16 v[60:63], a[140:143], v[156:159], v[60:63]
  s_waitcnt vmcnt(4)
  v_mfma_f32_16x16x32_bf16 v[0:3], a[144:147], v[64:67], v[0:3]
  v_mfma_f32_16x16x32_bf16 v[4:7], a[148:151], v[64:67], v[4:7]
  v_mfma_f32_16x16x32_bf16 v[8:11], a[152:155], v[64:67], v[8:11]
  v_mfma_f32_16x16x32_bf16 v[12:15], a[156:159], v[64:67], v[12:15]
  v_mfma_f32_16x16x32_bf16 v[16:19], a[144:147], v[68:71], v[16:19]
  v_mfma_f32_16x16x32_bf16 v[20:23], a[148:151], v[68:71], v[20:23]
  v_mfma_f32_16x16x32_bf16 v[24:27], a[152:155], v[68:71], v[24:27]
  v_mfma_f32_16x16x32_bf16 v[28:31], a[156:159], v[68:71], v[28:31]
  v_mfma_f32_16x16x32_bf16 v[32:35], a[144:147], v[72:75], v[32:35]
  v_mfma_f32_16x16x32_bf16 v[36:39], a[148:151], v[72:75], v[36:39]
  v_mfma_f32_16x16x32_bf16 v[40:43], a[152:155], v[72:75], v[40:43]
  v_mfma_f32_16x16x32_bf16 v[44:47], a[156:159], v[72:75], v[44:47]
  v_mfma_f32_16x16x32_bf16 v[48:51], a[144:147], v[76:79], v[48:51]
  v_mfma_f32_16x16x32_bf16 v[52:55], a[148:151], v[76:79], v[52:55]
  v_mfma_f32_16x16x32_bf16 v[56:59], a[152:155], v[76:79], v[56:59]
  v_mfma_f32_16x16x32_bf16 v[60:63], a[156:159], v[76:79], v[60:63]
  s_waitcnt vmcnt(0)
  v_mfma_f32_16x16x32_bf16 v[16:19], a[160:163], v[84:87], v[16:19]
  v_mfma_f32_16x16x32_bf16 v[20:23], a[164:167], v[84:87], v[20:23]
  v_mfma_f32_16x16x32_bf16 v[24:27], a[168:171], v[84:87], v[24:27]
  v_mfma_f32_16x16x32_bf16 v[28:31], a[172:175], v[84:87], v[28:31]
  v_mfma_f32_16x16x32_bf16 v[32:35], a[160:163], v[88:91], v[32:35]
  v_mfma_f32_16x16x32_bf16 v[36:39], a[164:167], v[88:91], v[36:39]
  v_mfma_f32_16x16x32_bf16 v[40:43], a[168:171], v[88:91], v[40:43]
  v_mfma_f32_16x16x32_bf16 v[44:47], a[172:175], v[88:91], v[44:47]
  v_mfma_f32_16x16x32_bf16 v[48:51], a[160:163], v[92:95], v[48:51]
  v_mfma_f32_16x16x32_bf16 v[52:55], a[164:167], v[92:95], v[52:55]
  v_mfma_f32_16x16x32_bf16 v[56:59], a[168:171], v[92:95], v[56:59]
  v_mfma_f32_16x16x32_bf16 v[60:63], a[172:175], v[92:95], v[60:63]
  v_mfma_f32_16x16x32_bf16 v[0:3], a[160:163], v[80:83], v[0:3]
  v_mfma_f32_16x16x32_bf16 v[4:7], a[164:167], v[80:83], v[4:7]
  v_mfma_f32_16x16x32_bf16 v[8:11], a[168:171], v[80:83], v[8:11]
  v_mfma_f32_16x16x32_bf16 v[12:15], a[172:175], v[80:83], v[12:15]
  ds_write_b128 v240, v[16:19]
  ds_write_b128 v240, v[20:23] offset:1024
  ds_write_b128 v240, v[24:27] offset:2048
  ds_write_b128 v240, v[28:31] offset:3072
  ds_write_b128 v240, v[32:35] offset:16384
  ds_write_b128 v240, v[36:39] offset:17408
  ds_write_b128 v240, v[40:43] offset:18432
  ds_write_b128 v240, v[44:47] offset:19456
  ds_write_b128 v240, v[48:51] offset:32768
  ds_write_b128 v240, v[52:55] offset:33792
  ds_write_b128 v240, v[56:59] offset:34816
  ds_write_b128 v240, v[60:63] offset:35840
  s_waitcnt lgkmcnt(0)
  s_barrier
  ds_read_b128 v[16:19], v241
  ds_read_b128 v[32:35], v242 offset:16384
  ds_read_b128 v[48:51], v243 offset:32768
  ds_read_b128 v[20:23], v241 offset:1024
  ds_read_b128 v[36:39], v242 offset:17408
  ds_read_b128 v[52:55], v243 offset:33792
  ds_read_b128 v[24:27], v241 offset:2048
  ds_read_b128 v[40:43], v242 offset:18432
  ds_read_b128 v[56:59], v243 offset:34816
  ds_read_b128 v[28:31], v241 offset:3072
  ds_read_b128 v[44:47], v242 offset:19456
  ds_read_b128 v[60:63], v243 offset:35840
  s_waitcnt lgkmcnt(11)
  v_pk_add_f32 v[0:1], v[0:1], v[16:17]
  s_waitcnt lgkmcnt(9)
  v_pk_add_f32 v[32:33], v[32:33], v[48:49]
  v_pk_add_f32 v[2:3], v[2:3], v[18:19]
  v_pk_add_f32 v[34:35], v[34:35], v[50:51]
  v_pk_add_f32 v[0:1], v[0:1], v[32:33]
  v_pk_add_f32 v[2:3], v[2:3], v[34:35]
  v_cvt_pk_bf16_f32 v0, v0, v1
  v_cvt_pk_bf16_f32 v1, v2, v3
  buffer_store_dwordx2 v[0:1], v245, s[20:23], s69 offen
  s_waitcnt lgkmcnt(8)
  v_pk_add_f32 v[4:5], v[4:5], v[20:21]
  s_waitcnt lgkmcnt(6)
  v_pk_add_f32 v[36:37], v[36:37], v[52:53]
  v_pk_add_f32 v[6:7], v[6:7], v[22:23]
  v_pk_add_f32 v[38:39], v[38:39], v[54:55]
  v_pk_add_f32 v[4:5], v[4:5], v[36:37]
  v_pk_add_f32 v[6:7], v[6:7], v[38:39]
  v_cvt_pk_bf16_f32 v4, v4, v5
  v_cvt_pk_bf16_f32 v5, v6, v7
  buffer_store_dwordx2 v[4:5], v245, s[20:23], s69 offen offset:32
  s_waitcnt lgkmcnt(5)
  v_pk_add_f32 v[8:9], v[8:9], v[24:25]
  s_waitcnt lgkmcnt(3)
  v_pk_add_f32 v[40:41], v[40:41], v[56:57]
  v_pk_add_f32 v[10:11], v[10:11], v[26:27]
  v_pk_add_f32 v[42:43], v[42:43], v[58:59]
  v_pk_add_f32 v[8:9], v[8:9], v[40:41]
  v_pk_add_f32 v[10:11], v[10:11], v[42:43]
  v_cvt_pk_bf16_f32 v8, v8, v9
  v_cvt_pk_bf16_f32 v9, v10, v11
  buffer_store_dwordx2 v[8:9], v245, s[20:23], s69 offen offset:64
  s_waitcnt lgkmcnt(2)
  v_pk_add_f32 v[12:13], v[12:13], v[28:29]
  s_waitcnt lgkmcnt(0)
  v_pk_add_f32 v[44:45], v[44:45], v[60:61]
  v_pk_add_f32 v[14:15], v[14:15], v[30:31]
  v_pk_add_f32 v[46:47], v[46:47], v[62:63]
  v_pk_add_f32 v[12:13], v[12:13], v[44:45]
  v_pk_add_f32 v[14:15], v[14:15], v[46:47]
  v_cvt_pk_bf16_f32 v12, v12, v13
  v_cvt_pk_bf16_f32 v13, v14, v15
  buffer_store_dwordx2 v[12:13], v245, s[20:23], s69 offen offset:96
K1_fin:
K1_end:
  s_endpgm
K1_safe:
  s_waitcnt vmcnt(0) lgkmcnt(0)
  s_nop 15
  s_mov_b32 s44, 1
  s_lshl_b32 s46, s36, 6
  v_add_u32 v0, s46, v187
  s_barrier
  s_nop 3
  s_branch K1_start
K1_safego:
  s_waitcnt vmcnt(0) lgkmcnt(0)
  s_nop 15
  s_mov_b32 s41, s45
  s_mov_b32 s42, s45
  s_mov_b32 s43, 32
  v_mov_b64 v[0:1], 0
  v_mov_b64 v[2:3], 0
  v_mov_b64 v[4:5], 0
  v_mov_b64 v[6:7], 0
  v_mov_b64 v[8:9], 0
  v_mov_b64 v[10:11], 0
  v_mov_b64 v[12:13], 0
  v_mov_b64 v[14:15], 0
  v_mov_b64 v[16:17], 0
  v_mov_b64 v[18:19], 0
  v_mov_b64 v[20:21], 0
  v_mov_b64 v[22:23], 0
  v_mov_b64 v[24:25], 0
  v_mov_b64 v[26:27], 0
  v_mov_b64 v[28:29], 0
  v_mov_b64 v[30:31], 0
  v_mov_b64 v[32:33], 0
  v_mov_b64 v[34:35], 0
  v_mov_b64 v[36:37], 0
  v_mov_b64 v[38:39], 0
  v_mov_b64 v[40:41], 0
  v_mov_b64 v[42:43], 0
  v_mov_b64 v[44:45], 0
  v_mov_b64 v[46:47], 0
  v_mov_b64 v[48:49], 0
  v_mov_b64 v[50:51], 0
  v_mov_b64 v[52:53], 0
  v_mov_b64 v[54:55], 0
  v_mov_b64 v[56:57], 0
  v_mov_b64 v[58:59], 0
  v_mov_b64 v[60:61], 0
  v_mov_b64 v[62:63], 0
  v_mov_b64 v[64:65], 0
  v_mov_b64 v[66:67], 0
  v_mov_b64 v[68:69], 0
  v_mov_b64 v[70:71], 0
  v_mov_b64 v[72:73], 0
  v_mov_b64 v[74:75], 0
  v_mov_b64 v[76:77], 0
  v_mov_b64 v[78:79], 0
  v_mov_b64 v[80:81], 0
  v_mov_b64 v[82:83], 0
  v_mov_b64 v[84:85], 0
  v_mov_b64 v[86:87], 0
  v_mov_b64 v[88:89], 0
  v_mov_b64 v[90:91], 0
  v_mov_b64 v[92:93], 0
  v_mov_b64 v[94:95], 0
  v_mov_b64 v[144:145], 0
  v_mov_b64 v[146:147], 0
  v_mov_b64 v[148:149], 0
  v_mov_b64 v[150:151], 0
  v_mov_b64 v[152:153], 0
  v_mov_b64 v[154:155], 0
  v_mov_b64 v[156:157], 0
  v_mov_b64 v[158:159], 0
  v_mov_b32 v224, 0xff800000
  v_mov_b32 v225, 0xff800000
  v_mov_b32 v226, 0xff800000
K1_safeloop:
  s_barrier
  s_add_u32 m0, s45, 49152
  s_nop 0
  buffer_load_dwordx4 v184, s[24:27], s41 offen nt lds
  buffer_load_dwordx4 v184, s[24:27], s41 offen offset:1024 nt lds
  buffer_load_dwordx4 v184, s[24:27], s41 offen offset:2048 nt lds
  buffer_load_dwordx4 v184, s[24:27], s41 offen offset:3072 nt lds
  s_add_u32 s41, s41, 16384
  s_add_u32 m0, s45, 65536
  s_nop 0
  buffer_load_dwordx4 v185, s[28:31], s42 offen nt lds
  buffer_load_dwordx4 v185, s[28:31], s42 offen offset:1024 nt lds
  buffer_load_dwordx4 v185, s[28:31], s42 offen offset:2048 nt lds
  buffer_load_dwordx4 v185, s[28:31], s42 offen offset:3072 nt lds
  s_add_u32 s42, s42, 16384
  s_waitcnt vmcnt(0)
  s_barrier
  ds_read_b128 a[48:51], v172 offset:49152
  ds_read_b128 a[52:55], v173 offset:49152
  ds_read_b128 a[56:59], v174 offset:49152
  ds_read_b128 a[60:63], v175 offset:49152
  ds_read_b128 a[64:67], v172 offset:50176
  ds_read_b128 a[68:71], v173 offset:50176
  ds_read_b128 a[72:75], v174 offset:50176
  ds_read_b128 a[76:79], v175 offset:50176
  ds_read_b128 a[80:83], v172 offset:51200
  ds_read_b128 a[84:87], v173 offset:51200
  ds_read_b128 a[88:91], v174 offset:51200
  ds_read_b128 a[92:95], v175 offset:51200
  ds_read_b128 a[96:99], v172 offset:52224
  ds_read_b128 a[100:103], v173 offset:52224
  ds_read_b128 a[104:107], v174 offset:52224
  ds_read_b128 a[108:111], v175 offset:52224
  ds_read_b64_tr_b16 a[112:113], v176
  ds_read_b64_tr_b16 a[114:115], v176 offset:1024
  ds_read_b64_tr_b16 a[116:117], v177
  ds_read_b64_tr_b16 a[118:119], v177 offset:1024
  ds_read_b64_tr_b16 a[120:121], v178
  ds_read_b64_tr_b16 a[122:123], v178 offset:1024
  ds_read_b64_tr_b16 a[124:125], v179
  ds_read_b64_tr_b16 a[126:127], v179 offset:1024
  ds_read_b64_tr_b16 a[128:129], v180
  ds_read_b64_tr_b16 a[130:131], v180 offset:1024
  ds_read_b64_tr_b16 a[132:133], v181
  ds_read_b64_tr_b16 a[134:135], v181 offset:1024
  ds_read_b64_tr_b16 a[136:137], v182
  ds_read_b64_tr_b16 a[138:139], v182 offset:1024
  ds_read_b64_tr_b16 a[140:141], v183
  ds_read_b64_tr_b16 a[142:143], v183 offset:1024
  ds_read_b64_tr_b16 a[144:145], v176 offset:2048
  ds_read_b64_tr_b16 a[146:147], v176 offset:3072
  ds_read_b64_tr_b16 a[148:149], v177 offset:2048
  ds_read_b64_tr_b16 a[150:151], v177 offset:3072
  ds_read_b64_tr_b16 a[152:153], v178 offset:2048
  ds_read_b64_tr_b16 a[154:155], v178 offset:3072
  ds_read_b64_tr_b16 a[156:157], v179 offset:2048
  ds_read_b64_tr_b16 a[158:159], v179 offset:3072
  ds_read_b64_tr_b16 a[160:161], v180 offset:2048
  ds_read_b64_tr_b16 a[162:163], v180 offset:3072
  ds_read_b64_tr_b16 a[164:165], v181 offset:2048
  ds_read_b64_tr_b16 a[166:167], v181 offset:3072
  ds_read_b64_tr_b16 a[168:169], v182 offset:2048
  ds_read_b64_tr_b16 a[170:171], v182 offset:3072
  ds_read_b64_tr_b16 a[172:173], v183 offset:2048
  ds_read_b64_tr_b16 a[174:175], v183 offset:3072
  s_waitcnt lgkmcnt(15)
  v_mfma_f32_16x16x32_bf16 v[96:99], a[48:51], a[0:3], v[144:147]
  v_mfma_f32_16x16x32_bf16 v[96:99], a[52:55], a[4:7], v[96:99]
  v_mfma_f32_16x16x32_bf16 v[96:99], a[56:59], a[8:11], v[96:99]
  v_mfma_f32_16x16x32_bf16 v[96:99], a[60:63], a[12:15], v[96:99]
  v_mfma_f32_16x16x32_bf16 v[100:103], a[64:67], a[0:3], v[144:147]
  v_mfma_f32_16x16x32_bf16 v[100:103], a[68:71], a[4:7], v[100:103]
  v_mfma_f32_16x16x32_bf16 v[100:103], a[72:75], a[8:11], v[100:103]
  v_mfma_f32_16x16x32_bf16 v[100:103], a[76:79], a[12:15], v[100:103]
  v_mfma_f32_16x16x32_bf16 v[104:107], a[48:51], a[16:19], v[148:151]
  v_mfma_f32_16x16x32_bf16 v[104:107], a[52:55], a[20:23], v[104:107]
  v_mfma_f32_16x16x32_bf16 v[104:107], a[56:59], a[24:27], v[104:107]
  v_mfma_f32_16x16x32_bf16 v[104:107], a[60:63], a[28:31], v[104:107]
  v_mfma_f32_16x16x32_bf16 v[108:111], a[64:67], a[16:19], v[148:151]
  v_mfma_f32_16x16x32_bf16 v[108:111], a[68:71], a[20:23], v[108:111]
  v_mfma_f32_16x16x32_bf16 v[108:111], a[72:75], a[24:27], v[108:111]
  v_mfma_f32_16x16x32_bf16 v[108:111], a[76:79], a[28:31], v[108:111]
  v_mfma_f32_16x16x32_bf16 v[112:115], a[48:51], a[32:35], v[152:155]
  v_mfma_f32_16x16x32_bf16 v[112:115], a[52:55], a[36:39], v[112:115]
  v_mfma_f32_16x16x32_bf16 v[112:115], a[56:59], a[40:43], v[112:115]
  v_mfma_f32_16x16x32_bf16 v[112:115], a[60:63], a[44:47], v[112:115]
  v_mfma_f32_16x16x32_bf16 v[116:119], a[64:67], a[32:35], v[152:155]
  v_mfma_f32_16x16x32_bf16 v[116:119], a[68:71], a[36:39], v[116:119]
  v_mfma_f32_16x16x32_bf16 v[116:119], a[72:75], a[40:43], v[116:119]
  v_mfma_f32_16x16x32_bf16 v[116:119], a[76:79], a[44:47], v[116:119]
  v_mfma_f32_16x16x32_bf16 v[120:123], a[80:83], a[0:3], v[144:147]
  v_mfma_f32_16x16x32_bf16 v[120:123], a[84:87], a[4:7], v[120:123]
  v_mfma_f32_16x16x32_bf16 v[120:123], a[88:91], a[8:11], v[120:123]
  v_mfma_f32_16x16x32_bf16 v[120:123], a[92:95], a[12:15], v[120:123]
  v_mfma_f32_16x16x32_bf16 v[124:127], a[96:99], a[0:3], v[144:147]
  v_mfma_f32_16x16x32_bf16 v[124:127], a[100:103], a[4:7], v[124:127]
  v_mfma_f32_16x16x32_bf16 v[124:127], a[104:107], a[8:11], v[124:127]
  v_mfma_f32_16x16x32_bf16 v[124:127], a[108:111], a[12:15], v[124:127]
  v_mfma_f32_16x16x32_bf16 v[128:131], a[80:83], a[16:19], v[148:151]
  v_mfma_f32_16x16x32_bf16 v[128:131], a[84:87], a[20:23], v[128:131]
  v_mfma_f32_16x16x32_bf16 v[128:131], a[88:91], a[24:27], v[128:131]
  v_mfma_f32_16x16x32_bf16 v[128:131], a[92:95], a[28:31], v[128:131]
  v_mfma_f32_16x16x32_bf16 v[132:135], a[96:99], a[16:19], v[148:151]
  v_mfma_f32_16x16x32_bf16 v[132:135], a[100:103], a[20:23], v[132:135]
  v_mfma_f32_16x16x32_bf16 v[132:135], a[104:107], a[24:27], v[132:135]
  v_mfma_f32_16x16x32_bf16 v[132:135], a[108:111], a[28:31], v[132:135]
  v_mfma_f32_16x16x32_bf16 v[136:139], a[80:83], a[32:35], v[152:155]
  v_mfma_f32_16x16x32_bf16 v[136:139], a[84:87], a[36:39], v[136:139]
  v_mfma_f32_16x16x32_bf16 v[136:139], a[88:91], a[40:43], v[136:139]
  v_mfma_f32_16x16x32_bf16 v[136:139], a[92:95], a[44:47], v[136:139]
  v_mfma_f32_16x16x32_bf16 v[140:143], a[96:99], a[32:35], v[152:155]
  v_mfma_f32_16x16x32_bf16 v[140:143], a[100:103], a[36:39], v[140:143]
  v_mfma_f32_16x16x32_bf16 v[140:143], a[104:107], a[40:43], v[140:143]
  v_mfma_f32_16x16x32_bf16 v[140:143], a[108:111], a[44:47], v[140:143]
  v_max3_f32 v216, v96, v97, v98
  v_max3_f32 v216, v216, v99, v100
  v_max3_f32 v216, v216, v101, v102
  v_max_f32 v216, v216, v103
  v_max3_f32 v216, v216, v120, v121
  v_max3_f32 v216, v216, v122, v123
  v_max3_f32 v216, v216, v124, v125
  v_max3_f32 v216, v216, v126, v127
  v_mov_b32 v219, v216
  s_nop 1
  v_permlane16_swap_b32 v219, v216
  v_max_f32 v216, v216, v219
  v_mov_b32 v219, v216
  s_nop 1
  v_permlane32_swap_b32 v219, v216
  v_max_f32 v216, v216, v219
  v_max_f32 v217, v216, v224
  v_max_f32 v218, 0, v217
  v_exp_f32 v218, -v218
  v_mov_b32 v224, 0
  v_sub_f32 v96, v96, v217
  v_sub_f32 v97, v97, v217
  v_sub_f32 v98, v98, v217
  v_sub_f32 v99, v99, v217
  v_sub_f32 v100, v100, v217
  v_sub_f32 v101, v101, v217
  v_sub_f32 v102, v102, v217
  v_sub_f32 v103, v103, v217
  v_sub_f32 v120, v120, v217
  v_sub_f32 v121, v121, v217
  v_sub_f32 v122, v122, v217
  v_sub_f32 v123, v123, v217
  v_sub_f32 v124, v124, v217
  v_sub_f32 v125, v125, v217
  v_sub_f32 v126, v126, v217
  v_sub_f32 v127, v127, v217
  v_sub_f32 v144, v144, v217
  v_sub_f32 v145, v145, v217
  v_sub_f32 v146, v146, v217
  v_sub_f32 v147, v147, v217
  v_mul_f32 v156, v218, v156
  v_mul_f32 v0, v218, v0
  v_mul_f32 v1, v218, v1
  v_mul_f32 v2, v218, v2
  v_mul_f32 v3, v218, v3
  v_mul_f32 v4, v218, v4
  v_mul_f32 v5, v218, v5
  v_mul_f32 v6, v218, v6
  v_mul_f32 v7, v218, v7
  v_mul_f32 v8, v218, v8
  v_mul_f32 v9, v218, v9
  v_mul_f32 v10, v218, v10
  v_mul_f32 v11, v218, v11
  v_mul_f32 v12, v218, v12
  v_mul_f32 v13, v218, v13
  v_mul_f32 v14, v218, v14
  v_mul_f32 v15, v218, v15
  v_mul_f32 v16, v218, v16
  v_mul_f32 v17, v218, v17
  v_mul_f32 v18, v218, v18
  v_mul_f32 v19, v218, v19
  v_mul_f32 v20, v218, v20
  v_mul_f32 v21, v218, v21
  v_mul_f32 v22, v218, v22
  v_mul_f32 v23, v218, v23
  v_mul_f32 v24, v218, v24
  v_mul_f32 v25, v218, v25
  v_mul_f32 v26, v218, v26
  v_mul_f32 v27, v218, v27
  v_mul_f32 v28, v218, v28
  v_mul_f32 v29, v218, v29
  v_mul_f32 v30, v218, v30
  v_mul_f32 v31, v218, v31
  v_exp_f32 v96, v96
  v_exp_f32 v97, v97
  v_exp_f32 v98, v98
  v_exp_f32 v99, v99
  v_exp_f32 v100, v100
  v_cvt_pk_bf16_f32 v96, v96, v97
  v_cvt_pk_bf16_f32 v97, v98, v99
  v_exp_f32 v101, v101
  v_exp_f32 v102, v102
  v_exp_f32 v103, v103
  v_cvt_pk_bf16_f32 v98, v100, v101
  v_cvt_pk_bf16_f32 v99, v102, v103
  v_exp_f32 v120, v120
  v_exp_f32 v121, v121
  v_exp_f32 v122, v122
  v_exp_f32 v123, v123
  v_exp_f32 v124, v124
  v_cvt_pk_bf16_f32 v120, v120, v121
  v_cvt_pk_bf16_f32 v121, v122, v123
  v_exp_f32 v125, v125
  v_exp_f32 v126, v126
  v_exp_f32 v127, v127
  v_cvt_pk_bf16_f32 v122, v124, v125
  v_cvt_pk_bf16_f32 v123, v126, v127
  v_max3_f32 v216, v104, v105, v106
  v_max3_f32 v216, v216, v107, v108
  v_max3_f32 v216, v216, v109, v110
  v_max_f32 v216, v216, v111
  v_max3_f32 v216, v216, v128, v129
  v_max3_f32 v216, v216, v130, v131
  v_max3_f32 v216, v216, v132, v133
  v_max3_f32 v216, v216, v134, v135
  v_mov_b32 v219, v216
  s_nop 1
  v_permlane16_swap_b32 v219, v216
  v_max_f32 v216, v216, v219
  v_mov_b32 v219, v216
  s_nop 1
  v_permlane32_swap_b32 v219, v216
  v_max_f32 v216, v216, v219
  v_max_f32 v217, v216, v225
  v_max_f32 v218, 0, v217
  v_exp_f32 v218, -v218
  v_mov_b32 v225, 0
  v_sub_f32 v104, v104, v217
  v_sub_f32 v105, v105, v217
  v_sub_f32 v106, v106, v217
  v_sub_f32 v107, v107, v217
  v_sub_f32 v108, v108, v217
  v_sub_f32 v109, v109, v217
  v_sub_f32 v110, v110, v217
  v_sub_f32 v111, v111, v217
  v_sub_f32 v128, v128, v217
  v_sub_f32 v129, v129, v217
  v_sub_f32 v130, v130, v217
  v_sub_f32 v131, v131, v217
  v_sub_f32 v132, v132, v217
  v_sub_f32 v133, v133, v217
  v_sub_f32 v134, v134, v217
  v_sub_f32 v135, v135, v217
  v_sub_f32 v148, v148, v217
  v_sub_f32 v149, v149, v217
  v_sub_f32 v150, v150, v217
  v_sub_f32 v151, v151, v217
  v_mul_f32 v157, v218, v157
  v_mul_f32 v32, v218, v32
  v_mul_f32 v33, v218, v33
  v_mul_f32 v34, v218, v34
  v_mul_f32 v35, v218, v35
  v_mul_f32 v36, v218, v36
  v_mul_f32 v37, v218, v37
  v_mul_f32 v38, v218, v38
  v_mul_f32 v39, v218, v39
  v_mul_f32 v40, v218, v40
  v_mul_f32 v41, v218, v41
  v_mul_f32 v42, v218, v42
  v_mul_f32 v43, v218, v43
  v_mul_f32 v44, v218, v44
  v_mul_f32 v45, v218, v45
  v_mul_f32 v46, v218, v46
  v_mul_f32 v47, v218, v47
  v_mul_f32 v48, v218, v48
  v_mul_f32 v49, v218, v49
  v_mul_f32 v50, v218, v50
  v_mul_f32 v51, v218, v51
  v_mul_f32 v52, v218, v52
  v_mul_f32 v53, v218, v53
  v_mul_f32 v54, v218, v54
  v_mul_f32 v55, v218, v55
  v_mul_f32 v56, v218, v56
  v_mul_f32 v57, v218, v57
  v_mul_f32 v58, v218, v58
  v_mul_f32 v59, v218, v59
  v_mul_f32 v60, v218, v60
  v_mul_f32 v61, v218, v61
  v_mul_f32 v62, v218, v62
  v_mul_f32 v63, v218, v63
  v_exp_f32 v104, v104
  v_exp_f32 v105, v105
  v_exp_f32 v106, v106
  v_exp_f32 v107, v107
  v_exp_f32 v108, v108
  v_cvt_pk_bf16_f32 v104, v104, v105
  v_cvt_pk_bf16_f32 v105, v106, v107
  v_exp_f32 v109, v109
  v_exp_f32 v110, v110
  v_exp_f32 v111, v111
  v_cvt_pk_bf16_f32 v106, v108, v109
  v_cvt_pk_bf16_f32 v107, v110, v111
  v_exp_f32 v128, v128
  v_exp_f32 v129, v129
  v_exp_f32 v130, v130
  v_exp_f32 v131, v131
  v_exp_f32 v132, v132
  v_cvt_pk_bf16_f32 v128, v128, v129
  v_cvt_pk_bf16_f32 v129, v130, v131
  v_exp_f32 v133, v133
  v_exp_f32 v134, v134
  v_exp_f32 v135, v135
  v_cvt_pk_bf16_f32 v130, v132, v133
  v_cvt_pk_bf16_f32 v131, v134, v135
  v_max3_f32 v216, v112, v113, v114
  v_max3_f32 v216, v216, v115, v116
  v_max3_f32 v216, v216, v117, v118
  v_max_f32 v216, v216, v119
  v_max3_f32 v216, v216, v136, v137
  v_max3_f32 v216, v216, v138, v139
  v_max3_f32 v216, v216, v140, v141
  v_max3_f32 v216, v216, v142, v143
  v_mov_b32 v219, v216
  s_nop 1
  v_permlane16_swap_b32 v219, v216
  v_max_f32 v216, v216, v219
  v_mov_b32 v219, v216
  s_nop 1
  v_permlane32_swap_b32 v219, v216
  v_max_f32 v216, v216, v219
  v_max_f32 v217, v216, v226
  v_max_f32 v218, 0, v217
  v_exp_f32 v218, -v218
  v_mov_b32 v226, 0
  v_sub_f32 v112, v112, v217
  v_sub_f32 v113, v113, v217
  v_sub_f32 v114, v114, v217
  v_sub_f32 v115, v115, v217
  v_sub_f32 v116, v116, v217
  v_sub_f32 v117, v117, v217
  v_sub_f32 v118, v118, v217
  v_sub_f32 v119, v119, v217
  v_sub_f32 v136, v136, v217
  v_sub_f32 v137, v137, v217
  v_sub_f32 v138, v138, v217
  v_sub_f32 v139, v139, v217
  v_sub_f32 v140, v140, v217
  v_sub_f32 v141, v141, v217
  v_sub_f32 v142, v142, v217
  v_sub_f32 v143, v143, v217
  v_sub_f32 v152, v152, v217
  v_sub_f32 v153, v153, v217
  v_sub_f32 v154, v154, v217
  v_sub_f32 v155, v155, v217
  v_mul_f32 v158, v218, v158
  v_mul_f32 v64, v218, v64
  v_mul_f32 v65, v218, v65
  v_mul_f32 v66, v218, v66
  v_mul_f32 v67, v218, v67
  v_mul_f32 v68, v218, v68
  v_mul_f32 v69, v218, v69
  v_mul_f32 v70, v218, v70
  v_mul_f32 v71, v218, v71
  v_mul_f32 v72, v218, v72
  v_mul_f32 v73, v218, v73
  v_mul_f32 v74, v218, v74
  v_mul_f32 v75, v218, v75
  v_mul_f32 v76, v218, v76
  v_mul_f32 v77, v218, v77
  v_mul_f32 v78, v218, v78
  v_mul_f32 v79, v218, v79
  v_mul_f32 v80, v218, v80
  v_mul_f32 v81, v218, v81
  v_mul_f32 v82, v218, v82
  v_mul_f32 v83, v218, v83
  v_mul_f32 v84, v218, v84
  v_mul_f32 v85, v218, v85
  v_mul_f32 v86, v218, v86
  v_mul_f32 v87, v218, v87
  v_mul_f32 v88, v218, v88
  v_mul_f32 v89, v218, v89
  v_mul_f32 v90, v218, v90
  v_mul_f32 v91, v218, v91
  v_mul_f32 v92, v218, v92
  v_mul_f32 v93, v218, v93
  v_mul_f32 v94, v218, v94
  v_mul_f32 v95, v218, v95
  v_exp_f32 v112, v112
  v_exp_f32 v113, v113
  v_exp_f32 v114, v114
  v_exp_f32 v115, v115
  v_exp_f32 v116, v116
  v_cvt_pk_bf16_f32 v112, v112, v113
  v_cvt_pk_bf16_f32 v113, v114, v115
  v_exp_f32 v117, v117
  v_exp_f32 v118, v118
  v_exp_f32 v119, v119
  v_cvt_pk_bf16_f32 v114, v116, v117
  v_cvt_pk_bf16_f32 v115, v118, v119
  v_exp_f32 v136, v136
  v_exp_f32 v137, v137
  v_exp_f32 v138, v138
  v_exp_f32 v139, v139
  v_exp_f32 v140, v140
  v_cvt_pk_bf16_f32 v136, v136, v137
  v_cvt_pk_bf16_f32 v137, v138, v139
  v_exp_f32 v141, v141
  v_exp_f32 v142, v142
  v_exp_f32 v143, v143
  v_cvt_pk_bf16_f32 v138, v140, v141
  v_cvt_pk_bf16_f32 v139, v142, v143
  s_waitcnt lgkmcnt(0)
  v_mfma_f32_16x16x32_bf16 v[0:3], a[112:115], v[96:99], v[0:3]
  v_mfma_f32_16x16x32_bf16 v[4:7], a[116:119], v[96:99], v[4:7]
  v_mfma_f32_16x16x32_bf16 v[8:11], a[120:123], v[96:99], v[8:11]
  v_mfma_f32_16x16x32_bf16 v[12:15], a[124:127], v[96:99], v[12:15]
  v_mfma_f32_16x16x32_bf16 v[16:19], a[128:131], v[96:99], v[16:19]
  v_mfma_f32_16x16x32_bf16 v[20:23], a[132:135], v[96:99], v[20:23]
  v_mfma_f32_16x16x32_bf16 v[24:27], a[136:139], v[96:99], v[24:27]
  v_mfma_f32_16x16x32_bf16 v[28:31], a[140:143], v[96:99], v[28:31]
  v_mfma_f32_16x16x32_bf16 v[156:159], v[160:163], v[96:99], v[156:159]
  v_mfma_f32_16x16x32_bf16 v[32:35], a[112:115], v[104:107], v[32:35]
  v_mfma_f32_16x16x32_bf16 v[36:39], a[116:119], v[104:107], v[36:39]
  v_mfma_f32_16x16x32_bf16 v[40:43], a[120:123], v[104:107], v[40:43]
  v_mfma_f32_16x16x32_bf16 v[44:47], a[124:127], v[104:107], v[44:47]
  v_mfma_f32_16x16x32_bf16 v[48:51], a[128:131], v[104:107], v[48:51]
  v_mfma_f32_16x16x32_bf16 v[52:55], a[132:135], v[104:107], v[52:55]
  v_mfma_f32_16x16x32_bf16 v[56:59], a[136:139], v[104:107], v[56:59]
  v_mfma_f32_16x16x32_bf16 v[60:63], a[140:143], v[104:107], v[60:63]
  v_mfma_f32_16x16x32_bf16 v[156:159], v[164:167], v[104:107], v[156:159]
  v_mfma_f32_16x16x32_bf16 v[64:67], a[112:115], v[112:115], v[64:67]
  v_mfma_f32_16x16x32_bf16 v[68:71], a[116:119], v[112:115], v[68:71]
  v_mfma_f32_16x16x32_bf16 v[72:75], a[120:123], v[112:115], v[72:75]
  v_mfma_f32_16x16x32_bf16 v[76:79], a[124:127], v[112:115], v[76:79]
  v_mfma_f32_16x16x32_bf16 v[80:83], a[128:131], v[112:115], v[80:83]
  v_mfma_f32_16x16x32_bf16 v[84:87], a[132:135], v[112:115], v[84:87]
  v_mfma_f32_16x16x32_bf16 v[88:91], a[136:139], v[112:115], v[88:91]
  v_mfma_f32_16x16x32_bf16 v[92:95], a[140:143], v[112:115], v[92:95]
  v_mfma_f32_16x16x32_bf16 v[156:159], v[168:171], v[112:115], v[156:159]
  v_mfma_f32_16x16x32_bf16 v[0:3], a[144:147], v[120:123], v[0:3]
  v_mfma_f32_16x16x32_bf16 v[4:7], a[148:151], v[120:123], v[4:7]
  v_mfma_f32_16x16x32_bf16 v[8:11], a[152:155], v[120:123], v[8:11]
  v_mfma_f32_16x16x32_bf16 v[12:15], a[156:159], v[120:123], v[12:15]
  v_mfma_f32_16x16x32_bf16 v[16:19], a[160:163], v[120:123], v[16:19]
  v_mfma_f32_16x16x32_bf16 v[20:23], a[164:167], v[120:123], v[20:23]
  v_mfma_f32_16x16x32_bf16 v[24:27], a[168:171], v[120:123], v[24:27]
  v_mfma_f32_16x16x32_bf16 v[28:31], a[172:175], v[120:123], v[28:31]
  v_mfma_f32_16x16x32_bf16 v[156:159], v[160:163], v[120:123], v[156:159]
  v_mfma_f32_16x16x32_bf16 v[32:35], a[144:147], v[128:131], v[32:35]
  v_mfma_f32_16x16x32_bf16 v[36:39], a[148:151], v[128:131], v[36:39]
  v_mfma_f32_16x16x32_bf16 v[40:43], a[152:155], v[128:131], v[40:43]
  v_mfma_f32_16x16x32_bf16 v[44:47], a[156:159], v[128:131], v[44:47]
  v_mfma_f32_16x16x32_bf16 v[48:51], a[160:163], v[128:131], v[48:51]
  v_mfma_f32_16x16x32_bf16 v[52:55], a[164:167], v[128:131], v[52:55]
  v_mfma_f32_16x16x32_bf16 v[56:59], a[168:171], v[128:131], v[56:59]
  v_mfma_f32_16x16x32_bf16 v[60:63], a[172:175], v[128:131], v[60:63]
  v_mfma_f32_16x16x32_bf16 v[156:159], v[164:167], v[128:131], v[156:159]
  v_mfma_f32_16x16x32_bf16 v[64:67], a[144:147], v[136:139], v[64:67]
  v_mfma_f32_16x16x32_bf16 v[68:71], a[148:151], v[136:139], v[68:71]
  v_mfma_f32_16x16x32_bf16 v[72:75], a[152:155], v[136:139], v[72:75]
  v_mfma_f32_16x16x32_bf16 v[76:79], a[156:159], v[136:139], v[76:79]
  v_mfma_f32_16x16x32_bf16 v[80:83], a[160:163], v[136:139], v[80:83]
  v_mfma_f32_16x16x32_bf16 v[84:87], a[164:167], v[136:139], v[84:87]
  v_mfma_f32_16x16x32_bf16 v[88:91], a[168:171], v[136:139], v[88:91]
  v_mfma_f32_16x16x32_bf16 v[92:95], a[172:175], v[136:139], v[92:95]
  v_mfma_f32_16x16x32_bf16 v[156:159], v[168:171], v[136:139], v[156:159]
  s_sub_u32 s43, s43, 1
  s_cmp_lg_u32 s43, 0
  s_cbranch_scc1 K1_safeloop
  s_barrier
  s_nop 15
  v_mov_b32 v128, 0
  v_mov_b32 v129, 0
  v_mov_b32 v130, 0
  v_mov_b32 v131, 0
  v_mov_b32 v132, 0
  v_mov_b32 v133, 0
  v_mov_b32 v134, 0
  v_mov_b32 v135, 0
  v_mov_b32 v136, 0
  v_mov_b32 v137, 0
  v_mov_b32 v138, 0
  v_mov_b32 v139, 0
  v_mov_b32 v140, 0
  v_mov_b32 v141, 0xff800000
  v_mov_b32 v142, 0xff800000
  v_mov_b32 v143, 0xff800000
  s_add_u32 m0, s45, 131072
  s_add_u32 s71, s67, 10
  s_and_b32 s71, s71, 7
  s_add_u32 s71, s71, 8
  s_mul_i32 s71, s71, 40960
  buffer_load_dwordx4 v188, s[92:95], s71 offen lds
  buffer_load_dwordx4 v189, s[92:95], s71 offen offset:1024 lds
  buffer_load_dwordx4 v190, s[92:95], s71 offen offset:2048 lds
  buffer_load_dwordx4 v191, s[92:95], s71 offen offset:3072 lds
  s_add_u32 m0, s45, 147456
  s_add_u32 s71, s67, 12
  s_and_b32 s71, s71, 7
  s_add_u32 s71, s71, 8
  s_mul_i32 s71, s71, 40960
  buffer_load_dwordx4 v188, s[92:95], s71 offen lds
  buffer_load_dwordx4 v189, s[92:95], s71 offen offset:1024 lds
  buffer_load_dwordx4 v190, s[92:95], s71 offen offset:2048 lds
  buffer_load_dwordx4 v191, s[92:95], s71 offen offset:3072 lds
  s_add_u32 m0, s45, 49152
  s_add_u32 s71, s67, 14
  s_and_b32 s71, s71, 7
  s_add_u32 s71, s71, 8
  s_mul_i32 s71, s71, 40960
  buffer_load_dwordx4 v188, s[92:95], s71 offen lds
  buffer_load_dwordx4 v189, s[92:95], s71 offen offset:1024 lds
  buffer_load_dwordx4 v190, s[92:95], s71 offen offset:2048 lds
  buffer_load_dwordx4 v191, s[92:95], s71 offen offset:3072 lds
  s_add_u32 m0, s45, 65536
  s_add_u32 s71, s67, 16
  s_and_b32 s71, s71, 7
  s_add_u32 s71, s71, 16
  s_mul_i32 s71, s71, 40960
  buffer_load_dwordx4 v188, s[92:95], s71 offen lds
  buffer_load_dwordx4 v189, s[92:95], s71 offen offset:1024 lds
  buffer_load_dwordx4 v190, s[92:95], s71 offen offset:2048 lds
  buffer_load_dwordx4 v191, s[92:95], s71 offen offset:3072 lds
  s_add_u32 m0, s45, 32768
  s_add_u32 s71, s67, 18
  s_and_b32 s71, s71, 7
  s_add_u32 s71, s71, 16
  s_mul_i32 s71, s71, 40960
  buffer_load_dwordx4 v188, s[92:95], s71 offen lds
  buffer_load_dwordx4 v189, s[92:95], s71 offen offset:1024 lds
  buffer_load_dwordx4 v190, s[92:95], s71 offen offset:2048 lds
  buffer_load_dwordx4 v191, s[92:95], s71 offen offset:3072 lds
  s_add_u32 m0, s45, 81920
  s_add_u32 s71, s67, 20
  s_and_b32 s71, s71, 7
  s_add_u32 s71, s71, 16
  s_mul_i32 s71, s71, 40960
  buffer_load_dwordx4 v188, s[92:95], s71 offen lds
  buffer_load_dwordx4 v189, s[92:95], s71 offen offset:1024 lds
  buffer_load_dwordx4 v190, s[92:95], s71 offen offset:2048 lds
  buffer_load_dwordx4 v191, s[92:95], s71 offen offset:3072 lds
  s_waitcnt vmcnt(0)
  s_nop 3
  s_branch K1_epi
.section .rodata,"a"
.p2align 6
.amdhsa_kernel standalone__mha_block_cached__near_ridge_kernel
  .amdhsa_next_free_vgpr 512
  .amdhsa_next_free_sgpr 100
  .amdhsa_accum_offset 256
  .amdhsa_group_segment_fixed_size 0
  .amdhsa_kernarg_size 64
  .amdhsa_user_sgpr_count 2
  .amdhsa_user_sgpr_kernarg_segment_ptr 1
  .amdhsa_system_sgpr_workgroup_id_x 1
.end_amdhsa_kernel
```
